```python
import torch

def _softmax(x, axis=-1):
    return torch.softmax(x, dim=axis)
def _gelu(x):
    return torch.nn.functional.gelu(x, approximate="tanh")
def _silu(x):
    return torch.nn.functional.silu(x)
def _sigmoid(x):
    return torch.sigmoid(x)
def _layernorm(x, axis=-1, eps=1e-5):
    m = x.mean(dim=axis, keepdim=True)
    v = x.var(dim=axis, keepdim=True, unbiased=False)
    return (x - m) / torch.sqrt(v + eps)
def _scatter_add(tgt, idx, src, axis=0):
    return tgt.clone().index_add_(axis, idx, src)
def _segment_sum(src, seg, n):
    out = torch.zeros((n,) + src.shape[1:], dtype=src.dtype)
    return out.index_add_(0, seg, src)
def _pad(x, pw):
    flat = tuple(v for pair in reversed(pw) for v in pair)
    return torch.nn.functional.pad(x, flat)

kernel_name = 'standalone__weight_only_int_gptq__prompt'

def setup_inputs():

    _w = (lambda a: (lambda t: t.to(torch.bfloat16) if t.is_floating_point() else t)(torch.as_tensor(a)))
    B, S, D, F = 1, 2048, 1024, 3584
    bits = max(2, min(4, 2))
    pf = 32 // bits
    G = 64 if 64 > 0 else D
    G = max(pf, (G // pf) * pf)
    D = max(G, (D // G) * G)
    ng = D // G
    qmax = 1 << bits
    qw = torch.randint(0, qmax, (D, F)).to(torch.int64)
    packed = torch.zeros((D // pf, F), dtype=torch.int64)
    for i in range(pf):
        packed |= (qw[i::pf] << (i * bits))
    packed = packed.to(torch.int32)
    return {
        "x": _w((lambda *s: torch.randn(*s, dtype=torch.bfloat16) * 0.05)(B, S, D)),
        "qw_packed": _w(packed),
        "scales": _w(torch.abs((lambda *s: torch.randn(*s, dtype=torch.bfloat16) * 0.05)(ng, F)).to(float) * 0.1 + 0.01),
        "zeros": _w(torch.randint(0, qmax, (ng, F)).to(float)),
        "bits": _w((lambda _x: torch.as_tensor(_x, dtype=torch.int32))(bits)),
    }

def reference(x, qw_packed, scales, zeros, bits):
    b = int(bits)
    pf = 32 // b
    mask = (1 << b) - 1
    P, F = qw_packed.shape
    D = P * pf
    ng = scales.shape[0]
    G = D // ng
    shifts = (lambda x, dt: x.to(dt))(torch.arange(pf) * b, qw_packed.dtype)
    qw = ((qw_packed[:, None, :] >> shifts[None, :, None]) & mask).reshape(D, F)
    s = (lambda x, n, axis: torch.repeat_interleave(x, n, dim=axis))(scales, G, axis=0)
    z = (lambda x, n, axis: torch.repeat_interleave(x, n, dim=axis))(zeros, G, axis=0)
    w = ((lambda x, dt: x.to(dt))(qw, x.dtype) - z) * s
    return torch.einsum("bsd,df->bsf", x, w)
```

```asm
; @launch grid=(256,1,1) block=(256,1,1) lds=163840
.amdgcn_target "amdgcn-amd-amdhsa--gfx950"
.text
.p2align 12
.fill 832, 4, 0xbf810000
.globl standalone__weight_only_int_gptq__prompt_kernel
.p2align 8
.type standalone__weight_only_int_gptq__prompt_kernel,@function
standalone__weight_only_int_gptq__prompt_kernel:
    s_load_dwordx2 s[16:17], s[0:1], 16
    s_load_dwordx2 s[20:21], s[0:1], 24
    s_load_dwordx2 s[12:13], s[0:1], 8
    s_load_dwordx2 s[8:9], s[0:1], 0
    s_load_dwordx2 s[24:25], s[0:1], 40
    s_cmp_ge_u32 s2, 256
    s_cbranch_scc1 L_end
    s_getpc_b64 s[36:37]
    s_lshr_b32 s53, s2, 3
    s_lshl_b32 s38, s53, 11
    v_lshrrev_b32 v136, 4, v0
    v_lshl_add_u32 v145, v136, 7, s38
    v_min_u32 v145, L_end-standalone__weight_only_int_gptq__prompt_kernel, v145
    global_load_dword a97, v145, s[36:37]
    v_readfirstlane_b32 s52, v0
    s_and_b32 s3, s2, 7
    s_mov_b32 s38, 0x40221e00
    s_mov_b32 s39, 0xc0a08060
    s_lshl_b32 s4, s3, 3
    s_lshr_b64 s[38:39], s[38:39], s4
    s_and_b32 s7, s38, 0xff
    s_bitcmp1_b32 5, s3
    s_cselect_b32 s6, 28, 0
    s_cselect_b32 s4, 30, 32
    s_cmp_ge_u32 s53, s4
    s_cbranch_scc1 L_helper
    v_and_b32 v142, 15, v0
    s_add_u32 s7, s7, s53
    s_sub_u32 s7, s7, 28
    v_and_b32 v143, 3, v136
    s_mul_i32 s4, s7, 2341
    s_lshr_b32 s4, s4, 16
    v_xor_b32 v138, v136, v0
    s_mul_i32 s5, s4, 28
    s_sub_u32 s54, s7, s5
    v_lshlrev_b32 v136, 1, v143
    s_sub_u32 s5, 27, s54
    s_bitcmp1_b32 s4, 0
    v_mov_b32 v137, 0x9c
    s_cselect_b32 s54, s5, s54
    s_mul_i32 s50, s4, 224
    v_bfe_u32 v144, v137, v136, 2
    s_addk_i32 s50, 480
    s_cmp_eq_u32 s3, 2
    v_mul_u32_u24 v136, 3584, v144
    s_cselect_b32 s5, 240, 0
    s_cmp_lt_u32 s53, s6
    v_mul_u32_u24 v139, 3584, v143
    s_cselect_b32 s54, s53, s54
    s_cselect_b32 s50, s5, s50
    v_lshrrev_b32 v140, 3, v0
    s_cselect_b32 s48, 1, 0
    s_lshl_b32 s47, s52, 4
    v_and_b32 v138, 7, v138
    s_lshr_b32 s52, s52, 6
    s_lshl2_add_u32 s32, s54, s52
    s_lshl_b32 s55, s32, 5
    v_lshl_add_u32 v137, v142, 1, s55
    v_add_lshl_u32 v3, v136, v137, 2
    v_add_lshl_u32 v15, v139, v137, 1
    v_add_lshl_u32 v136, v140, s50, 7
    v_add_lshl_u32 v5, v136, v138, 4
    s_mov_b32 s18, 114688
    s_mov_b32 s19, 0x20000
    s_mov_b64 s[22:23], s[18:19]
    s_mov_b32 s14, 917504
    s_mov_b32 s15, 0x20000
    s_mov_b32 s10, 4194304
    s_mov_b32 s11, 0x20000
    s_mov_b32 s62, 0x10000
    s_lshl_b32 s33, s50, 11
    s_waitcnt lgkmcnt(0)
    buffer_load_dword v30, v15, s[16:19], 0 offen
    buffer_load_dword v31, v15, s[20:23], 0 offen
    s_load_dword s98, s[8:9], s33
    s_load_dword s99, s[12:13], 0x140
    s_load_dword s100, s[20:21], 0x280
    s_xor_b32 s38, s33, 0x2003c0
    s_load_dword s101, s[8:9], s38
    buffer_load_dwordx2 v[22:23], v3, s[12:15], 0 offen
    s_mov_b32 s57, 57344
    buffer_load_dwordx2 v[24:25], v3, s[12:15], s57 offen
    s_mul_i32 s38, s50, 7168
    s_load_dword s96, s[24:25], s38 offset:0x500
    s_add_u32 s39, s38, 1605628
    s_load_dword s97, s[24:25], s39
    s_add_u32 m0, s47, 0
    s_movk_i32 s56, 0
    buffer_load_dwordx4 v5, s[8:11], s56 offen lds
    s_addk_i32 m0, 4096
    s_add_u32 s56, s56, s62
    buffer_load_dwordx4 v5, s[8:11], s56 offen lds
    s_addk_i32 m0, 4096
    s_add_u32 s56, s56, s62
    buffer_load_dwordx4 v5, s[8:11], s56 offen lds
    s_addk_i32 m0, 4096
    s_add_u32 s56, s56, s62
    buffer_load_dwordx4 v5, s[8:11], s56 offen lds
    s_lshl1_add_u32 s38, s32, s50
    s_lshl2_add_u32 s39, s7, s52
    s_lshl_b32 s4, s48, 12
    s_add_u32 s38, s38, s4
    s_cmp_lt_u32 s39, 480
    s_cselect_b32 s39, s39, s38
    s_max_u32 s39, s39, s4
    v_and_b32 v136, 1, v143
    v_add_u32 v136, s38, v136
    s_mov_b32 exec_lo, 0
    v_mov_b32 v136, s39
    s_mov_b32 exec_lo, -1
    v_bfe_u32 v137, v0, 1, 3
    v_min_u32 v137, 4, v137
    v_lshlrev_b32 v137, 7, v137
    v_lshl_add_u32 v7, v136, 11, v137
    s_movk_i32 s28, 128
    buffer_load_dword a96, v7, s[8:11], s28 offen
    s_addk_i32 m0, 4096
    s_add_u32 s56, s56, s62
    buffer_load_dwordx4 v5, s[8:11], s56 offen lds
    s_addk_i32 m0, 4096
    s_add_u32 s56, s56, s62
    buffer_load_dwordx4 v5, s[8:11], s56 offen lds
    s_addk_i32 m0, 4096
    s_add_u32 s56, s56, s62
    buffer_load_dwordx4 v5, s[8:11], s56 offen lds
    s_addk_i32 m0, 4096
    s_movk_i32 s56, 128
    buffer_load_dwordx4 v5, s[8:11], s56 offen lds
    s_mov_b32 s40, 0x4040000
    s_mov_b32 s41, 0x5050101
    s_mov_b32 s42, 0x6060202
    s_mov_b32 s43, 0x7070303
    s_mov_b32 s44, 0x03030303
    s_mov_b32 s45, 0x06040200
    s_mov_b32 s46, 0x07050301
    v_mov_b32 v1, 0x04000400
    v_lshrrev_b32 v136, 1, v142
    v_lshlrev_b32 v137, 1, v144
    v_xor_b32 v136, v136, v137
    v_lshlrev_b32 v136, 4, v136
    v_lshl_add_u32 v8, v142, 7, v136
    v_xor_b32 v9, 16, v8
    s_lshr_b32 s38, s52, 1
    s_mul_i32 s38, s38, 32640
    v_subrev_u32 v6, s38, v5
    s_movk_i32 s29, 768
    s_movk_i32 s30, 1408
    s_mov_b32 s26, 14680064
    s_mov_b32 s27, 0x20000
    s_mov_b32 s63, 93184
    s_mov_b32 s61, 57344
    v_add_u32 v10, 65536, v8
    v_add_u32 v11, 65536, v9
    v_add_u32 v12, 131072, v8
    v_add_u32 v13, 131072, v9
    s_mul_i32 s38, s52, 1024
    s_add_u32 s38, s38, 155648
    v_lshl_add_u32 v14, v0, 4, s38
    s_add_u32 s38, s38, s47
    v_lshl_add_u32 v2, v142, 4, s38
    v_lshl_add_u32 v136, v143, 2, s50
    v_mul_u32_u24 v136, 3584, v136
    v_lshl_add_u32 v137, v142, 1, s55
    v_add_lshl_u32 v4, v136, v137, 1
    s_mov_b64 exec, 0
    s_cmp_eq_u32 s48, 0
    s_cbranch_scc1 L_hopselB
    s_cmp_eq_u32 s52, 0
    s_cbranch_scc1 L_hopA1
    s_cmp_eq_u32 s52, 1
    s_cbranch_scc1 L_hopA2
    s_cmp_eq_u32 s52, 2
    s_cbranch_scc1 L_hopA3
    s_branch L_hopA4
L_hopselB:
    s_cmp_eq_u32 s52, 0
    s_cbranch_scc1 L_hopB1
    s_cmp_eq_u32 s52, 1
    s_cbranch_scc1 L_hopB2
    s_cmp_eq_u32 s52, 2
    s_cbranch_scc1 L_hopB3
    s_branch L_hopB4
L_hopret:
    s_mov_b64 exec, -1
    s_waitcnt vmcnt(11)
    v_lshlrev_b32 v36, 16, v30
    v_lshlrev_b32 v37, 16, v31
    v_mul_f32 v37, v36, v37
    v_sub_f32 v38, v36, v37
    v_fma_f32 v39, 2.0, v36, -v37
    v_add_f32 v36, v39, v36
    v_cvt_pk_bf16_f32 v37, -v37, v38
    v_cvt_pk_bf16_f32 v38, v39, v36
    v_perm_b32 v48, v38, v37, s46
    v_perm_b32 v49, v38, v37, s45
    v_and_b32 v36, 0xffff0000, v30
    v_and_b32 v37, 0xffff0000, v31
    v_mul_f32 v37, v36, v37
    v_sub_f32 v38, v36, v37
    v_fma_f32 v39, 2.0, v36, -v37
    v_add_f32 v36, v39, v36
    v_cvt_pk_bf16_f32 v37, -v37, v38
    v_cvt_pk_bf16_f32 v38, v39, v36
    v_perm_b32 v50, v38, v37, s46
    v_perm_b32 v51, v38, v37, s45
    v_mov_b32 v120, v48
    v_mov_b32 v121, v49
    v_mov_b32 v122, v50
    v_mov_b32 v123, v51
    s_nop 0
    v_permlane32_swap_b32 v48, v120
    v_permlane32_swap_b32 v49, v121
    v_permlane32_swap_b32 v50, v122
    v_permlane32_swap_b32 v51, v123
    v_mov_b32 v52, v48
    v_mov_b32 v53, v49
    v_mov_b32 v54, v50
    v_mov_b32 v55, v51
    s_waitcnt vmcnt(10)
    v_lshrrev_b64 v[16:17], 2, v[22:23]
    v_permlane16_swap_b32 v48, v52
    v_permlane16_swap_b32 v49, v53
    v_permlane16_swap_b32 v50, v54
    v_permlane16_swap_b32 v51, v55
    v_perm_b32 v18, v16, v22, s40
    v_perm_b32 v19, v16, v22, s41
    v_lshrrev_b64 v[20:21], 4, v[18:19]
    v_and_or_b32 v18, v18, s44, v1
    v_and_or_b32 v19, v19, s44, v1
    v_and_or_b32 v20, v20, s44, v1
    v_and_or_b32 v21, v21, s44, v1
    v_perm_b32 v56, v48, v49, v18
    v_perm_b32 v57, v48, v49, v20
    v_perm_b32 v58, v48, v49, v19
    v_perm_b32 v59, v48, v49, v21
    v_perm_b32 v18, v16, v22, s42
    v_perm_b32 v19, v16, v22, s43
    v_lshrrev_b64 v[20:21], 4, v[18:19]
    v_and_or_b32 v18, v18, s44, v1
    v_and_or_b32 v19, v19, s44, v1
    v_and_or_b32 v20, v20, s44, v1
    v_and_or_b32 v21, v21, s44, v1
    v_perm_b32 v64, v48, v49, v18
    v_perm_b32 v65, v48, v49, v20
    v_perm_b32 v66, v48, v49, v19
    v_perm_b32 v67, v48, v49, v21
    v_perm_b32 v18, v17, v23, s40
    v_perm_b32 v19, v17, v23, s41
    v_lshrrev_b64 v[20:21], 4, v[18:19]
    v_and_or_b32 v18, v18, s44, v1
    v_and_or_b32 v19, v19, s44, v1
    v_and_or_b32 v20, v20, s44, v1
    v_and_or_b32 v21, v21, s44, v1
    v_perm_b32 v60, v50, v51, v18
    v_perm_b32 v61, v50, v51, v20
    v_perm_b32 v62, v50, v51, v19
    v_perm_b32 v63, v50, v51, v21
    v_perm_b32 v18, v17, v23, s42
    v_perm_b32 v19, v17, v23, s43
    v_lshrrev_b64 v[20:21], 4, v[18:19]
    v_and_or_b32 v18, v18, s44, v1
    v_and_or_b32 v19, v19, s44, v1
    v_and_or_b32 v20, v20, s44, v1
    v_and_or_b32 v21, v21, s44, v1
    v_perm_b32 v68, v50, v51, v18
    v_perm_b32 v69, v50, v51, v20
    v_perm_b32 v70, v50, v51, v19
    v_perm_b32 v71, v50, v51, v21
    s_addk_i32 m0, 4096
    s_add_u32 s56, s56, s62
    buffer_load_dwordx4 v5, s[8:11], s56 offen lds
    s_addk_i32 m0, 4096
    s_add_u32 s56, s56, s62
    buffer_load_dwordx4 v5, s[8:11], s56 offen lds
    s_addk_i32 m0, 4096
    s_add_u32 s56, s56, s62
    buffer_load_dwordx4 v5, s[8:11], s56 offen lds
    s_cmp_eq_u32 s48, 0
    s_cbranch_scc1 L_mainB
L_mainA:
    s_waitcnt vmcnt(9)
    s_barrier
    ds_read_b128 a[0:3], v8 offset:0
    ds_read_b128 a[4:7], v9 offset:0
    ds_read_b128 a[8:11], v8 offset:2048
    ds_read_b128 a[12:15], v9 offset:2048
    ds_read_b128 a[16:19], v8 offset:4096
    s_waitcnt lgkmcnt(3)
    v_mfma_f32_16x16x32_bf16 v[136:139], a[0:3], v[56:59], 0
    ds_read_b128 a[20:23], v9 offset:4096
    v_lshrrev_b64 v[16:17], 2, v[24:25]
    v_mfma_f32_16x16x32_bf16 v[136:139], a[4:7], v[64:67], v[136:139]
    s_add_u32 s56, s56, s62
    v_perm_b32 v18, v16, v24, s40
    v_perm_b32 v19, v16, v24, s41
    v_lshrrev_b64 v[20:21], 4, v[18:19]
    v_mfma_f32_16x16x32_bf16 v[140:143], a[0:3], v[60:63], 0
    s_waitcnt lgkmcnt(3)
    s_addk_i32 m0, 4096
    ds_read_b128 a[24:27], v8 offset:6144
    v_mfma_f32_16x16x32_bf16 v[140:143], a[4:7], v[68:71], v[140:143]
    buffer_load_dwordx4 v5, s[8:11], s56 offen lds
    v_mfma_f32_16x16x32_bf16 v[144:147], a[8:11], v[56:59], 0
    s_waitcnt lgkmcnt(2)
    ds_read_b128 a[28:31], v9 offset:6144
    v_and_or_b32 v18, v18, s44, v1
    v_mfma_f32_16x16x32_bf16 v[144:147], a[12:15], v[64:67], v[144:147]
    s_add_u32 s56, s56, s62
    v_and_or_b32 v19, v19, s44, v1
    v_and_or_b32 v20, v20, s44, v1
    v_and_or_b32 v21, v21, s44, v1
    v_mfma_f32_16x16x32_bf16 v[148:151], a[8:11], v[60:63], 0
    s_add_u32 s57, s57, s61
    ds_read_b128 a[32:35], v8 offset:8192
    v_perm_b32 v72, v52, v53, v18
    v_mfma_f32_16x16x32_bf16 v[148:151], a[12:15], v[68:71], v[148:151]
    buffer_load_dwordx2 v[26:27], v3, s[12:15], s57 offen
    v_mfma_f32_16x16x32_bf16 v[152:155], a[16:19], v[56:59], 0
    s_waitcnt lgkmcnt(2)
    s_addk_i32 m0, 4096
    ds_read_b128 a[36:39], v9 offset:8192
    v_mfma_f32_16x16x32_bf16 v[152:155], a[20:23], v[64:67], v[152:155]
    buffer_load_dwordx4 v5, s[8:11], s56 offen lds
    v_mfma_f32_16x16x32_bf16 v[156:159], a[16:19], v[60:63], 0
    ds_read_b128 a[40:43], v8 offset:10240
    v_perm_b32 v73, v52, v53, v20
    v_mfma_f32_16x16x32_bf16 v[156:159], a[20:23], v[68:71], v[156:159]
    s_add_u32 s56, s56, s62
    v_perm_b32 v74, v52, v53, v19
    v_perm_b32 v75, v52, v53, v21
    v_perm_b32 v18, v16, v24, s42
    v_mfma_f32_16x16x32_bf16 v[160:163], a[24:27], v[56:59], 0
    s_waitcnt vmcnt(9) lgkmcnt(2)
    ds_read_b128 a[44:47], v9 offset:10240
    v_perm_b32 v19, v16, v24, s43
    v_mfma_f32_16x16x32_bf16 v[160:163], a[28:31], v[64:67], v[160:163]
    s_barrier
    v_mfma_f32_16x16x32_bf16 v[164:167], a[24:27], v[60:63], 0
    s_addk_i32 m0, 4096
    ds_read_b128 a[48:51], v8 offset:12288
    v_mfma_f32_16x16x32_bf16 v[164:167], a[28:31], v[68:71], v[164:167]
    buffer_load_dwordx4 v5, s[8:11], s56 offen lds
    v_mfma_f32_16x16x32_bf16 v[168:171], a[32:35], v[56:59], 0
    s_waitcnt lgkmcnt(2)
    ds_read_b128 a[52:55], v9 offset:12288
    v_lshrrev_b64 v[20:21], 4, v[18:19]
    v_mfma_f32_16x16x32_bf16 v[168:171], a[36:39], v[64:67], v[168:171]
    s_mov_b32 s56, 458752
    v_and_or_b32 v18, v18, s44, v1
    v_and_or_b32 v19, v19, s44, v1
    v_and_or_b32 v20, v20, s44, v1
    v_mfma_f32_16x16x32_bf16 v[172:175], a[32:35], v[60:63], 0
    s_addk_i32 m0, 4096
    ds_read_b128 a[56:59], v8 offset:14336
    v_and_or_b32 v21, v21, s44, v1
    v_mfma_f32_16x16x32_bf16 v[172:175], a[36:39], v[68:71], v[172:175]
    buffer_load_dwordx4 v6, s[8:11], s56 offen lds
    v_mfma_f32_16x16x32_bf16 v[176:179], a[40:43], v[56:59], 0
    s_waitcnt lgkmcnt(2)
    ds_read_b128 a[60:63], v9 offset:14336
    v_perm_b32 v80, v52, v53, v18
    v_mfma_f32_16x16x32_bf16 v[176:179], a[44:47], v[64:67], v[176:179]
    s_movk_i32 s56, 256
    v_perm_b32 v81, v52, v53, v20
    v_perm_b32 v82, v52, v53, v19
    v_perm_b32 v83, v52, v53, v21
    v_mfma_f32_16x16x32_bf16 v[180:183], a[40:43], v[60:63], 0
    s_addk_i32 m0, 4096
    ds_read_b128 a[64:67], v8 offset:16384
    v_perm_b32 v18, v17, v25, s40
    v_mfma_f32_16x16x32_bf16 v[180:183], a[44:47], v[68:71], v[180:183]
    buffer_load_dwordx4 v5, s[8:11], s56 offen lds
    v_mfma_f32_16x16x32_bf16 v[184:187], a[48:51], v[56:59], 0
    s_waitcnt lgkmcnt(2)
    ds_read_b128 a[68:71], v9 offset:16384
    v_perm_b32 v19, v17, v25, s41
    v_mfma_f32_16x16x32_bf16 v[184:187], a[52:55], v[64:67], v[184:187]
    s_add_u32 s56, s56, s62
    v_lshrrev_b64 v[20:21], 4, v[18:19]
    v_and_or_b32 v18, v18, s44, v1
    v_and_or_b32 v19, v19, s44, v1
    v_mfma_f32_16x16x32_bf16 v[188:191], a[48:51], v[60:63], 0
    s_addk_i32 m0, 4096
    ds_read_b128 a[72:75], v8 offset:18432
    v_and_or_b32 v20, v20, s44, v1
    v_mfma_f32_16x16x32_bf16 v[188:191], a[52:55], v[68:71], v[188:191]
    buffer_load_dwordx4 v5, s[8:11], s56 offen lds
    v_mfma_f32_16x16x32_bf16 v[192:195], a[56:59], v[56:59], 0
    s_waitcnt vmcnt(10) lgkmcnt(2)
    ds_read_b128 a[76:79], v9 offset:18432
    v_mfma_f32_16x16x32_bf16 v[192:195], a[60:63], v[64:67], v[192:195]
    s_barrier
    v_mfma_f32_16x16x32_bf16 v[196:199], a[56:59], v[60:63], 0
    s_waitcnt lgkmcnt(2)
    ds_read_b128 a[80:83], v8 offset:20480
    v_and_or_b32 v21, v21, s44, v1
    v_mfma_f32_16x16x32_bf16 v[196:199], a[60:63], v[68:71], v[196:199]
    s_add_u32 s56, s56, s62
    v_perm_b32 v76, v54, v55, v18
    v_perm_b32 v77, v54, v55, v20
    v_perm_b32 v78, v54, v55, v19
    v_mfma_f32_16x16x32_bf16 v[200:203], a[64:67], v[56:59], 0
    s_addk_i32 m0, 4096
    ds_read_b128 a[84:87], v9 offset:20480
    v_perm_b32 v79, v54, v55, v21
    v_mfma_f32_16x16x32_bf16 v[200:203], a[68:71], v[64:67], v[200:203]
    buffer_load_dwordx4 v5, s[8:11], s56 offen lds
    v_mfma_f32_16x16x32_bf16 v[204:207], a[64:67], v[60:63], 0
    s_waitcnt lgkmcnt(2)
    s_movk_i32 s59, 28672
    ds_read_b128 a[88:91], v8 offset:22528
    v_mfma_f32_16x16x32_bf16 v[204:207], a[68:71], v[68:71], v[204:207]
    buffer_load_dword v32, v15, s[16:19], s59 offen
    v_mfma_f32_16x16x32_bf16 v[208:211], a[72:75], v[56:59], 0
    s_add_u32 s56, s56, s62
    ds_read_b128 a[92:95], v9 offset:22528
    v_perm_b32 v18, v17, v25, s42
    v_mfma_f32_16x16x32_bf16 v[208:211], a[76:79], v[64:67], v[208:211]
    buffer_load_dword v33, v15, s[20:23], s59 offen
    v_mfma_f32_16x16x32_bf16 v[212:215], a[72:75], v[60:63], 0
    s_waitcnt lgkmcnt(2)
    s_addk_i32 m0, 4096
    ds_read_b128 a[0:3], v8 offset:24576
    v_mfma_f32_16x16x32_bf16 v[212:215], a[76:79], v[68:71], v[212:215]
    buffer_load_dwordx4 v5, s[8:11], s56 offen lds
    v_mfma_f32_16x16x32_bf16 v[216:219], a[80:83], v[56:59], 0
    s_waitcnt lgkmcnt(2)
    ds_read_b128 a[4:7], v9 offset:24576
    v_perm_b32 v19, v17, v25, s43
    v_mfma_f32_16x16x32_bf16 v[216:219], a[84:87], v[64:67], v[216:219]
    s_add_u32 s56, s56, s62
    v_lshrrev_b64 v[20:21], 4, v[18:19]
    v_and_or_b32 v18, v18, s44, v1
    v_and_or_b32 v19, v19, s44, v1
    v_mfma_f32_16x16x32_bf16 v[220:223], a[80:83], v[60:63], 0
    s_addk_i32 m0, 4096
    ds_read_b128 a[8:11], v8 offset:26624
    v_and_or_b32 v20, v20, s44, v1
    v_mfma_f32_16x16x32_bf16 v[220:223], a[84:87], v[68:71], v[220:223]
    buffer_load_dwordx4 v5, s[8:11], s56 offen lds
    v_mfma_f32_16x16x32_bf16 v[224:227], a[88:91], v[56:59], 0
    s_waitcnt lgkmcnt(2)
    ds_read_b128 a[12:15], v9 offset:26624
    v_and_or_b32 v21, v21, s44, v1
    v_mfma_f32_16x16x32_bf16 v[224:227], a[92:95], v[64:67], v[224:227]
    v_perm_b32 v84, v54, v55, v18
    v_perm_b32 v85, v54, v55, v20
    v_perm_b32 v86, v54, v55, v19
    v_mfma_f32_16x16x32_bf16 v[228:231], a[88:91], v[60:63], 0
    s_waitcnt lgkmcnt(2)
    ds_read_b128 a[16:19], v8 offset:28672
    v_perm_b32 v87, v54, v55, v21
    v_mfma_f32_16x16x32_bf16 v[228:231], a[92:95], v[68:71], v[228:231]
    s_add_u32 s56, s56, s62
    v_mov_b32 v124, v120
    v_mov_b32 v125, v121
    v_mov_b32 v126, v122
    v_mfma_f32_16x16x32_bf16 v[232:235], a[0:3], v[56:59], 0
    s_addk_i32 m0, 4096
    ds_read_b128 a[20:23], v9 offset:28672
    v_mov_b32 v127, v123
    v_mfma_f32_16x16x32_bf16 v[232:235], a[4:7], v[64:67], v[232:235]
    buffer_load_dwordx4 v5, s[8:11], s56 offen lds
    v_mfma_f32_16x16x32_bf16 v[236:239], a[0:3], v[60:63], 0
    s_waitcnt lgkmcnt(2)
    ds_read_b128 a[24:27], v8 offset:30720
    v_mfma_f32_16x16x32_bf16 v[236:239], a[4:7], v[68:71], v[236:239]
    s_add_u32 s56, s56, s62
    v_permlane16_swap_b32 v120, v124
    v_mfma_f32_16x16x32_bf16 v[240:243], a[8:11], v[56:59], 0
    s_waitcnt vmcnt(10) lgkmcnt(2)
    ds_read_b128 a[28:31], v9 offset:30720
    v_mfma_f32_16x16x32_bf16 v[240:243], a[12:15], v[64:67], v[240:243]
    s_barrier
    v_mfma_f32_16x16x32_bf16 v[244:247], a[8:11], v[60:63], 0
    s_addk_i32 m0, 4096
    ds_read_b128 a[32:35], v8 offset:32768
    v_mfma_f32_16x16x32_bf16 v[244:247], a[12:15], v[68:71], v[244:247]
    buffer_load_dwordx4 v5, s[8:11], s56 offen lds
    v_mfma_f32_16x16x32_bf16 v[136:139], a[16:19], v[72:75], v[136:139]
    s_waitcnt lgkmcnt(2)
    ds_read_b128 a[36:39], v9 offset:32768
    v_mfma_f32_16x16x32_bf16 v[136:139], a[20:23], v[80:83], v[136:139]
    s_add_u32 s56, s56, s62
    v_permlane16_swap_b32 v121, v125
    v_mfma_f32_16x16x32_bf16 v[140:143], a[16:19], v[76:79], v[140:143]
    s_add_u32 s57, s57, s61
    ds_read_b128 a[40:43], v8 offset:34816
    v_mfma_f32_16x16x32_bf16 v[140:143], a[20:23], v[84:87], v[140:143]
    buffer_load_dwordx2 v[28:29], v3, s[12:15], s57 offen
    v_mfma_f32_16x16x32_bf16 v[144:147], a[24:27], v[72:75], v[144:147]
    s_waitcnt lgkmcnt(2)
    s_addk_i32 m0, 4096
    ds_read_b128 a[44:47], v9 offset:34816
    v_mfma_f32_16x16x32_bf16 v[144:147], a[28:31], v[80:83], v[144:147]
    buffer_load_dwordx4 v6, s[8:11], s56 offen lds
    v_mfma_f32_16x16x32_bf16 v[148:151], a[24:27], v[76:79], v[148:151]
    ds_read_b128 a[48:51], v8 offset:36864
    v_mfma_f32_16x16x32_bf16 v[148:151], a[28:31], v[84:87], v[148:151]
    v_permlane16_swap_b32 v122, v126
    v_mfma_f32_16x16x32_bf16 v[152:155], a[32:35], v[72:75], v[152:155]
    s_waitcnt lgkmcnt(2)
    ds_read_b128 a[52:55], v9 offset:36864
    v_mfma_f32_16x16x32_bf16 v[152:155], a[36:39], v[80:83], v[152:155]
    s_movk_i32 s56, 384
    v_permlane16_swap_b32 v123, v127
    v_lshrrev_b64 v[16:17], 2, v[26:27]
    v_mfma_f32_16x16x32_bf16 v[156:159], a[32:35], v[76:79], v[156:159]
    s_addk_i32 m0, 4096
    ds_read_b128 a[56:59], v8 offset:38912
    v_perm_b32 v18, v16, v26, s40
    v_mfma_f32_16x16x32_bf16 v[156:159], a[36:39], v[84:87], v[156:159]
    buffer_load_dwordx4 v5, s[8:11], s56 offen lds
    v_mfma_f32_16x16x32_bf16 v[160:163], a[40:43], v[72:75], v[160:163]
    s_waitcnt lgkmcnt(2)
    ds_read_b128 a[60:63], v9 offset:38912
    v_perm_b32 v19, v16, v26, s41
    v_mfma_f32_16x16x32_bf16 v[160:163], a[44:47], v[80:83], v[160:163]
    v_lshrrev_b64 v[20:21], 4, v[18:19]
    v_and_or_b32 v18, v18, s44, v1
    v_and_or_b32 v19, v19, s44, v1
    v_mfma_f32_16x16x32_bf16 v[164:167], a[40:43], v[76:79], v[164:167]
    s_waitcnt lgkmcnt(2)
    ds_read_b128 a[64:67], v8 offset:40960
    v_and_or_b32 v20, v20, s44, v1
    v_mfma_f32_16x16x32_bf16 v[164:167], a[44:47], v[84:87], v[164:167]
    s_add_u32 s56, s56, s62
    v_and_or_b32 v21, v21, s44, v1
    v_perm_b32 v88, v120, v121, v18
    v_perm_b32 v89, v120, v121, v20
    v_mfma_f32_16x16x32_bf16 v[168:171], a[48:51], v[72:75], v[168:171]
    s_addk_i32 m0, 4096
    ds_read_b128 a[68:71], v9 offset:40960
    v_perm_b32 v90, v120, v121, v19
    v_mfma_f32_16x16x32_bf16 v[168:171], a[52:55], v[80:83], v[168:171]
    buffer_load_dwordx4 v5, s[8:11], s56 offen lds
    v_mfma_f32_16x16x32_bf16 v[172:175], a[48:51], v[76:79], v[172:175]
    ds_read_b128 a[72:75], v8 offset:43008
    v_perm_b32 v91, v120, v121, v21
    v_mfma_f32_16x16x32_bf16 v[172:175], a[52:55], v[84:87], v[172:175]
    s_waitcnt lgkmcnt(2)
    v_perm_b32 v18, v16, v26, s42
    v_perm_b32 v19, v16, v26, s43
    v_lshrrev_b64 v[20:21], 4, v[18:19]
    v_mfma_f32_16x16x32_bf16 v[176:179], a[56:59], v[72:75], v[176:179]
    ds_read_b128 a[76:79], v9 offset:43008
    v_and_or_b32 v18, v18, s44, v1
    v_mfma_f32_16x16x32_bf16 v[176:179], a[60:63], v[80:83], v[176:179]
    s_add_u32 s56, s56, s62
    v_and_or_b32 v19, v19, s44, v1
    v_and_or_b32 v20, v20, s44, v1
    v_and_or_b32 v21, v21, s44, v1
    v_mfma_f32_16x16x32_bf16 v[180:183], a[56:59], v[76:79], v[180:183]
    s_addk_i32 m0, 4096
    ds_read_b128 a[80:83], v8 offset:45056
    v_perm_b32 v96, v120, v121, v18
    v_mfma_f32_16x16x32_bf16 v[180:183], a[60:63], v[84:87], v[180:183]
    buffer_load_dwordx4 v5, s[8:11], s56 offen lds
    v_mfma_f32_16x16x32_bf16 v[184:187], a[64:67], v[72:75], v[184:187]
    s_waitcnt lgkmcnt(2)
    ds_read_b128 a[84:87], v9 offset:45056
    v_perm_b32 v97, v120, v121, v20
    v_mfma_f32_16x16x32_bf16 v[184:187], a[68:71], v[80:83], v[184:187]
    v_perm_b32 v98, v120, v121, v19
    v_perm_b32 v99, v120, v121, v21
    v_perm_b32 v18, v17, v27, s40
    v_mfma_f32_16x16x32_bf16 v[188:191], a[64:67], v[76:79], v[188:191]
    s_waitcnt lgkmcnt(2)
    ds_read_b128 a[88:91], v8 offset:47104
    v_perm_b32 v19, v17, v27, s41
    v_mfma_f32_16x16x32_bf16 v[188:191], a[68:71], v[84:87], v[188:191]
    s_add_u32 s56, s56, s62
    v_lshrrev_b64 v[20:21], 4, v[18:19]
    v_and_or_b32 v18, v18, s44, v1
    v_and_or_b32 v19, v19, s44, v1
    v_mfma_f32_16x16x32_bf16 v[192:195], a[72:75], v[72:75], v[192:195]
    s_addk_i32 m0, 4096
    ds_read_b128 a[92:95], v9 offset:47104
    v_and_or_b32 v20, v20, s44, v1
    v_mfma_f32_16x16x32_bf16 v[192:195], a[76:79], v[80:83], v[192:195]
    buffer_load_dwordx4 v5, s[8:11], s56 offen lds
    v_mfma_f32_16x16x32_bf16 v[196:199], a[72:75], v[76:79], v[196:199]
    ds_read_b128 a[0:3], v8 offset:49152
    v_and_or_b32 v21, v21, s44, v1
    v_mfma_f32_16x16x32_bf16 v[196:199], a[76:79], v[84:87], v[196:199]
    s_waitcnt lgkmcnt(2)
    v_perm_b32 v92, v122, v123, v18
    v_perm_b32 v93, v122, v123, v20
    v_perm_b32 v94, v122, v123, v19
    v_mfma_f32_16x16x32_bf16 v[200:203], a[80:83], v[72:75], v[200:203]
    ds_read_b128 a[4:7], v9 offset:49152
    v_perm_b32 v95, v122, v123, v21
    v_mfma_f32_16x16x32_bf16 v[200:203], a[84:87], v[80:83], v[200:203]
    s_add_u32 s56, s56, s62
    v_perm_b32 v18, v17, v27, s42
    v_perm_b32 v19, v17, v27, s43
    v_lshrrev_b64 v[20:21], 4, v[18:19]
    v_mfma_f32_16x16x32_bf16 v[204:207], a[80:83], v[76:79], v[204:207]
    s_addk_i32 m0, 4096
    ds_read_b128 a[8:11], v8 offset:51200
    v_and_or_b32 v18, v18, s44, v1
    v_mfma_f32_16x16x32_bf16 v[204:207], a[84:87], v[84:87], v[204:207]
    buffer_load_dwordx4 v5, s[8:11], s56 offen lds
    v_mfma_f32_16x16x32_bf16 v[208:211], a[88:91], v[72:75], v[208:211]
    s_waitcnt vmcnt(8) lgkmcnt(2)
    ds_read_b128 a[12:15], v9 offset:51200
    v_mfma_f32_16x16x32_bf16 v[208:211], a[92:95], v[80:83], v[208:211]
    s_barrier
    v_mfma_f32_16x16x32_bf16 v[212:215], a[88:91], v[76:79], v[212:215]
    s_waitcnt lgkmcnt(2)
    ds_read_b128 a[16:19], v8 offset:53248
    v_and_or_b32 v19, v19, s44, v1
    v_mfma_f32_16x16x32_bf16 v[212:215], a[92:95], v[84:87], v[212:215]
    s_add_u32 s56, s56, s62
    v_and_or_b32 v20, v20, s44, v1
    v_and_or_b32 v21, v21, s44, v1
    v_perm_b32 v100, v122, v123, v18
    v_mfma_f32_16x16x32_bf16 v[216:219], a[0:3], v[72:75], v[216:219]
    s_addk_i32 m0, 4096
    ds_read_b128 a[20:23], v9 offset:53248
    v_perm_b32 v101, v122, v123, v20
    v_mfma_f32_16x16x32_bf16 v[216:219], a[4:7], v[80:83], v[216:219]
    buffer_load_dwordx4 v5, s[8:11], s56 offen lds
    v_mfma_f32_16x16x32_bf16 v[220:223], a[0:3], v[76:79], v[220:223]
L_hopA1:
    s_cbranch_execz L_hopA5
    ds_read_b128 a[24:27], v8 offset:55296
    v_perm_b32 v102, v122, v123, v19
    v_mfma_f32_16x16x32_bf16 v[220:223], a[4:7], v[84:87], v[220:223]
    s_waitcnt lgkmcnt(2)
    v_perm_b32 v103, v122, v123, v21
    v_lshlrev_b32 v36, 16, v32
    v_lshlrev_b32 v37, 16, v33
    v_mfma_f32_16x16x32_bf16 v[224:227], a[8:11], v[72:75], v[224:227]
    ds_read_b128 a[28:31], v9 offset:55296
    v_mul_f32 v37, v36, v37
    v_mfma_f32_16x16x32_bf16 v[224:227], a[12:15], v[80:83], v[224:227]
    s_add_u32 s56, s56, s62
    v_sub_f32 v38, v36, v37
    v_fma_f32 v39, 2.0, v36, -v37
    v_add_f32 v36, v39, v36
    v_mfma_f32_16x16x32_bf16 v[228:231], a[8:11], v[76:79], v[228:231]
    s_addk_i32 m0, 4096
    ds_read_b128 a[32:35], v8 offset:57344
    v_cvt_pk_bf16_f32 v37, -v37, v38
    v_mfma_f32_16x16x32_bf16 v[228:231], a[12:15], v[84:87], v[228:231]
    buffer_load_dwordx4 v5, s[8:11], s56 offen lds
    v_mfma_f32_16x16x32_bf16 v[232:235], a[16:19], v[72:75], v[232:235]
    s_waitcnt lgkmcnt(2)
    ds_read_b128 a[36:39], v9 offset:57344
    v_cvt_pk_bf16_f32 v38, v39, v36
    v_mfma_f32_16x16x32_bf16 v[232:235], a[20:23], v[80:83], v[232:235]
    v_perm_b32 v40, v38, v37, s46
    v_perm_b32 v41, v38, v37, s45
    v_and_b32 v36, 0xffff0000, v32
    v_mfma_f32_16x16x32_bf16 v[236:239], a[16:19], v[76:79], v[236:239]
    s_waitcnt lgkmcnt(2)
    ds_read_b128 a[40:43], v8 offset:59392
    v_and_b32 v37, 0xffff0000, v33
    v_mfma_f32_16x16x32_bf16 v[236:239], a[20:23], v[84:87], v[236:239]
    s_movk_i32 s56, 512
    v_mul_f32 v37, v36, v37
    v_sub_f32 v38, v36, v37
    v_fma_f32 v39, 2.0, v36, -v37
    v_mfma_f32_16x16x32_bf16 v[240:243], a[24:27], v[72:75], v[240:243]
    s_addk_i32 m0, 4096
    ds_read_b128 a[44:47], v9 offset:59392
    v_add_f32 v36, v39, v36
    v_mfma_f32_16x16x32_bf16 v[240:243], a[28:31], v[80:83], v[240:243]
    buffer_load_dwordx4 v5, s[8:11], s56 offen lds
    v_mfma_f32_16x16x32_bf16 v[244:247], a[24:27], v[76:79], v[244:247]
    s_waitcnt lgkmcnt(2)
    ds_read_b128 a[48:51], v8 offset:61440
    v_cvt_pk_bf16_f32 v37, -v37, v38
    v_mfma_f32_16x16x32_bf16 v[244:247], a[28:31], v[84:87], v[244:247]
    s_add_u32 s56, s56, s62
    v_cvt_pk_bf16_f32 v38, v39, v36
    v_perm_b32 v42, v38, v37, s46
    v_perm_b32 v43, v38, v37, s45
    v_mfma_f32_16x16x32_bf16 v[248:251], a[32:35], v[56:59], 0
    s_waitcnt lgkmcnt(2)
    s_add_u32 s57, s57, s61
    ds_read_b128 a[52:55], v9 offset:61440
    v_mfma_f32_16x16x32_bf16 v[248:251], a[36:39], v[64:67], v[248:251]
    buffer_load_dwordx2 v[22:23], v3, s[12:15], s57 offen
    v_mfma_f32_16x16x32_bf16 v[248:251], a[40:43], v[72:75], v[248:251]
    s_waitcnt lgkmcnt(2)
    s_addk_i32 m0, 4096
    ds_read_b128 a[56:59], v8 offset:63488
    v_mfma_f32_16x16x32_bf16 v[248:251], a[44:47], v[80:83], v[248:251]
    buffer_load_dwordx4 v5, s[8:11], s56 offen lds
    v_mfma_f32_16x16x32_bf16 v[252:255], a[32:35], v[60:63], 0
    ds_read_b128 a[60:63], v9 offset:63488
    v_mov_b32 v48, v40
    v_mfma_f32_16x16x32_bf16 v[252:255], a[36:39], v[68:71], v[252:255]
    v_mov_b32 v49, v41
    v_mov_b32 v50, v42
    v_mov_b32 v51, v43
    v_mfma_f32_16x16x32_bf16 v[252:255], a[40:43], v[76:79], v[252:255]
    s_waitcnt vmcnt(11) lgkmcnt(2)
    ds_read_b128 a[64:67], v10 offset:0
    v_lshrrev_b64 v[16:17], 2, v[28:29]
    v_mfma_f32_16x16x32_bf16 v[252:255], a[44:47], v[84:87], v[252:255]
    s_add_u32 s56, s56, s62
    v_permlane32_swap_b32 v40, v48
    v_perm_b32 v18, v16, v28, s40
    v_mfma_f32_16x16x32_bf16 v[136:139], a[48:51], v[88:91], v[136:139]
    s_addk_i32 m0, 4096
    ds_read_b128 a[68:71], v11 offset:0
    v_perm_b32 v19, v16, v28, s41
    v_mfma_f32_16x16x32_bf16 v[136:139], a[52:55], v[96:99], v[136:139]
    buffer_load_dwordx4 v5, s[8:11], s56 offen lds
    v_mfma_f32_16x16x32_bf16 v[140:143], a[48:51], v[92:95], v[140:143]
    ds_read_b128 a[72:75], v10 offset:2048
    v_lshrrev_b64 v[20:21], 4, v[18:19]
    v_mfma_f32_16x16x32_bf16 v[140:143], a[52:55], v[100:103], v[140:143]
    s_waitcnt lgkmcnt(2)
    v_permlane32_swap_b32 v41, v49
    v_and_or_b32 v18, v18, s44, v1
    v_mfma_f32_16x16x32_bf16 v[144:147], a[56:59], v[88:91], v[144:147]
    ds_read_b128 a[76:79], v11 offset:2048
    v_and_or_b32 v19, v19, s44, v1
    v_mfma_f32_16x16x32_bf16 v[144:147], a[60:63], v[96:99], v[144:147]
    s_add_u32 s56, s56, s62
    v_permlane32_swap_b32 v42, v50
    v_and_or_b32 v20, v20, s44, v1
    v_mfma_f32_16x16x32_bf16 v[148:151], a[56:59], v[92:95], v[148:151]
    s_addk_i32 m0, 4096
    ds_read_b128 a[80:83], v10 offset:4096
    v_and_or_b32 v21, v21, s44, v1
    v_mfma_f32_16x16x32_bf16 v[148:151], a[60:63], v[100:103], v[148:151]
    buffer_load_dwordx4 v5, s[8:11], s56 offen lds
    v_mfma_f32_16x16x32_bf16 v[152:155], a[64:67], v[88:91], v[152:155]
    s_waitcnt lgkmcnt(2)
    ds_read_b128 a[84:87], v11 offset:4096
    v_perm_b32 v104, v124, v125, v18
    v_mfma_f32_16x16x32_bf16 v[152:155], a[68:71], v[96:99], v[152:155]
    s_waitcnt lgkmcnt(2)
    v_permlane32_swap_b32 v43, v51
    v_mov_b32 v44, v40
    v_mfma_f32_16x16x32_bf16 v[156:159], a[64:67], v[92:95], v[156:159]
    s_addk_i32 s59, 28672
    ds_read_b128 a[88:91], v10 offset:6144
    v_mov_b32 v45, v41
    v_mfma_f32_16x16x32_bf16 v[156:159], a[68:71], v[100:103], v[156:159]
    buffer_load_dword v30, v15, s[16:19], s59 offen
    v_mfma_f32_16x16x32_bf16 v[160:163], a[72:75], v[88:91], v[160:163]
    s_add_u32 s56, s56, s62
    ds_read_b128 a[92:95], v11 offset:6144
    v_mov_b32 v46, v42
    v_mfma_f32_16x16x32_bf16 v[160:163], a[76:79], v[96:99], v[160:163]
    buffer_load_dword v31, v15, s[20:23], s59 offen
    v_mfma_f32_16x16x32_bf16 v[164:167], a[72:75], v[92:95], v[164:167]
    s_waitcnt lgkmcnt(2)
    s_addk_i32 m0, 4096
    ds_read_b128 a[0:3], v10 offset:8192
    v_mfma_f32_16x16x32_bf16 v[164:167], a[76:79], v[100:103], v[164:167]
    buffer_load_dwordx4 v5, s[8:11], s56 offen lds
    v_mfma_f32_16x16x32_bf16 v[168:171], a[80:83], v[88:91], v[168:171]
    s_waitcnt lgkmcnt(2)
    ds_read_b128 a[4:7], v11 offset:8192
    v_mov_b32 v47, v43
    v_mfma_f32_16x16x32_bf16 v[168:171], a[84:87], v[96:99], v[168:171]
    s_add_u32 s56, s56, s62
    v_permlane16_swap_b32 v40, v44
    v_perm_b32 v105, v124, v125, v20
    v_mfma_f32_16x16x32_bf16 v[172:175], a[80:83], v[92:95], v[172:175]
    s_addk_i32 m0, 4096
    ds_read_b128 a[8:11], v10 offset:10240
    v_perm_b32 v106, v124, v125, v19
    v_mfma_f32_16x16x32_bf16 v[172:175], a[84:87], v[100:103], v[172:175]
    buffer_load_dwordx4 v5, s[8:11], s56 offen lds
    v_mfma_f32_16x16x32_bf16 v[176:179], a[88:91], v[88:91], v[176:179]
    s_waitcnt lgkmcnt(2)
    ds_read_b128 a[12:15], v11 offset:10240
    v_perm_b32 v107, v124, v125, v21
    v_mfma_f32_16x16x32_bf16 v[176:179], a[92:95], v[96:99], v[176:179]
    v_permlane16_swap_b32 v41, v45
    v_perm_b32 v18, v16, v28, s42
    v_mfma_f32_16x16x32_bf16 v[180:183], a[88:91], v[92:95], v[180:183]
    s_waitcnt lgkmcnt(2)
    ds_read_b128 a[16:19], v10 offset:12288
    v_perm_b32 v19, v16, v28, s43
    v_mfma_f32_16x16x32_bf16 v[180:183], a[92:95], v[100:103], v[180:183]
    s_add_u32 s56, s56, s62
    v_permlane16_swap_b32 v42, v46
    v_lshrrev_b64 v[20:21], 4, v[18:19]
    v_mfma_f32_16x16x32_bf16 v[184:187], a[0:3], v[88:91], v[184:187]
    s_addk_i32 m0, 4096
    ds_read_b128 a[20:23], v11 offset:12288
    v_and_or_b32 v18, v18, s44, v1
    v_mfma_f32_16x16x32_bf16 v[184:187], a[4:7], v[96:99], v[184:187]
    buffer_load_dwordx4 v5, s[8:11], s56 offen lds
    v_mfma_f32_16x16x32_bf16 v[188:191], a[0:3], v[92:95], v[188:191]
    ds_read_b128 a[24:27], v10 offset:14336
    v_and_or_b32 v19, v19, s44, v1
    v_mfma_f32_16x16x32_bf16 v[188:191], a[4:7], v[100:103], v[188:191]
    s_waitcnt lgkmcnt(2)
    v_permlane16_swap_b32 v43, v47
    v_mov_b32 v52, v48
    v_mfma_f32_16x16x32_bf16 v[192:195], a[8:11], v[88:91], v[192:195]
    ds_read_b128 a[28:31], v11 offset:14336
    v_mov_b32 v53, v49
    v_mfma_f32_16x16x32_bf16 v[192:195], a[12:15], v[96:99], v[192:195]
    s_add_u32 s56, s56, s62
    v_mov_b32 v54, v50
    v_mov_b32 v55, v51
    v_and_or_b32 v20, v20, s44, v1
    v_mfma_f32_16x16x32_bf16 v[196:199], a[8:11], v[92:95], v[196:199]
    s_add_u32 s57, s57, s61
    ds_read_b128 a[32:35], v10 offset:16384
    v_permlane16_swap_b32 v48, v52
    v_permlane16_swap_b32 v49, v53
    v_permlane16_swap_b32 v50, v54
    v_permlane16_swap_b32 v51, v55
    v_mfma_f32_16x16x32_bf16 v[196:199], a[12:15], v[100:103], v[196:199]
    buffer_load_dwordx2 v[24:25], v3, s[12:15], s57 offen
    v_mfma_f32_16x16x32_bf16 v[200:203], a[16:19], v[88:91], v[200:203]
    s_waitcnt lgkmcnt(2)
    s_addk_i32 m0, 4096
    ds_read_b128 a[36:39], v11 offset:16384
    v_mfma_f32_16x16x32_bf16 v[200:203], a[20:23], v[96:99], v[200:203]
    buffer_load_dwordx4 v6, s[8:11], s56 offen lds
    v_mfma_f32_16x16x32_bf16 v[204:207], a[16:19], v[92:95], v[204:207]
    ds_read_b128 a[40:43], v10 offset:18432
    v_and_or_b32 v21, v21, s44, v1
    v_mfma_f32_16x16x32_bf16 v[204:207], a[20:23], v[100:103], v[204:207]
    s_movk_i32 s56, 640
    v_perm_b32 v112, v124, v125, v18
    v_perm_b32 v113, v124, v125, v20
    v_perm_b32 v114, v124, v125, v19
    v_mfma_f32_16x16x32_bf16 v[208:211], a[24:27], v[88:91], v[208:211]
    s_waitcnt vmcnt(11) lgkmcnt(2)
    ds_read_b128 a[44:47], v11 offset:18432
    v_perm_b32 v115, v124, v125, v21
    v_mfma_f32_16x16x32_bf16 v[208:211], a[28:31], v[96:99], v[208:211]
    s_barrier
    v_mfma_f32_16x16x32_bf16 v[212:215], a[24:27], v[92:95], v[212:215]
    s_add_u32 m0, s47, 0
    ds_read_b128 a[48:51], v10 offset:20480
    v_mfma_f32_16x16x32_bf16 v[212:215], a[28:31], v[100:103], v[212:215]
    buffer_load_dwordx4 v5, s[8:11], s56 offen lds
    v_mfma_f32_16x16x32_bf16 v[216:219], a[32:35], v[88:91], v[216:219]
    s_waitcnt lgkmcnt(2)
    ds_read_b128 a[52:55], v11 offset:20480
    v_perm_b32 v18, v17, v29, s40
    v_mfma_f32_16x16x32_bf16 v[216:219], a[36:39], v[96:99], v[216:219]
    s_add_u32 s56, s56, s62
    v_perm_b32 v19, v17, v29, s41
    v_lshrrev_b64 v[20:21], 4, v[18:19]
    v_and_or_b32 v18, v18, s44, v1
    v_mfma_f32_16x16x32_bf16 v[220:223], a[32:35], v[92:95], v[220:223]
    s_addk_i32 m0, 4096
    ds_read_b128 a[56:59], v10 offset:22528
    v_and_or_b32 v19, v19, s44, v1
    v_mfma_f32_16x16x32_bf16 v[220:223], a[36:39], v[100:103], v[220:223]
    buffer_load_dwordx4 v5, s[8:11], s56 offen lds
    v_mfma_f32_16x16x32_bf16 v[224:227], a[40:43], v[88:91], v[224:227]
    s_waitcnt lgkmcnt(2)
    ds_read_b128 a[60:63], v11 offset:22528
    v_and_or_b32 v20, v20, s44, v1
    v_mfma_f32_16x16x32_bf16 v[224:227], a[44:47], v[96:99], v[224:227]
    v_and_or_b32 v21, v21, s44, v1
    v_perm_b32 v108, v126, v127, v18
    v_perm_b32 v109, v126, v127, v20
    v_mfma_f32_16x16x32_bf16 v[228:231], a[40:43], v[92:95], v[228:231]
    s_waitcnt lgkmcnt(2)
    ds_read_b128 a[64:67], v10 offset:24576
    v_perm_b32 v110, v126, v127, v19
    v_mfma_f32_16x16x32_bf16 v[228:231], a[44:47], v[100:103], v[228:231]
    s_add_u32 s56, s56, s62
    v_perm_b32 v111, v126, v127, v21
    v_perm_b32 v18, v17, v29, s42
    v_perm_b32 v19, v17, v29, s43
    v_mfma_f32_16x16x32_bf16 v[232:235], a[48:51], v[88:91], v[232:235]
    s_addk_i32 m0, 4096
    ds_read_b128 a[68:71], v11 offset:24576
    v_lshrrev_b64 v[20:21], 4, v[18:19]
    v_mfma_f32_16x16x32_bf16 v[232:235], a[52:55], v[96:99], v[232:235]
    buffer_load_dwordx4 v5, s[8:11], s56 offen lds
    v_mfma_f32_16x16x32_bf16 v[236:239], a[48:51], v[92:95], v[236:239]
    ds_read_b128 a[72:75], v10 offset:28672
    v_and_or_b32 v18, v18, s44, v1
    v_mfma_f32_16x16x32_bf16 v[236:239], a[52:55], v[100:103], v[236:239]
    s_waitcnt lgkmcnt(2)
    v_and_or_b32 v19, v19, s44, v1
    v_and_or_b32 v20, v20, s44, v1
    v_and_or_b32 v21, v21, s44, v1
    v_mfma_f32_16x16x32_bf16 v[240:243], a[56:59], v[88:91], v[240:243]
    s_waitcnt vmcnt(13)
    ds_read_b128 a[76:79], v11 offset:28672
    v_perm_b32 v116, v126, v127, v18
    v_mfma_f32_16x16x32_bf16 v[240:243], a[60:63], v[96:99], v[240:243]
    s_add_u32 s56, s56, s62
    v_perm_b32 v117, v126, v127, v20
    v_perm_b32 v118, v126, v127, v19
    v_perm_b32 v119, v126, v127, v21
    v_mfma_f32_16x16x32_bf16 v[244:247], a[56:59], v[92:95], v[244:247]
    s_addk_i32 m0, 4096
    ds_read_b128 a[80:83], v10 offset:30720
    v_lshrrev_b64 v[16:17], 2, v[22:23]
    v_mfma_f32_16x16x32_bf16 v[244:247], a[60:63], v[100:103], v[244:247]
    buffer_load_dwordx4 v5, s[8:11], s56 offen lds
    v_mfma_f32_16x16x32_bf16 v[248:251], a[64:67], v[88:91], v[248:251]
    s_waitcnt lgkmcnt(2)
    ds_read_b128 a[84:87], v11 offset:30720
    v_perm_b32 v18, v16, v22, s40
    v_mfma_f32_16x16x32_bf16 v[248:251], a[68:71], v[96:99], v[248:251]
    v_perm_b32 v19, v16, v22, s41
    v_lshrrev_b64 v[20:21], 4, v[18:19]
    v_and_or_b32 v18, v18, s44, v1
    v_mfma_f32_16x16x32_bf16 v[252:255], a[64:67], v[92:95], v[252:255]
    s_waitcnt lgkmcnt(2)
    ds_read_b128 a[88:91], v10 offset:32768
    v_and_or_b32 v19, v19, s44, v1
    v_mfma_f32_16x16x32_bf16 v[252:255], a[68:71], v[100:103], v[252:255]
    s_add_u32 s56, s56, s62
    v_and_or_b32 v20, v20, s44, v1
    v_and_or_b32 v21, v21, s44, v1
    v_perm_b32 v120, v40, v41, v18
    v_mfma_f32_16x16x32_bf16 v[136:139], a[72:75], v[104:107], v[136:139]
    s_addk_i32 m0, 4096
    ds_read_b128 a[92:95], v11 offset:32768
    v_perm_b32 v121, v40, v41, v20
    v_mfma_f32_16x16x32_bf16 v[136:139], a[76:79], v[112:115], v[136:139]
    buffer_load_dwordx4 v5, s[8:11], s56 offen lds
    v_mfma_f32_16x16x32_bf16 v[140:143], a[72:75], v[108:111], v[140:143]
    ds_read_b128 a[0:3], v10 offset:34816
    v_perm_b32 v122, v40, v41, v19
    v_mfma_f32_16x16x32_bf16 v[140:143], a[76:79], v[116:119], v[140:143]
    s_waitcnt lgkmcnt(2)
    v_perm_b32 v123, v40, v41, v21
    v_perm_b32 v18, v16, v22, s42
    v_perm_b32 v19, v16, v22, s43
    v_mfma_f32_16x16x32_bf16 v[144:147], a[80:83], v[104:107], v[144:147]
    ds_read_b128 a[4:7], v11 offset:34816
    ds_read_b128 a[8:11], v10 offset:36864
    v_mfma_f32_16x16x32_bf16 v[144:147], a[84:87], v[112:115], v[144:147]
    s_add_u32 s56, s56, s62
    v_lshrrev_b64 v[20:21], 4, v[18:19]
    v_and_or_b32 v18, v18, s44, v1
    v_and_or_b32 v19, v19, s44, v1
    v_mfma_f32_16x16x32_bf16 v[148:151], a[80:83], v[108:111], v[148:151]
    s_addk_i32 m0, 4096
    ds_read_b128 a[12:15], v11 offset:36864
    v_and_or_b32 v20, v20, s44, v1
    v_mfma_f32_16x16x32_bf16 v[148:151], a[84:87], v[116:119], v[148:151]
    buffer_load_dwordx4 v5, s[8:11], s56 offen lds
    v_mfma_f32_16x16x32_bf16 v[152:155], a[88:91], v[104:107], v[152:155]
    s_waitcnt lgkmcnt(3)
    ds_read_b128 a[16:19], v10 offset:38912
    v_and_or_b32 v21, v21, s44, v1
    v_mfma_f32_16x16x32_bf16 v[152:155], a[92:95], v[112:115], v[152:155]
    s_waitcnt lgkmcnt(2)
    v_perm_b32 v128, v40, v41, v18
    v_perm_b32 v129, v40, v41, v20
    v_perm_b32 v130, v40, v41, v19
    v_mfma_f32_16x16x32_bf16 v[156:159], a[88:91], v[108:111], v[156:159]
    s_addk_i32 s59, 28672
    ds_read_b128 a[20:23], v11 offset:38912
    v_perm_b32 v131, v40, v41, v21
    v_mfma_f32_16x16x32_bf16 v[156:159], a[92:95], v[116:119], v[156:159]
    buffer_load_dword v32, v15, s[16:19], s59 offen
    v_mfma_f32_16x16x32_bf16 v[160:163], a[0:3], v[104:107], v[160:163]
    s_add_u32 s56, s56, s62
    ds_read_b128 a[24:27], v10 offset:40960
    v_perm_b32 v18, v17, v23, s40
    v_mfma_f32_16x16x32_bf16 v[160:163], a[4:7], v[112:115], v[160:163]
    buffer_load_dword v33, v15, s[20:23], s59 offen
    v_mfma_f32_16x16x32_bf16 v[164:167], a[0:3], v[108:111], v[164:167]
    s_addk_i32 m0, 4096
    ds_read_b128 a[28:31], v11 offset:40960
    v_perm_b32 v19, v17, v23, s41
    v_mfma_f32_16x16x32_bf16 v[164:167], a[4:7], v[116:119], v[164:167]
    buffer_load_dwordx4 v5, s[8:11], s56 offen lds
    v_mfma_f32_16x16x32_bf16 v[168:171], a[8:11], v[104:107], v[168:171]
    s_waitcnt lgkmcnt(2)
    ds_read_b128 a[32:35], v10 offset:43008
    v_lshrrev_b64 v[20:21], 4, v[18:19]
    v_mfma_f32_16x16x32_bf16 v[168:171], a[12:15], v[112:115], v[168:171]
    s_movk_i32 s56, 768
    v_and_or_b32 v18, v18, s44, v1
    v_and_or_b32 v19, v19, s44, v1
    v_and_or_b32 v20, v20, s44, v1
    v_mfma_f32_16x16x32_bf16 v[172:175], a[8:11], v[108:111], v[172:175]
    s_addk_i32 m0, 4096
    ds_read_b128 a[36:39], v11 offset:43008
    ds_read_b128 a[40:43], v10 offset:45056
    v_mfma_f32_16x16x32_bf16 v[172:175], a[12:15], v[116:119], v[172:175]
    buffer_load_dwordx4 v5, s[8:11], s56 offen lds
    v_mfma_f32_16x16x32_bf16 v[176:179], a[16:19], v[104:107], v[176:179]
    ds_read_b128 a[44:47], v11 offset:45056
    v_and_or_b32 v21, v21, s44, v1
    v_mfma_f32_16x16x32_bf16 v[176:179], a[20:23], v[112:115], v[176:179]
    v_perm_b32 v124, v42, v43, v18
    v_perm_b32 v125, v42, v43, v20
    v_mfma_f32_16x16x32_bf16 v[180:183], a[16:19], v[108:111], v[180:183]
    s_waitcnt lgkmcnt(3)
    ds_read_b128 a[48:51], v10 offset:47104
    v_perm_b32 v126, v42, v43, v19
    v_mfma_f32_16x16x32_bf16 v[180:183], a[20:23], v[116:119], v[180:183]
    s_add_u32 s56, s56, s62
    v_perm_b32 v127, v42, v43, v21
    v_perm_b32 v18, v17, v23, s42
    v_mfma_f32_16x16x32_bf16 v[184:187], a[24:27], v[104:107], v[184:187]
    s_addk_i32 m0, 4096
    ds_read_b128 a[52:55], v11 offset:47104
    v_perm_b32 v19, v17, v23, s43
    v_mfma_f32_16x16x32_bf16 v[184:187], a[28:31], v[112:115], v[184:187]
    buffer_load_dwordx4 v5, s[8:11], s56 offen lds
    v_mfma_f32_16x16x32_bf16 v[188:191], a[24:27], v[108:111], v[188:191]
    ds_read_b128 a[56:59], v10 offset:49152
    v_lshrrev_b64 v[20:21], 4, v[18:19]
    v_mfma_f32_16x16x32_bf16 v[188:191], a[28:31], v[116:119], v[188:191]
    v_and_or_b32 v18, v18, s44, v1
    v_and_or_b32 v19, v19, s44, v1
    v_mfma_f32_16x16x32_bf16 v[192:195], a[32:35], v[104:107], v[192:195]
    s_waitcnt lgkmcnt(2)
    ds_read_b128 a[60:63], v11 offset:49152
    v_and_or_b32 v20, v20, s44, v1
    v_mfma_f32_16x16x32_bf16 v[192:195], a[36:39], v[112:115], v[192:195]
    s_add_u32 s56, s56, s62
    v_and_or_b32 v21, v21, s44, v1
    v_perm_b32 v132, v42, v43, v18
    v_mfma_f32_16x16x32_bf16 v[196:199], a[32:35], v[108:111], v[196:199]
    s_addk_i32 m0, 4096
    ds_read_b128 a[64:67], v10 offset:51200
    v_perm_b32 v133, v42, v43, v20
    v_mfma_f32_16x16x32_bf16 v[196:199], a[36:39], v[116:119], v[196:199]
    buffer_load_dwordx4 v5, s[8:11], s56 offen lds
    v_mfma_f32_16x16x32_bf16 v[200:203], a[40:43], v[104:107], v[200:203]
    s_waitcnt vmcnt(13) lgkmcnt(2)
    ds_read_b128 a[68:71], v11 offset:51200
    ds_read_b128 a[72:75], v10 offset:53248
    v_perm_b32 v134, v42, v43, v19
    v_perm_b32 v135, v42, v43, v21
    v_mfma_f32_16x16x32_bf16 v[200:203], a[44:47], v[112:115], v[200:203]
    s_add_u32 s56, s56, s62
    v_lshrrev_b64 v[16:17], 2, v[24:25]
    v_perm_b32 v18, v16, v24, s40
    v_mfma_f32_16x16x32_bf16 v[204:207], a[40:43], v[108:111], v[204:207]
    s_add_u32 s57, s57, s61
    ds_read_b128 a[76:79], v11 offset:53248
    v_perm_b32 v19, v16, v24, s41
    v_mfma_f32_16x16x32_bf16 v[204:207], a[44:47], v[116:119], v[204:207]
    buffer_load_dwordx2 v[26:27], v3, s[12:15], s57 offen
    v_mfma_f32_16x16x32_bf16 v[208:211], a[48:51], v[104:107], v[208:211]
    s_addk_i32 m0, 4096
    ds_read_b128 a[80:83], v10 offset:55296
    v_lshrrev_b64 v[20:21], 4, v[18:19]
    v_mfma_f32_16x16x32_bf16 v[208:211], a[52:55], v[112:115], v[208:211]
    buffer_load_dwordx4 v5, s[8:11], s56 offen lds
    v_mfma_f32_16x16x32_bf16 v[212:215], a[48:51], v[108:111], v[212:215]
    ds_read_b128 a[84:87], v11 offset:55296
    v_and_or_b32 v18, v18, s44, v1
    v_mfma_f32_16x16x32_bf16 v[212:215], a[52:55], v[116:119], v[212:215]
    v_and_or_b32 v19, v19, s44, v1
    v_and_or_b32 v20, v20, s44, v1
    v_mfma_f32_16x16x32_bf16 v[216:219], a[56:59], v[104:107], v[216:219]
    s_waitcnt lgkmcnt(2)
    ds_read_b128 a[88:91], v10 offset:26624
    v_and_or_b32 v21, v21, s44, v1
    v_mfma_f32_16x16x32_bf16 v[216:219], a[60:63], v[112:115], v[216:219]
    s_add_u32 s56, s56, s62
    v_perm_b32 v56, v44, v45, v18
    v_perm_b32 v57, v44, v45, v20
    v_mfma_f32_16x16x32_bf16 v[220:223], a[56:59], v[108:111], v[220:223]
    s_addk_i32 m0, 4096
    ds_read_b128 a[92:95], v11 offset:26624
    v_perm_b32 v58, v44, v45, v19
    v_mfma_f32_16x16x32_bf16 v[220:223], a[60:63], v[116:119], v[220:223]
    buffer_load_dwordx4 v5, s[8:11], s56 offen lds
    v_mfma_f32_16x16x32_bf16 v[224:227], a[64:67], v[104:107], v[224:227]
    ds_read_b128 a[0:3], v10 offset:57344
    v_perm_b32 v59, v44, v45, v21
    v_mfma_f32_16x16x32_bf16 v[224:227], a[68:71], v[112:115], v[224:227]
    v_perm_b32 v18, v16, v24, s42
    v_perm_b32 v19, v16, v24, s43
    v_mfma_f32_16x16x32_bf16 v[228:231], a[64:67], v[108:111], v[228:231]
    ds_read_b128 a[4:7], v11 offset:57344
    ds_read_b128 a[8:11], v10 offset:59392
    v_mfma_f32_16x16x32_bf16 v[228:231], a[68:71], v[116:119], v[228:231]
    s_add_u32 s56, s56, s62
    v_lshrrev_b64 v[20:21], 4, v[18:19]
    v_and_or_b32 v18, v18, s44, v1
    v_mfma_f32_16x16x32_bf16 v[232:235], a[72:75], v[104:107], v[232:235]
    s_waitcnt vmcnt(10) lgkmcnt(3)
    ds_read_b128 a[12:15], v11 offset:59392
    v_and_or_b32 v19, v19, s44, v1
    v_mfma_f32_16x16x32_bf16 v[232:235], a[76:79], v[112:115], v[232:235]
    s_barrier
    v_mfma_f32_16x16x32_bf16 v[236:239], a[72:75], v[108:111], v[236:239]
    s_addk_i32 m0, 4096
    ds_read_b128 a[16:19], v10 offset:61440
    v_mfma_f32_16x16x32_bf16 v[236:239], a[76:79], v[116:119], v[236:239]
    buffer_load_dwordx4 v5, s[8:11], s56 offen lds
    v_mfma_f32_16x16x32_bf16 v[240:243], a[80:83], v[104:107], v[240:243]
    ds_read_b128 a[20:23], v11 offset:61440
    v_and_or_b32 v20, v20, s44, v1
    v_mfma_f32_16x16x32_bf16 v[240:243], a[84:87], v[112:115], v[240:243]
    s_add_u32 s56, s56, s62
    v_and_or_b32 v21, v21, s44, v1
    v_perm_b32 v64, v44, v45, v18
    v_mfma_f32_16x16x32_bf16 v[244:247], a[80:83], v[108:111], v[244:247]
    s_addk_i32 m0, 4096
    ds_read_b128 a[24:27], v10 offset:63488
    v_perm_b32 v65, v44, v45, v20
    v_mfma_f32_16x16x32_bf16 v[244:247], a[84:87], v[116:119], v[244:247]
    buffer_load_dwordx4 v5, s[8:11], s56 offen lds
    v_mfma_f32_16x16x32_bf16 v[248:251], a[88:91], v[104:107], v[248:251]
    ds_read_b128 a[28:31], v11 offset:63488
    v_perm_b32 v66, v44, v45, v19
    v_mfma_f32_16x16x32_bf16 v[248:251], a[92:95], v[112:115], v[248:251]
    v_perm_b32 v67, v44, v45, v21
    v_perm_b32 v18, v17, v25, s40
    v_mfma_f32_16x16x32_bf16 v[252:255], a[88:91], v[108:111], v[252:255]
    s_waitcnt lgkmcnt(2)
    ds_read_b128 a[32:35], v12 offset:0
    v_perm_b32 v19, v17, v25, s41
    v_mfma_f32_16x16x32_bf16 v[252:255], a[92:95], v[116:119], v[252:255]
    s_add_u32 s56, s56, s62
    v_lshrrev_b64 v[20:21], 4, v[18:19]
    v_and_or_b32 v18, v18, s44, v1
    v_mfma_f32_16x16x32_bf16 v[136:139], a[0:3], v[120:123], v[136:139]
    s_addk_i32 m0, 4096
    ds_read_b128 a[36:39], v13 offset:0
    v_and_or_b32 v19, v19, s44, v1
    v_mfma_f32_16x16x32_bf16 v[136:139], a[4:7], v[128:131], v[136:139]
    buffer_load_dwordx4 v6, s[8:11], s56 offen lds
    v_mfma_f32_16x16x32_bf16 v[140:143], a[0:3], v[124:127], v[140:143]
    ds_read_b128 a[40:43], v12 offset:2048
    v_and_or_b32 v20, v20, s44, v1
    v_mfma_f32_16x16x32_bf16 v[140:143], a[4:7], v[132:135], v[140:143]
    v_and_or_b32 v21, v21, s44, v1
    v_perm_b32 v60, v46, v47, v18
    v_mfma_f32_16x16x32_bf16 v[144:147], a[8:11], v[120:123], v[144:147]
    ds_read_b128 a[44:47], v13 offset:2048
    v_perm_b32 v61, v46, v47, v20
    v_mfma_f32_16x16x32_bf16 v[144:147], a[12:15], v[128:131], v[144:147]
    s_movk_i32 s56, 896
    v_perm_b32 v62, v46, v47, v19
    v_perm_b32 v63, v46, v47, v21
    v_mfma_f32_16x16x32_bf16 v[148:151], a[8:11], v[124:127], v[148:151]
    s_addk_i32 m0, 4096
    ds_read_b128 a[48:51], v12 offset:4096
    v_perm_b32 v18, v17, v25, s42
    v_mfma_f32_16x16x32_bf16 v[148:151], a[12:15], v[132:135], v[148:151]
    buffer_load_dwordx4 v5, s[8:11], s56 offen lds
    v_mfma_f32_16x16x32_bf16 v[152:155], a[16:19], v[120:123], v[152:155]
    ds_read_b128 a[52:55], v13 offset:4096
    v_perm_b32 v19, v17, v25, s43
    v_mfma_f32_16x16x32_bf16 v[152:155], a[20:23], v[128:131], v[152:155]
    v_lshrrev_b64 v[20:21], 4, v[18:19]
    v_and_or_b32 v18, v18, s44, v1
    v_mfma_f32_16x16x32_bf16 v[156:159], a[16:19], v[124:127], v[156:159]
    s_waitcnt lgkmcnt(2)
    ds_read_b128 a[56:59], v12 offset:6144
    v_and_or_b32 v19, v19, s44, v1
    v_mfma_f32_16x16x32_bf16 v[156:159], a[20:23], v[132:135], v[156:159]
    s_add_u32 s56, s56, s62
    v_and_or_b32 v20, v20, s44, v1
    v_and_or_b32 v21, v21, s44, v1
    v_mfma_f32_16x16x32_bf16 v[160:163], a[24:27], v[120:123], v[160:163]
    s_addk_i32 m0, 4096
    ds_read_b128 a[60:63], v13 offset:6144
    v_perm_b32 v68, v46, v47, v18
    v_mfma_f32_16x16x32_bf16 v[160:163], a[28:31], v[128:131], v[160:163]
    buffer_load_dwordx4 v5, s[8:11], s56 offen lds
    v_mfma_f32_16x16x32_bf16 v[164:167], a[24:27], v[124:127], v[164:167]
    ds_read_b128 a[64:67], v12 offset:8192
    v_perm_b32 v69, v46, v47, v20
    v_mfma_f32_16x16x32_bf16 v[164:167], a[28:31], v[132:135], v[164:167]
    v_perm_b32 v70, v46, v47, v19
    v_perm_b32 v71, v46, v47, v21
    v_mfma_f32_16x16x32_bf16 v[168:171], a[32:35], v[120:123], v[168:171]
    ds_read_b128 a[68:71], v13 offset:8192
    v_lshlrev_b32 v36, 16, v30
    v_mfma_f32_16x16x32_bf16 v[168:171], a[36:39], v[128:131], v[168:171]
    s_add_u32 s56, s56, s62
    v_lshlrev_b32 v37, 16, v31
    v_mul_f32 v37, v36, v37
    v_mfma_f32_16x16x32_bf16 v[172:175], a[32:35], v[124:127], v[172:175]
    s_addk_i32 m0, 4096
    ds_read_b128 a[72:75], v12 offset:10240
    v_sub_f32 v38, v36, v37
    v_mfma_f32_16x16x32_bf16 v[172:175], a[36:39], v[132:135], v[172:175]
    buffer_load_dwordx4 v5, s[8:11], s56 offen lds
    v_mfma_f32_16x16x32_bf16 v[176:179], a[40:43], v[120:123], v[176:179]
    s_waitcnt lgkmcnt(2)
    ds_read_b128 a[76:79], v13 offset:10240
    v_fma_f32 v39, 2.0, v36, -v37
    v_mfma_f32_16x16x32_bf16 v[176:179], a[44:47], v[128:131], v[176:179]
    s_add_u32 s56, s56, s62
    v_add_f32 v36, v39, v36
    v_cvt_pk_bf16_f32 v37, -v37, v38
    v_mfma_f32_16x16x32_bf16 v[180:183], a[40:43], v[124:127], v[180:183]
    s_add_u32 s57, s57, s61
    ds_read_b128 a[80:83], v12 offset:12288
    v_cvt_pk_bf16_f32 v38, v39, v36
    v_mfma_f32_16x16x32_bf16 v[180:183], a[44:47], v[132:135], v[180:183]
    buffer_load_dwordx2 v[28:29], v3, s[12:15], s57 offen
    v_mfma_f32_16x16x32_bf16 v[184:187], a[48:51], v[120:123], v[184:187]
    s_addk_i32 m0, 4096
    ds_read_b128 a[84:87], v13 offset:12288
    v_perm_b32 v40, v38, v37, s46
    v_mfma_f32_16x16x32_bf16 v[184:187], a[52:55], v[128:131], v[184:187]
    buffer_load_dwordx4 v5, s[8:11], s56 offen lds
    v_mfma_f32_16x16x32_bf16 v[188:191], a[48:51], v[124:127], v[188:191]
L_hopA2:
    s_cbranch_execz L_hopret
    ds_read_b128 a[88:91], v12 offset:14336
    v_perm_b32 v41, v38, v37, s45
    v_mfma_f32_16x16x32_bf16 v[188:191], a[52:55], v[132:135], v[188:191]
    v_and_b32 v36, 0xffff0000, v30
    v_and_b32 v37, 0xffff0000, v31
    v_mfma_f32_16x16x32_bf16 v[192:195], a[56:59], v[120:123], v[192:195]
    ds_read_b128 a[92:95], v13 offset:14336
    v_mul_f32 v37, v36, v37
    v_mfma_f32_16x16x32_bf16 v[192:195], a[60:63], v[128:131], v[192:195]
    s_add_u32 s56, s56, s62
    v_sub_f32 v38, v36, v37
    v_fma_f32 v39, 2.0, v36, -v37
    v_mfma_f32_16x16x32_bf16 v[196:199], a[56:59], v[124:127], v[196:199]
    s_addk_i32 m0, 4096
    ds_read_b128 a[0:3], v12 offset:16384
    v_add_f32 v36, v39, v36
    v_mfma_f32_16x16x32_bf16 v[196:199], a[60:63], v[132:135], v[196:199]
    buffer_load_dwordx4 v5, s[8:11], s56 offen lds
    v_mfma_f32_16x16x32_bf16 v[200:203], a[64:67], v[120:123], v[200:203]
    s_waitcnt lgkmcnt(2)
    ds_read_b128 a[4:7], v13 offset:16384
    v_cvt_pk_bf16_f32 v37, -v37, v38
    v_mfma_f32_16x16x32_bf16 v[200:203], a[68:71], v[128:131], v[200:203]
    v_cvt_pk_bf16_f32 v38, v39, v36
    v_perm_b32 v42, v38, v37, s46
    v_mfma_f32_16x16x32_bf16 v[204:207], a[64:67], v[124:127], v[204:207]
    s_waitcnt vmcnt(11) lgkmcnt(2)
    ds_read_b128 a[8:11], v12 offset:18432
    v_perm_b32 v43, v38, v37, s45
    v_mfma_f32_16x16x32_bf16 v[204:207], a[68:71], v[132:135], v[204:207]
    s_add_u32 s56, s56, s62
    v_lshrrev_b64 v[16:17], 2, v[26:27]
    v_perm_b32 v18, v16, v26, s40
    v_mfma_f32_16x16x32_bf16 v[208:211], a[72:75], v[120:123], v[208:211]
    s_addk_i32 m0, 4096
    ds_read_b128 a[12:15], v13 offset:18432
    v_perm_b32 v19, v16, v26, s41
    v_mfma_f32_16x16x32_bf16 v[208:211], a[76:79], v[128:131], v[208:211]
    buffer_load_dwordx4 v5, s[8:11], s56 offen lds
    v_mfma_f32_16x16x32_bf16 v[212:215], a[72:75], v[124:127], v[212:215]
    ds_read_b128 a[16:19], v12 offset:20480
    v_lshlrev_b32 v36, 16, v32
    v_mfma_f32_16x16x32_bf16 v[212:215], a[76:79], v[132:135], v[212:215]
    v_lshlrev_b32 v37, 16, v33
    v_mul_f32 v37, v36, v37
    v_mfma_f32_16x16x32_bf16 v[216:219], a[80:83], v[120:123], v[216:219]
    ds_read_b128 a[20:23], v13 offset:20480
    v_sub_f32 v38, v36, v37
    v_mfma_f32_16x16x32_bf16 v[216:219], a[84:87], v[128:131], v[216:219]
    s_add_u32 s56, s56, s62
    v_fma_f32 v39, 2.0, v36, -v37
    v_add_f32 v36, v39, v36
    v_mfma_f32_16x16x32_bf16 v[220:223], a[80:83], v[124:127], v[220:223]
    s_addk_i32 m0, 4096
    ds_read_b128 a[24:27], v8 offset:0
    v_cvt_pk_bf16_f32 v37, -v37, v38
    v_mfma_f32_16x16x32_bf16 v[220:223], a[84:87], v[132:135], v[220:223]
    buffer_load_dwordx4 v5, s[8:11], s56 offen lds
    v_mfma_f32_16x16x32_bf16 v[224:227], a[88:91], v[120:123], v[224:227]
    ds_read_b128 a[28:31], v9 offset:0
    v_cvt_pk_bf16_f32 v38, v39, v36
    v_mfma_f32_16x16x32_bf16 v[224:227], a[92:95], v[128:131], v[224:227]
    s_waitcnt lgkmcnt(2)
    v_perm_b32 v44, v38, v37, s46
    v_perm_b32 v45, v38, v37, s45
    v_mfma_f32_16x16x32_bf16 v[228:231], a[88:91], v[124:127], v[228:231]
    s_add_u32 s57, s57, s61
    ds_read_b128 a[32:35], v8 offset:2048
    v_and_b32 v36, 0xffff0000, v32
    v_mfma_f32_16x16x32_bf16 v[228:231], a[92:95], v[132:135], v[228:231]
    buffer_load_dwordx2 v[22:23], v3, s[12:15], s57 offen
    v_mfma_f32_16x16x32_bf16 v[232:235], a[0:3], v[120:123], v[232:235]
    ds_read_b128 a[36:39], v9 offset:2048
    v_and_b32 v37, 0xffff0000, v33
    v_mfma_f32_16x16x32_bf16 v[232:235], a[4:7], v[128:131], v[232:235]
    v_mul_f32 v37, v36, v37
    v_sub_f32 v38, v36, v37
    v_mfma_f32_16x16x32_bf16 v[236:239], a[0:3], v[124:127], v[236:239]
    ds_read_b128 a[40:43], v8 offset:4096
    v_fma_f32 v39, 2.0, v36, -v37
    v_mfma_f32_16x16x32_bf16 v[236:239], a[4:7], v[132:135], v[236:239]
    v_add_f32 v36, v39, v36
    v_cvt_pk_bf16_f32 v37, -v37, v38
    v_mfma_f32_16x16x32_bf16 v[240:243], a[8:11], v[120:123], v[240:243]
    ds_read_b128 a[44:47], v9 offset:4096
    v_cvt_pk_bf16_f32 v38, v39, v36
    v_mfma_f32_16x16x32_bf16 v[240:243], a[12:15], v[128:131], v[240:243]
    v_perm_b32 v46, v38, v37, s46
    v_perm_b32 v47, v38, v37, s45
    v_mfma_f32_16x16x32_bf16 v[244:247], a[8:11], v[124:127], v[244:247]
    ds_read_b128 a[48:51], v8 offset:6144
    v_lshrrev_b64 v[20:21], 4, v[18:19]
    v_mfma_f32_16x16x32_bf16 v[244:247], a[12:15], v[132:135], v[244:247]
    v_and_or_b32 v18, v18, s44, v1
    v_and_or_b32 v19, v19, s44, v1
    v_mfma_f32_16x16x32_bf16 v[248:251], a[16:19], v[120:123], v[248:251]
    ds_read_b128 a[52:55], v9 offset:6144
    v_and_or_b32 v20, v20, s44, v1
    v_mfma_f32_16x16x32_bf16 v[248:251], a[20:23], v[128:131], v[248:251]
    v_and_or_b32 v21, v21, s44, v1
    v_perm_b32 v72, v48, v49, v18
    v_mfma_f32_16x16x32_bf16 v[252:255], a[16:19], v[124:127], v[252:255]
    ds_read_b128 a[56:59], v8 offset:8192
    v_perm_b32 v73, v48, v49, v20
    v_mfma_f32_16x16x32_bf16 v[252:255], a[20:23], v[132:135], v[252:255]
    s_waitcnt lgkmcnt(2)
    v_perm_b32 v74, v48, v49, v19
    v_perm_b32 v75, v48, v49, v21
    v_mfma_f32_16x16x32_bf16 v[136:139], a[24:27], v[56:59], v[136:139]
    ds_read_b128 a[60:63], v9 offset:8192
    v_perm_b32 v18, v16, v26, s42
    v_mfma_f32_16x16x32_bf16 v[136:139], a[28:31], v[64:67], v[136:139]
    v_perm_b32 v19, v16, v26, s43
    v_lshrrev_b64 v[20:21], 4, v[18:19]
    v_mfma_f32_16x16x32_bf16 v[140:143], a[24:27], v[60:63], v[140:143]
    ds_read_b128 a[64:67], v8 offset:10240
    v_and_or_b32 v18, v18, s44, v1
    v_mfma_f32_16x16x32_bf16 v[140:143], a[28:31], v[68:71], v[140:143]
    v_and_or_b32 v19, v19, s44, v1
    v_and_or_b32 v20, v20, s44, v1
    v_mfma_f32_16x16x32_bf16 v[144:147], a[32:35], v[56:59], v[144:147]
    ds_read_b128 a[68:71], v9 offset:10240
    v_and_or_b32 v21, v21, s44, v1
    v_mfma_f32_16x16x32_bf16 v[144:147], a[36:39], v[64:67], v[144:147]
    v_perm_b32 v80, v48, v49, v18
    v_perm_b32 v81, v48, v49, v20
    v_mfma_f32_16x16x32_bf16 v[148:151], a[32:35], v[60:63], v[148:151]
    ds_read_b128 a[72:75], v8 offset:12288
    v_perm_b32 v82, v48, v49, v19
    v_mfma_f32_16x16x32_bf16 v[148:151], a[36:39], v[68:71], v[148:151]
    v_perm_b32 v83, v48, v49, v21
    v_perm_b32 v18, v17, v27, s40
    v_mfma_f32_16x16x32_bf16 v[152:155], a[40:43], v[56:59], v[152:155]
    ds_read_b128 a[76:79], v9 offset:12288
    v_perm_b32 v19, v17, v27, s41
    v_mfma_f32_16x16x32_bf16 v[152:155], a[44:47], v[64:67], v[152:155]
    v_lshrrev_b64 v[20:21], 4, v[18:19]
    v_and_or_b32 v18, v18, s44, v1
    v_mfma_f32_16x16x32_bf16 v[156:159], a[40:43], v[60:63], v[156:159]
    ds_read_b128 a[80:83], v8 offset:14336
    v_and_or_b32 v19, v19, s44, v1
    v_mfma_f32_16x16x32_bf16 v[156:159], a[44:47], v[68:71], v[156:159]
    v_and_or_b32 v20, v20, s44, v1
    v_and_or_b32 v21, v21, s44, v1
    v_mfma_f32_16x16x32_bf16 v[160:163], a[48:51], v[56:59], v[160:163]
    s_waitcnt lgkmcnt(2)
    ds_read_b128 a[84:87], v9 offset:14336
    v_perm_b32 v76, v50, v51, v18
    v_mfma_f32_16x16x32_bf16 v[160:163], a[52:55], v[64:67], v[160:163]
    v_perm_b32 v77, v50, v51, v20
    v_perm_b32 v78, v50, v51, v19
    v_mfma_f32_16x16x32_bf16 v[164:167], a[48:51], v[60:63], v[164:167]
    ds_read_b128 a[88:91], v8 offset:16384
    v_perm_b32 v79, v50, v51, v21
    v_mfma_f32_16x16x32_bf16 v[164:167], a[52:55], v[68:71], v[164:167]
    v_perm_b32 v18, v17, v27, s42
    v_perm_b32 v19, v17, v27, s43
    v_mfma_f32_16x16x32_bf16 v[168:171], a[56:59], v[56:59], v[168:171]
    ds_read_b128 a[92:95], v9 offset:16384
    v_lshrrev_b64 v[20:21], 4, v[18:19]
    v_mfma_f32_16x16x32_bf16 v[168:171], a[60:63], v[64:67], v[168:171]
    v_and_or_b32 v18, v18, s44, v1
    v_and_or_b32 v19, v19, s44, v1
    v_mfma_f32_16x16x32_bf16 v[172:175], a[56:59], v[60:63], v[172:175]
    ds_read_b128 a[0:3], v8 offset:18432
    v_and_or_b32 v20, v20, s44, v1
    v_mfma_f32_16x16x32_bf16 v[172:175], a[60:63], v[68:71], v[172:175]
    v_and_or_b32 v21, v21, s44, v1
    v_perm_b32 v84, v50, v51, v18
    v_mfma_f32_16x16x32_bf16 v[176:179], a[64:67], v[56:59], v[176:179]
    s_waitcnt vmcnt(3) lgkmcnt(2)
    ds_read_b128 a[4:7], v9 offset:18432
    v_perm_b32 v85, v50, v51, v20
    v_mfma_f32_16x16x32_bf16 v[176:179], a[68:71], v[64:67], v[176:179]
    s_barrier
    v_mfma_f32_16x16x32_bf16 v[180:183], a[64:67], v[60:63], v[180:183]
    ds_read_b128 a[8:11], v8 offset:20480
    v_perm_b32 v86, v50, v51, v19
    v_mfma_f32_16x16x32_bf16 v[180:183], a[68:71], v[68:71], v[180:183]
    v_perm_b32 v87, v50, v51, v21
    v_lshrrev_b64 v[16:17], 2, v[28:29]
    v_mfma_f32_16x16x32_bf16 v[184:187], a[72:75], v[56:59], v[184:187]
    ds_read_b128 a[12:15], v9 offset:20480
    v_perm_b32 v18, v16, v28, s40
    v_mfma_f32_16x16x32_bf16 v[184:187], a[76:79], v[64:67], v[184:187]
    v_perm_b32 v19, v16, v28, s41
    v_lshrrev_b64 v[20:21], 4, v[18:19]
    v_mfma_f32_16x16x32_bf16 v[188:191], a[72:75], v[60:63], v[188:191]
    ds_read_b128 a[16:19], v8 offset:22528
    v_and_or_b32 v18, v18, s44, v1
    v_mfma_f32_16x16x32_bf16 v[188:191], a[76:79], v[68:71], v[188:191]
    v_and_or_b32 v19, v19, s44, v1
    v_and_or_b32 v20, v20, s44, v1
    v_mfma_f32_16x16x32_bf16 v[192:195], a[80:83], v[56:59], v[192:195]
    ds_read_b128 a[20:23], v9 offset:22528
    v_and_or_b32 v21, v21, s44, v1
    v_mfma_f32_16x16x32_bf16 v[192:195], a[84:87], v[64:67], v[192:195]
    v_perm_b32 v88, v52, v53, v18
    v_perm_b32 v89, v52, v53, v20
    v_mfma_f32_16x16x32_bf16 v[196:199], a[80:83], v[60:63], v[196:199]
    ds_read_b128 a[24:27], v8 offset:24576
    v_perm_b32 v90, v52, v53, v19
    v_mfma_f32_16x16x32_bf16 v[196:199], a[84:87], v[68:71], v[196:199]
    v_perm_b32 v91, v52, v53, v21
    v_perm_b32 v18, v16, v28, s42
    v_mfma_f32_16x16x32_bf16 v[200:203], a[88:91], v[56:59], v[200:203]
    s_waitcnt lgkmcnt(2)
    ds_read_b128 a[28:31], v9 offset:24576
    v_perm_b32 v19, v16, v28, s43
    v_mfma_f32_16x16x32_bf16 v[200:203], a[92:95], v[64:67], v[200:203]
    ds_write_b128 v14, v[40:43] offset:0
    v_mfma_f32_16x16x32_bf16 v[204:207], a[88:91], v[60:63], v[204:207]
    s_movk_i32 s56, 1024
    ds_read_b128 a[32:35], v8 offset:26624
    v_lshrrev_b64 v[20:21], 4, v[18:19]
    v_mfma_f32_16x16x32_bf16 v[204:207], a[92:95], v[68:71], v[204:207]
    ds_write_b128 v14, v[44:47] offset:1024
    v_mfma_f32_16x16x32_bf16 v[208:211], a[0:3], v[56:59], v[208:211]
    s_addk_i32 m0, 4096
    ds_read_b128 a[36:39], v9 offset:26624
    v_and_or_b32 v18, v18, s44, v1
    v_mfma_f32_16x16x32_bf16 v[208:211], a[4:7], v[64:67], v[208:211]
    buffer_load_dwordx4 v5, s[8:11], s56 offen lds
    v_mfma_f32_16x16x32_bf16 v[212:215], a[0:3], v[60:63], v[212:215]
    ds_read_b128 a[40:43], v12 offset:22528
    v_and_or_b32 v19, v19, s44, v1
    v_mfma_f32_16x16x32_bf16 v[212:215], a[4:7], v[68:71], v[212:215]
    s_add_u32 s56, s56, s62
    v_and_or_b32 v20, v20, s44, v1
    v_and_or_b32 v21, v21, s44, v1
    v_mfma_f32_16x16x32_bf16 v[216:219], a[8:11], v[56:59], v[216:219]
    s_addk_i32 m0, 4096
    ds_read_b128 a[44:47], v13 offset:22528
    v_perm_b32 v96, v52, v53, v18
    v_mfma_f32_16x16x32_bf16 v[216:219], a[12:15], v[64:67], v[216:219]
    buffer_load_dwordx4 v5, s[8:11], s56 offen lds
    v_mfma_f32_16x16x32_bf16 v[220:223], a[8:11], v[60:63], v[220:223]
    ds_read_b128 a[48:51], v8 offset:28672
    v_perm_b32 v97, v52, v53, v20
    v_mfma_f32_16x16x32_bf16 v[220:223], a[12:15], v[68:71], v[220:223]
    v_perm_b32 v98, v52, v53, v19
    v_perm_b32 v99, v52, v53, v21
    v_mfma_f32_16x16x32_bf16 v[224:227], a[16:19], v[56:59], v[224:227]
    s_waitcnt lgkmcnt(2)
    ds_read_b128 a[52:55], v9 offset:28672
    v_perm_b32 v18, v17, v29, s40
    v_mfma_f32_16x16x32_bf16 v[224:227], a[20:23], v[64:67], v[224:227]
    s_add_u32 s56, s56, s62
    v_perm_b32 v19, v17, v29, s41
    v_lshrrev_b64 v[20:21], 4, v[18:19]
    v_mfma_f32_16x16x32_bf16 v[228:231], a[16:19], v[60:63], v[228:231]
    s_addk_i32 m0, 4096
    ds_read_b128 a[56:59], v8 offset:30720
    v_and_or_b32 v18, v18, s44, v1
    v_mfma_f32_16x16x32_bf16 v[228:231], a[20:23], v[68:71], v[228:231]
    buffer_load_dwordx4 v5, s[8:11], s56 offen lds
    v_mfma_f32_16x16x32_bf16 v[232:235], a[24:27], v[56:59], v[232:235]
    s_add_u32 s57, s57, s61
    ds_read_b128 a[60:63], v9 offset:30720
    v_and_or_b32 v19, v19, s44, v1
    v_mfma_f32_16x16x32_bf16 v[232:235], a[28:31], v[64:67], v[232:235]
    buffer_load_dwordx2 v[24:25], v3, s[12:15], s57 offen
    v_mfma_f32_16x16x32_bf16 v[236:239], a[24:27], v[60:63], v[236:239]
    ds_read_b128 a[64:67], v8 offset:32768
    v_and_or_b32 v20, v20, s44, v1
    v_mfma_f32_16x16x32_bf16 v[236:239], a[28:31], v[68:71], v[236:239]
    s_add_u32 s56, s56, s62
    v_and_or_b32 v21, v21, s44, v1
    v_perm_b32 v92, v54, v55, v18
    v_mfma_f32_16x16x32_bf16 v[240:243], a[32:35], v[56:59], v[240:243]
    s_addk_i32 m0, 4096
    ds_read_b128 a[68:71], v9 offset:32768
    v_perm_b32 v93, v54, v55, v20
    v_mfma_f32_16x16x32_bf16 v[240:243], a[36:39], v[64:67], v[240:243]
    buffer_load_dwordx4 v5, s[8:11], s56 offen lds
    v_mfma_f32_16x16x32_bf16 v[244:247], a[32:35], v[60:63], v[244:247]
    ds_read_b128 a[72:75], v8 offset:34816
    v_perm_b32 v94, v54, v55, v19
    v_mfma_f32_16x16x32_bf16 v[244:247], a[36:39], v[68:71], v[244:247]
    v_perm_b32 v95, v54, v55, v21
    v_perm_b32 v18, v17, v29, s42
    v_mfma_f32_16x16x32_bf16 v[248:251], a[40:43], v[56:59], v[248:251]
    s_waitcnt lgkmcnt(2)
    ds_read_b128 a[76:79], v9 offset:34816
    v_perm_b32 v19, v17, v29, s43
    v_mfma_f32_16x16x32_bf16 v[248:251], a[44:47], v[64:67], v[248:251]
    s_add_u32 s56, s56, s62
    v_lshrrev_b64 v[20:21], 4, v[18:19]
    v_and_or_b32 v18, v18, s44, v1
    v_mfma_f32_16x16x32_bf16 v[252:255], a[40:43], v[60:63], v[252:255]
    s_addk_i32 m0, 4096
    ds_read_b128 a[80:83], v8 offset:36864
    v_and_or_b32 v19, v19, s44, v1
    v_mfma_f32_16x16x32_bf16 v[252:255], a[44:47], v[68:71], v[252:255]
    buffer_load_dwordx4 v5, s[8:11], s56 offen lds
    v_mfma_f32_16x16x32_bf16 v[136:139], a[48:51], v[72:75], v[136:139]
    ds_read_b128 a[84:87], v9 offset:36864
    v_and_or_b32 v20, v20, s44, v1
    v_mfma_f32_16x16x32_bf16 v[136:139], a[52:55], v[80:83], v[136:139]
    v_and_or_b32 v21, v21, s44, v1
    v_perm_b32 v100, v54, v55, v18
    v_mfma_f32_16x16x32_bf16 v[140:143], a[48:51], v[76:79], v[140:143]
    s_waitcnt vmcnt(6) lgkmcnt(2)
    ds_read_b128 a[88:91], v8 offset:38912
    v_perm_b32 v101, v54, v55, v20
    v_mfma_f32_16x16x32_bf16 v[140:143], a[52:55], v[84:87], v[140:143]
    s_add_u32 s56, s56, s62
    v_perm_b32 v102, v54, v55, v19
    v_perm_b32 v103, v54, v55, v21
    v_mfma_f32_16x16x32_bf16 v[144:147], a[56:59], v[72:75], v[144:147]
    s_addk_i32 m0, 4096
    ds_read_b128 a[92:95], v9 offset:38912
    v_lshrrev_b64 v[16:17], 2, v[22:23]
    v_mfma_f32_16x16x32_bf16 v[144:147], a[60:63], v[80:83], v[144:147]
    buffer_load_dwordx4 v5, s[8:11], s56 offen lds
    v_mfma_f32_16x16x32_bf16 v[148:151], a[56:59], v[76:79], v[148:151]
    ds_read_b128 a[0:3], v8 offset:40960
    v_perm_b32 v18, v16, v22, s40
    v_mfma_f32_16x16x32_bf16 v[148:151], a[60:63], v[84:87], v[148:151]
    ds_read_b128 v[48:51], v2 offset:0
    v_perm_b32 v19, v16, v22, s41
    v_mfma_f32_16x16x32_bf16 v[152:155], a[64:67], v[72:75], v[152:155]
    ds_read_b128 a[4:7], v9 offset:40960
    v_lshrrev_b64 v[20:21], 4, v[18:19]
    v_mfma_f32_16x16x32_bf16 v[152:155], a[68:71], v[80:83], v[152:155]
    s_add_u32 s56, s56, s62
    v_and_or_b32 v18, v18, s44, v1
    v_and_or_b32 v19, v19, s44, v1
    v_mfma_f32_16x16x32_bf16 v[156:159], a[64:67], v[76:79], v[156:159]
    s_addk_i32 m0, 4096
    ds_read_b128 a[8:11], v8 offset:43008
    v_and_or_b32 v20, v20, s44, v1
    v_mfma_f32_16x16x32_bf16 v[156:159], a[68:71], v[84:87], v[156:159]
    buffer_load_dwordx4 v5, s[8:11], s56 offen lds
    v_mfma_f32_16x16x32_bf16 v[160:163], a[72:75], v[72:75], v[160:163]
    ds_read_b128 a[12:15], v9 offset:43008
    v_and_or_b32 v21, v21, s44, v1
    v_mfma_f32_16x16x32_bf16 v[160:163], a[76:79], v[80:83], v[160:163]
    s_waitcnt lgkmcnt(2)
    v_perm_b32 v104, v48, v49, v18
    v_perm_b32 v105, v48, v49, v20
    v_mfma_f32_16x16x32_bf16 v[164:167], a[72:75], v[76:79], v[164:167]
    ds_read_b128 a[16:19], v8 offset:45056
    v_perm_b32 v106, v48, v49, v19
    v_mfma_f32_16x16x32_bf16 v[164:167], a[76:79], v[84:87], v[164:167]
    s_add_u32 s56, s56, s62
    v_perm_b32 v107, v48, v49, v21
    v_perm_b32 v18, v16, v22, s42
    v_mfma_f32_16x16x32_bf16 v[168:171], a[80:83], v[72:75], v[168:171]
    s_addk_i32 m0, 4096
    ds_read_b128 a[20:23], v9 offset:45056
    v_perm_b32 v19, v16, v22, s43
    v_mfma_f32_16x16x32_bf16 v[168:171], a[84:87], v[80:83], v[168:171]
    buffer_load_dwordx4 v6, s[8:11], s56 offen lds
    v_mfma_f32_16x16x32_bf16 v[172:175], a[80:83], v[76:79], v[172:175]
    ds_read_b128 a[24:27], v8 offset:47104
    v_lshrrev_b64 v[20:21], 4, v[18:19]
    v_mfma_f32_16x16x32_bf16 v[172:175], a[84:87], v[84:87], v[172:175]
    v_and_or_b32 v18, v18, s44, v1
    v_and_or_b32 v19, v19, s44, v1
    v_mfma_f32_16x16x32_bf16 v[176:179], a[88:91], v[72:75], v[176:179]
    ds_read_b128 a[28:31], v9 offset:47104
    v_and_or_b32 v20, v20, s44, v1
    v_mfma_f32_16x16x32_bf16 v[176:179], a[92:95], v[80:83], v[176:179]
    s_movk_i32 s56, 1152
    v_and_or_b32 v21, v21, s44, v1
    v_perm_b32 v112, v48, v49, v18
    v_mfma_f32_16x16x32_bf16 v[180:183], a[88:91], v[76:79], v[180:183]
    s_addk_i32 m0, 4096
    ds_read_b128 a[32:35], v8 offset:49152
    v_perm_b32 v113, v48, v49, v20
    v_mfma_f32_16x16x32_bf16 v[180:183], a[92:95], v[84:87], v[180:183]
    buffer_load_dwordx4 v5, s[8:11], s56 offen lds
    v_mfma_f32_16x16x32_bf16 v[184:187], a[0:3], v[72:75], v[184:187]
    s_waitcnt lgkmcnt(2)
    ds_read_b128 a[36:39], v9 offset:49152
    v_perm_b32 v114, v48, v49, v19
    v_mfma_f32_16x16x32_bf16 v[184:187], a[4:7], v[80:83], v[184:187]
    s_add_u32 s56, s56, s62
    v_perm_b32 v115, v48, v49, v21
    v_perm_b32 v18, v17, v23, s40
    v_mfma_f32_16x16x32_bf16 v[188:191], a[0:3], v[76:79], v[188:191]
    s_add_u32 s57, s57, s61
    ds_read_b128 a[40:43], v8 offset:51200
    v_perm_b32 v19, v17, v23, s41
    v_mfma_f32_16x16x32_bf16 v[188:191], a[4:7], v[84:87], v[188:191]
    buffer_load_dwordx2 v[26:27], v3, s[12:15], s57 offen
    v_mfma_f32_16x16x32_bf16 v[192:195], a[8:11], v[72:75], v[192:195]
    s_addk_i32 m0, 4096
    ds_read_b128 a[44:47], v9 offset:51200
    v_lshrrev_b64 v[20:21], 4, v[18:19]
    v_mfma_f32_16x16x32_bf16 v[192:195], a[12:15], v[80:83], v[192:195]
    buffer_load_dwordx4 v5, s[8:11], s56 offen lds
    v_mfma_f32_16x16x32_bf16 v[196:199], a[8:11], v[76:79], v[196:199]
    ds_read_b128 a[48:51], v8 offset:53248
    v_and_or_b32 v18, v18, s44, v1
    v_mfma_f32_16x16x32_bf16 v[196:199], a[12:15], v[84:87], v[196:199]
    v_and_or_b32 v19, v19, s44, v1
    v_and_or_b32 v20, v20, s44, v1
    v_mfma_f32_16x16x32_bf16 v[200:203], a[16:19], v[72:75], v[200:203]
    ds_read_b128 a[52:55], v9 offset:53248
    v_and_or_b32 v21, v21, s44, v1
    v_mfma_f32_16x16x32_bf16 v[200:203], a[20:23], v[80:83], v[200:203]
    s_add_u32 s56, s56, s62
    v_perm_b32 v108, v50, v51, v18
    v_perm_b32 v109, v50, v51, v20
    v_mfma_f32_16x16x32_bf16 v[204:207], a[16:19], v[76:79], v[204:207]
    s_addk_i32 m0, 4096
    ds_read_b128 a[56:59], v8 offset:55296
    v_perm_b32 v110, v50, v51, v19
    v_mfma_f32_16x16x32_bf16 v[204:207], a[20:23], v[84:87], v[204:207]
    buffer_load_dwordx4 v5, s[8:11], s56 offen lds
    v_mfma_f32_16x16x32_bf16 v[208:211], a[24:27], v[72:75], v[208:211]
    s_waitcnt lgkmcnt(2)
    ds_read_b128 a[60:63], v9 offset:55296
    v_perm_b32 v111, v50, v51, v21
    v_mfma_f32_16x16x32_bf16 v[208:211], a[28:31], v[80:83], v[208:211]
    v_perm_b32 v18, v17, v23, s42
    v_perm_b32 v19, v17, v23, s43
    v_mfma_f32_16x16x32_bf16 v[212:215], a[24:27], v[76:79], v[212:215]
    ds_read_b128 a[64:67], v8 offset:57344
    v_lshrrev_b64 v[20:21], 4, v[18:19]
    v_mfma_f32_16x16x32_bf16 v[212:215], a[28:31], v[84:87], v[212:215]
    s_add_u32 s56, s56, s62
    v_and_or_b32 v18, v18, s44, v1
    v_and_or_b32 v19, v19, s44, v1
    v_mfma_f32_16x16x32_bf16 v[216:219], a[32:35], v[72:75], v[216:219]
    s_addk_i32 m0, 4096
    ds_read_b128 a[68:71], v9 offset:57344
    v_and_or_b32 v20, v20, s44, v1
    v_mfma_f32_16x16x32_bf16 v[216:219], a[36:39], v[80:83], v[216:219]
    buffer_load_dwordx4 v5, s[8:11], s56 offen lds
    v_mfma_f32_16x16x32_bf16 v[220:223], a[32:35], v[76:79], v[220:223]
    ds_read_b128 a[72:75], v8 offset:61440
    v_and_or_b32 v21, v21, s44, v1
    v_mfma_f32_16x16x32_bf16 v[220:223], a[36:39], v[84:87], v[220:223]
    v_perm_b32 v116, v50, v51, v18
    v_perm_b32 v117, v50, v51, v20
    v_mfma_f32_16x16x32_bf16 v[224:227], a[40:43], v[72:75], v[224:227]
    s_waitcnt vmcnt(10) lgkmcnt(2)
    ds_read_b128 a[76:79], v9 offset:61440
    v_perm_b32 v118, v50, v51, v19
    v_mfma_f32_16x16x32_bf16 v[224:227], a[44:47], v[80:83], v[224:227]
    s_add_u32 s56, s56, s62
    ds_read_b128 v[52:55], v2 offset:256
    v_perm_b32 v119, v50, v51, v21
    v_mfma_f32_16x16x32_bf16 v[228:231], a[40:43], v[76:79], v[228:231]
    s_addk_i32 m0, 4096
    ds_read_b128 a[80:83], v8 offset:63488
    v_lshrrev_b64 v[16:17], 2, v[24:25]
    v_mfma_f32_16x16x32_bf16 v[228:231], a[44:47], v[84:87], v[228:231]
    buffer_load_dwordx4 v5, s[8:11], s56 offen lds
    v_mfma_f32_16x16x32_bf16 v[232:235], a[48:51], v[72:75], v[232:235]
    ds_read_b128 a[84:87], v9 offset:63488
    v_perm_b32 v18, v16, v24, s40
    v_mfma_f32_16x16x32_bf16 v[232:235], a[52:55], v[80:83], v[232:235]
    v_perm_b32 v19, v16, v24, s41
    v_lshrrev_b64 v[20:21], 4, v[18:19]
    v_mfma_f32_16x16x32_bf16 v[236:239], a[48:51], v[76:79], v[236:239]
    ds_read_b128 a[88:91], v10 offset:0
    v_and_or_b32 v18, v18, s44, v1
    v_mfma_f32_16x16x32_bf16 v[236:239], a[52:55], v[84:87], v[236:239]
    s_add_u32 s56, s56, s62
    v_and_or_b32 v19, v19, s44, v1
    v_and_or_b32 v20, v20, s44, v1
    v_mfma_f32_16x16x32_bf16 v[240:243], a[56:59], v[72:75], v[240:243]
    s_addk_i32 m0, 4096
    ds_read_b128 a[92:95], v11 offset:0
    v_and_or_b32 v21, v21, s44, v1
    v_mfma_f32_16x16x32_bf16 v[240:243], a[60:63], v[80:83], v[240:243]
    buffer_load_dwordx4 v5, s[8:11], s56 offen lds
    v_mfma_f32_16x16x32_bf16 v[244:247], a[56:59], v[76:79], v[244:247]
    s_waitcnt lgkmcnt(2)
    ds_read_b128 a[0:3], v10 offset:2048
    v_perm_b32 v120, v52, v53, v18
    v_mfma_f32_16x16x32_bf16 v[244:247], a[60:63], v[84:87], v[244:247]
    v_perm_b32 v121, v52, v53, v20
    v_perm_b32 v122, v52, v53, v19
    v_mfma_f32_16x16x32_bf16 v[248:251], a[64:67], v[72:75], v[248:251]
    ds_read_b128 a[4:7], v11 offset:2048
    v_perm_b32 v123, v52, v53, v21
    v_mfma_f32_16x16x32_bf16 v[248:251], a[68:71], v[80:83], v[248:251]
    s_add_u32 s56, s56, s62
    v_perm_b32 v18, v16, v24, s42
    v_perm_b32 v19, v16, v24, s43
    v_mfma_f32_16x16x32_bf16 v[252:255], a[64:67], v[76:79], v[252:255]
    s_addk_i32 m0, 4096
    ds_read_b128 a[8:11], v10 offset:4096
    v_lshrrev_b64 v[20:21], 4, v[18:19]
    v_mfma_f32_16x16x32_bf16 v[252:255], a[68:71], v[84:87], v[252:255]
    buffer_load_dwordx4 v5, s[8:11], s56 offen lds
    v_mfma_f32_16x16x32_bf16 v[136:139], a[72:75], v[88:91], v[136:139]
    ds_read_b128 a[12:15], v11 offset:4096
    v_and_or_b32 v18, v18, s44, v1
    v_mfma_f32_16x16x32_bf16 v[136:139], a[76:79], v[96:99], v[136:139]
    v_and_or_b32 v19, v19, s44, v1
    v_and_or_b32 v20, v20, s44, v1
    v_mfma_f32_16x16x32_bf16 v[140:143], a[72:75], v[92:95], v[140:143]
    ds_read_b128 a[16:19], v10 offset:6144
    v_and_or_b32 v21, v21, s44, v1
    v_mfma_f32_16x16x32_bf16 v[140:143], a[76:79], v[100:103], v[140:143]
    v_perm_b32 v128, v52, v53, v18
    v_perm_b32 v129, v52, v53, v20
    v_mfma_f32_16x16x32_bf16 v[144:147], a[80:83], v[88:91], v[144:147]
    ds_read_b128 a[20:23], v11 offset:6144
    v_perm_b32 v130, v52, v53, v19
    v_mfma_f32_16x16x32_bf16 v[144:147], a[84:87], v[96:99], v[144:147]
    v_perm_b32 v131, v52, v53, v21
    v_perm_b32 v18, v17, v25, s40
    v_mfma_f32_16x16x32_bf16 v[148:151], a[80:83], v[92:95], v[148:151]
    ds_read_b128 a[24:27], v10 offset:8192
    v_perm_b32 v19, v17, v25, s41
    v_mfma_f32_16x16x32_bf16 v[148:151], a[84:87], v[100:103], v[148:151]
    s_waitcnt lgkmcnt(2)
    v_lshrrev_b64 v[20:21], 4, v[18:19]
    v_and_or_b32 v18, v18, s44, v1
    v_mfma_f32_16x16x32_bf16 v[152:155], a[88:91], v[88:91], v[152:155]
    s_add_u32 s57, s57, s61
    ds_read_b128 a[28:31], v11 offset:8192
    v_and_or_b32 v19, v19, s44, v1
    v_mfma_f32_16x16x32_bf16 v[152:155], a[92:95], v[96:99], v[152:155]
    buffer_load_dwordx2 v[28:29], v3, s[12:15], s57 offen
    v_mfma_f32_16x16x32_bf16 v[156:159], a[88:91], v[92:95], v[156:159]
    ds_read_b128 a[32:35], v10 offset:10240
    v_and_or_b32 v20, v20, s44, v1
    v_mfma_f32_16x16x32_bf16 v[156:159], a[92:95], v[100:103], v[156:159]
    v_and_or_b32 v21, v21, s44, v1
    v_perm_b32 v124, v54, v55, v18
    v_mfma_f32_16x16x32_bf16 v[160:163], a[0:3], v[88:91], v[160:163]
    ds_read_b128 a[36:39], v11 offset:10240
    v_perm_b32 v125, v54, v55, v20
    v_mfma_f32_16x16x32_bf16 v[160:163], a[4:7], v[96:99], v[160:163]
    v_perm_b32 v126, v54, v55, v19
    v_perm_b32 v127, v54, v55, v21
    v_mfma_f32_16x16x32_bf16 v[164:167], a[0:3], v[92:95], v[164:167]
    ds_read_b128 a[40:43], v10 offset:12288
    v_perm_b32 v18, v17, v25, s42
    v_mfma_f32_16x16x32_bf16 v[164:167], a[4:7], v[100:103], v[164:167]
    v_perm_b32 v19, v17, v25, s43
    v_lshrrev_b64 v[20:21], 4, v[18:19]
    v_mfma_f32_16x16x32_bf16 v[168:171], a[8:11], v[88:91], v[168:171]
    ds_read_b128 a[44:47], v11 offset:12288
    v_and_or_b32 v18, v18, s44, v1
    v_mfma_f32_16x16x32_bf16 v[168:171], a[12:15], v[96:99], v[168:171]
L_hopA3:
    s_cbranch_execz L_hopret
    v_and_or_b32 v19, v19, s44, v1
    v_and_or_b32 v20, v20, s44, v1
    v_mfma_f32_16x16x32_bf16 v[172:175], a[8:11], v[92:95], v[172:175]
    ds_read_b128 a[48:51], v10 offset:14336
    v_and_or_b32 v21, v21, s44, v1
    v_mfma_f32_16x16x32_bf16 v[172:175], a[12:15], v[100:103], v[172:175]
    s_movk_i32 s56, 1280
    v_perm_b32 v132, v54, v55, v18
    v_perm_b32 v133, v54, v55, v20
    v_mfma_f32_16x16x32_bf16 v[176:179], a[16:19], v[88:91], v[176:179]
    s_waitcnt vmcnt(5) lgkmcnt(2)
    ds_read_b128 a[52:55], v11 offset:14336
    v_perm_b32 v134, v54, v55, v19
    v_mfma_f32_16x16x32_bf16 v[176:179], a[20:23], v[96:99], v[176:179]
    s_barrier
    v_mfma_f32_16x16x32_bf16 v[180:183], a[16:19], v[92:95], v[180:183]
    s_addk_i32 m0, 4096
    ds_read_b128 a[56:59], v10 offset:16384
    v_perm_b32 v135, v54, v55, v21
    v_mfma_f32_16x16x32_bf16 v[180:183], a[20:23], v[100:103], v[180:183]
    buffer_load_dwordx4 v5, s[8:11], s56 offen lds
    v_mfma_f32_16x16x32_bf16 v[184:187], a[24:27], v[88:91], v[184:187]
    ds_read_b128 a[60:63], v11 offset:16384
    v_lshrrev_b64 v[16:17], 2, v[26:27]
    v_mfma_f32_16x16x32_bf16 v[184:187], a[28:31], v[96:99], v[184:187]
    ds_read_b128 v[48:51], v2 offset:512
    v_perm_b32 v18, v16, v26, s40
    v_mfma_f32_16x16x32_bf16 v[188:191], a[24:27], v[92:95], v[188:191]
    ds_read_b128 a[64:67], v10 offset:18432
    v_perm_b32 v19, v16, v26, s41
    v_mfma_f32_16x16x32_bf16 v[188:191], a[28:31], v[100:103], v[188:191]
    s_add_u32 s56, s56, s62
    v_lshrrev_b64 v[20:21], 4, v[18:19]
    v_and_or_b32 v18, v18, s44, v1
    v_mfma_f32_16x16x32_bf16 v[192:195], a[32:35], v[88:91], v[192:195]
    s_add_u32 m0, s47, 0
    ds_read_b128 a[68:71], v11 offset:18432
    v_and_or_b32 v19, v19, s44, v1
    v_mfma_f32_16x16x32_bf16 v[192:195], a[36:39], v[96:99], v[192:195]
    buffer_load_dwordx4 v5, s[8:11], s56 offen lds
    v_mfma_f32_16x16x32_bf16 v[196:199], a[32:35], v[92:95], v[196:199]
    ds_read_b128 a[72:75], v10 offset:20480
    v_and_or_b32 v20, v20, s44, v1
    v_mfma_f32_16x16x32_bf16 v[196:199], a[36:39], v[100:103], v[196:199]
    s_waitcnt lgkmcnt(2)
    v_and_or_b32 v21, v21, s44, v1
    v_perm_b32 v56, v48, v49, v18
    v_mfma_f32_16x16x32_bf16 v[200:203], a[40:43], v[88:91], v[200:203]
    ds_read_b128 a[76:79], v11 offset:20480
    v_perm_b32 v57, v48, v49, v20
    v_mfma_f32_16x16x32_bf16 v[200:203], a[44:47], v[96:99], v[200:203]
    s_add_u32 s56, s56, s62
    v_perm_b32 v58, v48, v49, v19
    v_perm_b32 v59, v48, v49, v21
    v_mfma_f32_16x16x32_bf16 v[204:207], a[40:43], v[92:95], v[204:207]
    s_addk_i32 m0, 4096
    ds_read_b128 a[80:83], v10 offset:22528
    v_perm_b32 v18, v16, v26, s42
    v_mfma_f32_16x16x32_bf16 v[204:207], a[44:47], v[100:103], v[204:207]
    buffer_load_dwordx4 v5, s[8:11], s56 offen lds
    v_mfma_f32_16x16x32_bf16 v[208:211], a[48:51], v[88:91], v[208:211]
    ds_read_b128 a[84:87], v11 offset:22528
    v_perm_b32 v19, v16, v26, s43
    v_mfma_f32_16x16x32_bf16 v[208:211], a[52:55], v[96:99], v[208:211]
    v_lshrrev_b64 v[20:21], 4, v[18:19]
    v_and_or_b32 v18, v18, s44, v1
    v_mfma_f32_16x16x32_bf16 v[212:215], a[48:51], v[92:95], v[212:215]
    ds_read_b128 a[88:91], v8 offset:59392
    v_and_or_b32 v19, v19, s44, v1
    v_mfma_f32_16x16x32_bf16 v[212:215], a[52:55], v[100:103], v[212:215]
    s_add_u32 s56, s56, s62
    v_and_or_b32 v20, v20, s44, v1
    v_and_or_b32 v21, v21, s44, v1
    v_mfma_f32_16x16x32_bf16 v[216:219], a[56:59], v[88:91], v[216:219]
    s_addk_i32 m0, 4096
    ds_read_b128 a[92:95], v9 offset:59392
    v_perm_b32 v64, v48, v49, v18
    v_mfma_f32_16x16x32_bf16 v[216:219], a[60:63], v[96:99], v[216:219]
    buffer_load_dwordx4 v5, s[8:11], s56 offen lds
    v_mfma_f32_16x16x32_bf16 v[220:223], a[56:59], v[92:95], v[220:223]
    ds_read_b128 a[0:3], v10 offset:24576
    v_perm_b32 v65, v48, v49, v20
    v_mfma_f32_16x16x32_bf16 v[220:223], a[60:63], v[100:103], v[220:223]
    v_perm_b32 v66, v48, v49, v19
    v_perm_b32 v67, v48, v49, v21
    v_mfma_f32_16x16x32_bf16 v[224:227], a[64:67], v[88:91], v[224:227]
    s_waitcnt lgkmcnt(2)
    ds_read_b128 a[4:7], v11 offset:24576
    v_perm_b32 v18, v17, v27, s40
    v_mfma_f32_16x16x32_bf16 v[224:227], a[68:71], v[96:99], v[224:227]
    s_add_u32 s56, s56, s62
    v_perm_b32 v19, v17, v27, s41
    v_lshrrev_b64 v[20:21], 4, v[18:19]
    v_mfma_f32_16x16x32_bf16 v[228:231], a[64:67], v[92:95], v[228:231]
    s_addk_i32 m0, 4096
    ds_read_b128 a[8:11], v10 offset:26624
    v_and_or_b32 v18, v18, s44, v1
    v_mfma_f32_16x16x32_bf16 v[228:231], a[68:71], v[100:103], v[228:231]
    buffer_load_dwordx4 v5, s[8:11], s56 offen lds
    v_mfma_f32_16x16x32_bf16 v[232:235], a[72:75], v[88:91], v[232:235]
    ds_read_b128 a[12:15], v11 offset:26624
    v_and_or_b32 v19, v19, s44, v1
    v_mfma_f32_16x16x32_bf16 v[232:235], a[76:79], v[96:99], v[232:235]
    s_add_u32 s56, s56, s62
    v_and_or_b32 v20, v20, s44, v1
    v_and_or_b32 v21, v21, s44, v1
    v_mfma_f32_16x16x32_bf16 v[236:239], a[72:75], v[92:95], v[236:239]
    s_add_u32 s57, s57, s61
    ds_read_b128 a[16:19], v10 offset:28672
    v_perm_b32 v60, v50, v51, v18
    v_mfma_f32_16x16x32_bf16 v[236:239], a[76:79], v[100:103], v[236:239]
    buffer_load_dwordx2 v[22:23], v3, s[12:15], s57 offen
    v_mfma_f32_16x16x32_bf16 v[240:243], a[80:83], v[88:91], v[240:243]
    s_addk_i32 m0, 4096
    ds_read_b128 a[20:23], v11 offset:28672
    v_perm_b32 v61, v50, v51, v20
    v_mfma_f32_16x16x32_bf16 v[240:243], a[84:87], v[96:99], v[240:243]
    buffer_load_dwordx4 v5, s[8:11], s56 offen lds
    v_mfma_f32_16x16x32_bf16 v[244:247], a[80:83], v[92:95], v[244:247]
    ds_read_b128 a[24:27], v10 offset:30720
    v_perm_b32 v62, v50, v51, v19
    v_mfma_f32_16x16x32_bf16 v[244:247], a[84:87], v[100:103], v[244:247]
    v_perm_b32 v63, v50, v51, v21
    v_perm_b32 v18, v17, v27, s42
    v_mfma_f32_16x16x32_bf16 v[248:251], a[88:91], v[88:91], v[248:251]
    s_waitcnt lgkmcnt(2)
    ds_read_b128 a[28:31], v11 offset:30720
    v_perm_b32 v19, v17, v27, s43
    v_mfma_f32_16x16x32_bf16 v[248:251], a[92:95], v[96:99], v[248:251]
    s_add_u32 s56, s56, s62
    v_lshrrev_b64 v[20:21], 4, v[18:19]
    v_and_or_b32 v18, v18, s44, v1
    v_mfma_f32_16x16x32_bf16 v[252:255], a[88:91], v[92:95], v[252:255]
    s_addk_i32 m0, 4096
    ds_read_b128 a[32:35], v10 offset:32768
    v_and_or_b32 v19, v19, s44, v1
    v_mfma_f32_16x16x32_bf16 v[252:255], a[92:95], v[100:103], v[252:255]
    buffer_load_dwordx4 v5, s[8:11], s56 offen lds
    v_mfma_f32_16x16x32_bf16 v[136:139], a[0:3], v[104:107], v[136:139]
    ds_read_b128 a[36:39], v11 offset:32768
    v_and_or_b32 v20, v20, s44, v1
    v_mfma_f32_16x16x32_bf16 v[136:139], a[4:7], v[112:115], v[136:139]
    v_and_or_b32 v21, v21, s44, v1
    v_perm_b32 v68, v50, v51, v18
    v_mfma_f32_16x16x32_bf16 v[140:143], a[0:3], v[108:111], v[140:143]
    s_waitcnt vmcnt(8) lgkmcnt(2)
    ds_read_b128 a[40:43], v10 offset:34816
    v_perm_b32 v69, v50, v51, v20
    v_mfma_f32_16x16x32_bf16 v[140:143], a[4:7], v[116:119], v[140:143]
    s_add_u32 s56, s56, s62
    v_perm_b32 v70, v50, v51, v19
    v_perm_b32 v71, v50, v51, v21
    v_mfma_f32_16x16x32_bf16 v[144:147], a[8:11], v[104:107], v[144:147]
    s_addk_i32 m0, 4096
    ds_read_b128 a[44:47], v11 offset:34816
    v_lshrrev_b64 v[16:17], 2, v[28:29]
    v_mfma_f32_16x16x32_bf16 v[144:147], a[12:15], v[112:115], v[144:147]
    buffer_load_dwordx4 v6, s[8:11], s56 offen lds
    v_mfma_f32_16x16x32_bf16 v[148:151], a[8:11], v[108:111], v[148:151]
    ds_read_b128 a[48:51], v10 offset:36864
    v_perm_b32 v18, v16, v28, s40
    v_mfma_f32_16x16x32_bf16 v[148:151], a[12:15], v[116:119], v[148:151]
    ds_read_b128 v[52:55], v2 offset:768
    v_perm_b32 v19, v16, v28, s41
    v_mfma_f32_16x16x32_bf16 v[152:155], a[16:19], v[104:107], v[152:155]
    ds_read_b128 a[52:55], v11 offset:36864
    v_lshrrev_b64 v[20:21], 4, v[18:19]
    v_mfma_f32_16x16x32_bf16 v[152:155], a[20:23], v[112:115], v[152:155]
    s_movk_i32 s56, 1408
    v_and_or_b32 v18, v18, s44, v1
    v_and_or_b32 v19, v19, s44, v1
    v_mfma_f32_16x16x32_bf16 v[156:159], a[16:19], v[108:111], v[156:159]
    s_addk_i32 m0, 4096
    ds_read_b128 a[56:59], v10 offset:38912
    v_and_or_b32 v20, v20, s44, v1
    v_mfma_f32_16x16x32_bf16 v[156:159], a[20:23], v[116:119], v[156:159]
    buffer_load_dwordx4 v5, s[8:11], s56 offen lds
    v_mfma_f32_16x16x32_bf16 v[160:163], a[24:27], v[104:107], v[160:163]
    ds_read_b128 a[60:63], v11 offset:38912
    v_and_or_b32 v21, v21, s44, v1
    v_mfma_f32_16x16x32_bf16 v[160:163], a[28:31], v[112:115], v[160:163]
    s_waitcnt lgkmcnt(2)
    v_perm_b32 v72, v52, v53, v18
    v_perm_b32 v73, v52, v53, v20
    v_mfma_f32_16x16x32_bf16 v[164:167], a[24:27], v[108:111], v[164:167]
    ds_read_b128 a[64:67], v10 offset:40960
    v_perm_b32 v74, v52, v53, v19
    v_mfma_f32_16x16x32_bf16 v[164:167], a[28:31], v[116:119], v[164:167]
    s_addk_i32 s56, 128
    v_perm_b32 v75, v52, v53, v21
    v_perm_b32 v18, v16, v28, s42
    v_mfma_f32_16x16x32_bf16 v[168:171], a[32:35], v[104:107], v[168:171]
    s_addk_i32 m0, 4096
    ds_read_b128 a[68:71], v11 offset:40960
    v_perm_b32 v19, v16, v28, s43
    v_mfma_f32_16x16x32_bf16 v[168:171], a[36:39], v[112:115], v[168:171]
    buffer_load_dwordx4 v5, s[8:11], s56 offen lds
    v_mfma_f32_16x16x32_bf16 v[172:175], a[32:35], v[108:111], v[172:175]
    ds_read_b128 a[72:75], v10 offset:43008
    v_lshrrev_b64 v[20:21], 4, v[18:19]
    v_mfma_f32_16x16x32_bf16 v[172:175], a[36:39], v[116:119], v[172:175]
    v_and_or_b32 v18, v18, s44, v1
    v_and_or_b32 v19, v19, s44, v1
    v_mfma_f32_16x16x32_bf16 v[176:179], a[40:43], v[104:107], v[176:179]
    ds_read_b128 a[76:79], v11 offset:43008
    v_and_or_b32 v20, v20, s44, v1
    v_mfma_f32_16x16x32_bf16 v[176:179], a[44:47], v[112:115], v[176:179]
    s_addk_i32 s56, 128
    v_and_or_b32 v21, v21, s44, v1
    v_perm_b32 v80, v52, v53, v18
    v_mfma_f32_16x16x32_bf16 v[180:183], a[40:43], v[108:111], v[180:183]
    s_addk_i32 m0, 4096
    ds_read_b128 a[80:83], v10 offset:45056
    v_perm_b32 v81, v52, v53, v20
    v_mfma_f32_16x16x32_bf16 v[180:183], a[44:47], v[116:119], v[180:183]
    buffer_load_dwordx4 v5, s[8:11], s56 offen lds
    v_mfma_f32_16x16x32_bf16 v[184:187], a[48:51], v[104:107], v[184:187]
    ds_read_b128 a[84:87], v11 offset:45056
    v_perm_b32 v82, v52, v53, v19
    v_mfma_f32_16x16x32_bf16 v[184:187], a[52:55], v[112:115], v[184:187]
    v_perm_b32 v83, v52, v53, v21
    v_perm_b32 v18, v17, v29, s40
    v_mfma_f32_16x16x32_bf16 v[188:191], a[48:51], v[108:111], v[188:191]
    s_waitcnt lgkmcnt(2)
    ds_read_b128 a[88:91], v10 offset:47104
    v_perm_b32 v19, v17, v29, s41
    v_mfma_f32_16x16x32_bf16 v[188:191], a[52:55], v[116:119], v[188:191]
    s_addk_i32 s56, 128
    v_lshrrev_b64 v[20:21], 4, v[18:19]
    v_and_or_b32 v18, v18, s44, v1
    v_mfma_f32_16x16x32_bf16 v[192:195], a[56:59], v[104:107], v[192:195]
    s_addk_i32 m0, 4096
    ds_read_b128 a[92:95], v11 offset:47104
    v_and_or_b32 v19, v19, s44, v1
    v_mfma_f32_16x16x32_bf16 v[192:195], a[60:63], v[112:115], v[192:195]
    buffer_load_dwordx4 v5, s[8:11], s56 offen lds
    v_mfma_f32_16x16x32_bf16 v[196:199], a[56:59], v[108:111], v[196:199]
    s_add_u32 s57, s57, s61
    ds_read_b128 a[0:3], v10 offset:49152
    v_and_or_b32 v20, v20, s44, v1
    v_mfma_f32_16x16x32_bf16 v[196:199], a[60:63], v[116:119], v[196:199]
    buffer_load_dwordx2 v[24:25], v3, s[12:15], s57 offen
    v_mfma_f32_16x16x32_bf16 v[200:203], a[64:67], v[104:107], v[200:203]
    ds_read_b128 a[4:7], v11 offset:49152
    v_and_or_b32 v21, v21, s44, v1
    v_mfma_f32_16x16x32_bf16 v[200:203], a[68:71], v[112:115], v[200:203]
    s_addk_i32 s56, 128
    v_perm_b32 v76, v54, v55, v18
    v_perm_b32 v77, v54, v55, v20
    v_mfma_f32_16x16x32_bf16 v[204:207], a[64:67], v[108:111], v[204:207]
    s_addk_i32 m0, 4096
    ds_read_b128 a[8:11], v10 offset:51200
    v_perm_b32 v78, v54, v55, v19
    v_mfma_f32_16x16x32_bf16 v[204:207], a[68:71], v[116:119], v[204:207]
    buffer_load_dwordx4 v5, s[8:11], s56 offen lds
    v_mfma_f32_16x16x32_bf16 v[208:211], a[72:75], v[104:107], v[208:211]
    ds_read_b128 a[12:15], v11 offset:51200
    v_perm_b32 v79, v54, v55, v21
    v_mfma_f32_16x16x32_bf16 v[208:211], a[76:79], v[112:115], v[208:211]
    v_perm_b32 v18, v17, v29, s42
    v_perm_b32 v19, v17, v29, s43
    v_mfma_f32_16x16x32_bf16 v[212:215], a[72:75], v[108:111], v[212:215]
    s_waitcnt lgkmcnt(2)
    ds_read_b128 a[16:19], v10 offset:53248
    v_lshrrev_b64 v[20:21], 4, v[18:19]
    v_mfma_f32_16x16x32_bf16 v[212:215], a[76:79], v[116:119], v[212:215]
    s_mov_b32 s56, 66944
    v_and_or_b32 v18, v18, s44, v1
    v_and_or_b32 v19, v19, s44, v1
    v_mfma_f32_16x16x32_bf16 v[216:219], a[80:83], v[104:107], v[216:219]
    s_addk_i32 m0, 4096
    ds_read_b128 a[20:23], v11 offset:53248
    v_and_or_b32 v20, v20, s44, v1
    v_mfma_f32_16x16x32_bf16 v[216:219], a[84:87], v[112:115], v[216:219]
    buffer_load_dwordx4 v5, s[8:11], s56 offen lds
    v_mfma_f32_16x16x32_bf16 v[220:223], a[80:83], v[108:111], v[220:223]
    ds_read_b128 a[24:27], v10 offset:57344
    v_and_or_b32 v21, v21, s44, v1
    v_mfma_f32_16x16x32_bf16 v[220:223], a[84:87], v[116:119], v[220:223]
    v_perm_b32 v84, v54, v55, v18
    v_perm_b32 v85, v54, v55, v20
    v_mfma_f32_16x16x32_bf16 v[224:227], a[88:91], v[104:107], v[224:227]
    s_waitcnt vmcnt(10) lgkmcnt(2)
    ds_read_b128 a[28:31], v11 offset:57344
    v_perm_b32 v86, v54, v55, v19
    v_mfma_f32_16x16x32_bf16 v[224:227], a[92:95], v[112:115], v[224:227]
    s_addk_i32 s56, 128
    v_perm_b32 v87, v54, v55, v21
    v_lshrrev_b64 v[16:17], 2, v[22:23]
    v_mfma_f32_16x16x32_bf16 v[228:231], a[88:91], v[108:111], v[228:231]
    s_addk_i32 m0, 4096
    ds_read_b128 a[32:35], v10 offset:59392
    v_perm_b32 v18, v16, v22, s40
    v_mfma_f32_16x16x32_bf16 v[228:231], a[92:95], v[116:119], v[228:231]
    buffer_load_dwordx4 v5, s[8:11], s56 offen lds
    v_mfma_f32_16x16x32_bf16 v[232:235], a[0:3], v[104:107], v[232:235]
    ds_read_b128 a[36:39], v11 offset:59392
    v_perm_b32 v19, v16, v22, s41
    v_mfma_f32_16x16x32_bf16 v[232:235], a[4:7], v[112:115], v[232:235]
    ds_read_b128 v[48:51], v2 offset:1024
    v_lshrrev_b64 v[20:21], 4, v[18:19]
    v_mfma_f32_16x16x32_bf16 v[236:239], a[0:3], v[108:111], v[236:239]
    ds_read_b128 a[40:43], v10 offset:61440
    v_and_or_b32 v18, v18, s44, v1
    v_mfma_f32_16x16x32_bf16 v[236:239], a[4:7], v[116:119], v[236:239]
    v_and_or_b32 v19, v19, s44, v1
    v_and_or_b32 v20, v20, s44, v1
    v_mfma_f32_16x16x32_bf16 v[240:243], a[8:11], v[104:107], v[240:243]
    ds_read_b128 a[44:47], v11 offset:61440
    v_and_or_b32 v21, v21, s44, v1
    v_mfma_f32_16x16x32_bf16 v[240:243], a[12:15], v[112:115], v[240:243]
    v_mfma_f32_16x16x32_bf16 v[244:247], a[8:11], v[108:111], v[244:247]
    ds_read_b128 a[48:51], v10 offset:63488
    v_mfma_f32_16x16x32_bf16 v[244:247], a[12:15], v[116:119], v[244:247]
    s_waitcnt lgkmcnt(2)
    v_perm_b32 v88, v48, v49, v18
    v_perm_b32 v89, v48, v49, v20
    v_mfma_f32_16x16x32_bf16 v[248:251], a[16:19], v[104:107], v[248:251]
    ds_read_b128 a[52:55], v11 offset:63488
    v_perm_b32 v90, v48, v49, v19
    v_mfma_f32_16x16x32_bf16 v[248:251], a[20:23], v[112:115], v[248:251]
    v_perm_b32 v91, v48, v49, v21
    v_perm_b32 v18, v16, v22, s42
    v_mfma_f32_16x16x32_bf16 v[252:255], a[16:19], v[108:111], v[252:255]
    ds_read_b128 a[56:59], v12 offset:0
    v_perm_b32 v19, v16, v22, s43
    v_mfma_f32_16x16x32_bf16 v[252:255], a[20:23], v[116:119], v[252:255]
    v_lshrrev_b64 v[20:21], 4, v[18:19]
    v_and_or_b32 v18, v18, s44, v1
    v_mfma_f32_16x16x32_bf16 v[136:139], a[24:27], v[120:123], v[136:139]
    ds_read_b128 a[60:63], v13 offset:0
    v_and_or_b32 v19, v19, s44, v1
    v_mfma_f32_16x16x32_bf16 v[136:139], a[28:31], v[128:131], v[136:139]
    v_and_or_b32 v20, v20, s44, v1
    v_and_or_b32 v21, v21, s44, v1
    v_mfma_f32_16x16x32_bf16 v[140:143], a[24:27], v[124:127], v[140:143]
    ds_read_b128 a[64:67], v12 offset:2048
    v_perm_b32 v96, v48, v49, v18
    v_mfma_f32_16x16x32_bf16 v[140:143], a[28:31], v[132:135], v[140:143]
    s_addk_i32 s56, 128
    v_perm_b32 v97, v48, v49, v20
    v_perm_b32 v98, v48, v49, v19
    v_mfma_f32_16x16x32_bf16 v[144:147], a[32:35], v[120:123], v[144:147]
    s_waitcnt vmcnt(6) lgkmcnt(2)
    ds_read_b128 a[68:71], v13 offset:2048
    v_perm_b32 v99, v48, v49, v21
    v_mfma_f32_16x16x32_bf16 v[144:147], a[36:39], v[128:131], v[144:147]
    s_barrier
    v_mfma_f32_16x16x32_bf16 v[148:151], a[32:35], v[124:127], v[148:151]
    s_addk_i32 m0, 4096
    ds_read_b128 a[72:75], v12 offset:4096
    v_perm_b32 v18, v17, v23, s40
    v_mfma_f32_16x16x32_bf16 v[148:151], a[36:39], v[132:135], v[148:151]
    buffer_load_dwordx4 v5, s[8:11], s56 offen lds
    v_mfma_f32_16x16x32_bf16 v[152:155], a[40:43], v[120:123], v[152:155]
    ds_read_b128 a[76:79], v13 offset:4096
    v_perm_b32 v19, v17, v23, s41
    v_mfma_f32_16x16x32_bf16 v[152:155], a[44:47], v[128:131], v[152:155]
    v_lshrrev_b64 v[20:21], 4, v[18:19]
    v_and_or_b32 v18, v18, s44, v1
    v_mfma_f32_16x16x32_bf16 v[156:159], a[40:43], v[124:127], v[156:159]
    ds_read_b128 a[80:83], v12 offset:6144
    v_and_or_b32 v19, v19, s44, v1
    v_mfma_f32_16x16x32_bf16 v[156:159], a[44:47], v[132:135], v[156:159]
    s_addk_i32 s56, 128
    v_and_or_b32 v20, v20, s44, v1
    v_and_or_b32 v21, v21, s44, v1
    v_mfma_f32_16x16x32_bf16 v[160:163], a[48:51], v[120:123], v[160:163]
    s_add_u32 s57, s57, s61
    ds_read_b128 a[84:87], v13 offset:6144
    v_perm_b32 v92, v50, v51, v18
    v_mfma_f32_16x16x32_bf16 v[160:163], a[52:55], v[128:131], v[160:163]
    buffer_load_dwordx2 v[26:27], v3, s[12:15], s57 offen
    v_mfma_f32_16x16x32_bf16 v[164:167], a[48:51], v[124:127], v[164:167]
    s_addk_i32 m0, 4096
    ds_read_b128 a[88:91], v12 offset:8192
    v_perm_b32 v93, v50, v51, v20
    v_mfma_f32_16x16x32_bf16 v[164:167], a[52:55], v[132:135], v[164:167]
    buffer_load_dwordx4 v5, s[8:11], s56 offen lds
    v_mfma_f32_16x16x32_bf16 v[168:171], a[56:59], v[120:123], v[168:171]
    s_waitcnt lgkmcnt(2)
    ds_read_b128 a[92:95], v13 offset:8192
    v_perm_b32 v94, v50, v51, v19
    v_mfma_f32_16x16x32_bf16 v[168:171], a[60:63], v[128:131], v[168:171]
    s_addk_i32 s56, 128
    v_perm_b32 v95, v50, v51, v21
    v_perm_b32 v18, v17, v23, s42
    v_mfma_f32_16x16x32_bf16 v[172:175], a[56:59], v[124:127], v[172:175]
    s_addk_i32 m0, 4096
    ds_read_b128 a[0:3], v12 offset:10240
    v_perm_b32 v19, v17, v23, s43
    v_mfma_f32_16x16x32_bf16 v[172:175], a[60:63], v[132:135], v[172:175]
    buffer_load_dwordx4 v5, s[8:11], s56 offen lds
    v_mfma_f32_16x16x32_bf16 v[176:179], a[64:67], v[120:123], v[176:179]
    ds_read_b128 a[4:7], v13 offset:10240
    v_lshrrev_b64 v[20:21], 4, v[18:19]
    v_mfma_f32_16x16x32_bf16 v[176:179], a[68:71], v[128:131], v[176:179]
    v_and_or_b32 v18, v18, s44, v1
    v_and_or_b32 v19, v19, s44, v1
    v_mfma_f32_16x16x32_bf16 v[180:183], a[64:67], v[124:127], v[180:183]
    ds_read_b128 a[8:11], v12 offset:12288
    v_and_or_b32 v20, v20, s44, v1
    v_mfma_f32_16x16x32_bf16 v[180:183], a[68:71], v[132:135], v[180:183]
    s_mov_b32 s56, 132480
    v_and_or_b32 v21, v21, s44, v1
    v_perm_b32 v100, v50, v51, v18
    v_mfma_f32_16x16x32_bf16 v[184:187], a[72:75], v[120:123], v[184:187]
    s_addk_i32 m0, 4096
    ds_read_b128 a[12:15], v13 offset:12288
    v_perm_b32 v101, v50, v51, v20
    v_mfma_f32_16x16x32_bf16 v[184:187], a[76:79], v[128:131], v[184:187]
    buffer_load_dwordx4 v5, s[8:11], s56 offen lds
    v_mfma_f32_16x16x32_bf16 v[188:191], a[72:75], v[124:127], v[188:191]
    ds_read_b128 a[16:19], v12 offset:14336
    v_perm_b32 v102, v50, v51, v19
    v_mfma_f32_16x16x32_bf16 v[188:191], a[76:79], v[132:135], v[188:191]
    ds_read_b128 v[52:55], v2 offset:1280
    v_perm_b32 v103, v50, v51, v21
    v_mfma_f32_16x16x32_bf16 v[192:195], a[80:83], v[120:123], v[192:195]
    s_waitcnt vmcnt(8) lgkmcnt(3)
    ds_read_b128 a[20:23], v13 offset:14336
    v_lshrrev_b64 v[16:17], 2, v[24:25]
    v_mfma_f32_16x16x32_bf16 v[192:195], a[84:87], v[128:131], v[192:195]
    s_addk_i32 s56, 128
    v_perm_b32 v18, v16, v24, s40
    v_perm_b32 v19, v16, v24, s41
    v_mfma_f32_16x16x32_bf16 v[196:199], a[80:83], v[124:127], v[196:199]
    s_addk_i32 m0, 4096
    ds_read_b128 a[24:27], v12 offset:16384
    v_lshrrev_b64 v[20:21], 4, v[18:19]
    v_mfma_f32_16x16x32_bf16 v[196:199], a[84:87], v[132:135], v[196:199]
    buffer_load_dwordx4 v5, s[8:11], s56 offen lds
    v_mfma_f32_16x16x32_bf16 v[200:203], a[88:91], v[120:123], v[200:203]
    ds_read_b128 a[28:31], v13 offset:16384
    v_and_or_b32 v18, v18, s44, v1
    v_mfma_f32_16x16x32_bf16 v[200:203], a[92:95], v[128:131], v[200:203]
    v_and_or_b32 v19, v19, s44, v1
    v_and_or_b32 v20, v20, s44, v1
    v_mfma_f32_16x16x32_bf16 v[204:207], a[88:91], v[124:127], v[204:207]
    s_waitcnt lgkmcnt(2)
    ds_read_b128 a[32:35], v12 offset:18432
    v_and_or_b32 v21, v21, s44, v1
    v_mfma_f32_16x16x32_bf16 v[204:207], a[92:95], v[132:135], v[204:207]
    s_addk_i32 s56, 128
    v_perm_b32 v104, v52, v53, v18
    v_perm_b32 v105, v52, v53, v20
    v_mfma_f32_16x16x32_bf16 v[208:211], a[0:3], v[120:123], v[208:211]
    s_addk_i32 m0, 4096
    ds_read_b128 a[36:39], v13 offset:18432
    v_perm_b32 v106, v52, v53, v19
    v_mfma_f32_16x16x32_bf16 v[208:211], a[4:7], v[128:131], v[208:211]
    buffer_load_dwordx4 v5, s[8:11], s56 offen lds
    v_mfma_f32_16x16x32_bf16 v[212:215], a[0:3], v[124:127], v[212:215]
    ds_read_b128 a[40:43], v10 offset:55296
    v_perm_b32 v107, v52, v53, v21
    v_mfma_f32_16x16x32_bf16 v[212:215], a[4:7], v[132:135], v[212:215]
    v_perm_b32 v18, v16, v24, s42
    v_perm_b32 v19, v16, v24, s43
    v_mfma_f32_16x16x32_bf16 v[216:219], a[8:11], v[120:123], v[216:219]
    ds_read_b128 a[44:47], v11 offset:55296
    v_lshrrev_b64 v[20:21], 4, v[18:19]
    v_mfma_f32_16x16x32_bf16 v[216:219], a[12:15], v[128:131], v[216:219]
    s_addk_i32 s56, 128
    v_and_or_b32 v18, v18, s44, v1
    v_and_or_b32 v19, v19, s44, v1
    v_mfma_f32_16x16x32_bf16 v[220:223], a[8:11], v[124:127], v[220:223]
    s_addk_i32 m0, 4096
    ds_read_b128 a[48:51], v12 offset:20480
    v_and_or_b32 v20, v20, s44, v1
    v_mfma_f32_16x16x32_bf16 v[220:223], a[12:15], v[132:135], v[220:223]
    buffer_load_dwordx4 v5, s[8:11], s56 offen lds
    v_mfma_f32_16x16x32_bf16 v[224:227], a[16:19], v[120:123], v[224:227]
    ds_read_b128 a[52:55], v13 offset:20480
    v_and_or_b32 v21, v21, s44, v1
    v_mfma_f32_16x16x32_bf16 v[224:227], a[20:23], v[128:131], v[224:227]
    v_perm_b32 v112, v52, v53, v18
    v_perm_b32 v113, v52, v53, v20
    v_mfma_f32_16x16x32_bf16 v[228:231], a[16:19], v[124:127], v[228:231]
    s_waitcnt lgkmcnt(2)
    ds_read_b128 a[56:59], v12 offset:22528
    v_perm_b32 v114, v52, v53, v19
    v_mfma_f32_16x16x32_bf16 v[228:231], a[20:23], v[132:135], v[228:231]
    s_addk_i32 s56, 128
    v_perm_b32 v115, v52, v53, v21
    v_perm_b32 v18, v17, v25, s40
    v_mfma_f32_16x16x32_bf16 v[232:235], a[24:27], v[120:123], v[232:235]
    s_addk_i32 m0, 4096
    ds_read_b128 a[60:63], v13 offset:22528
    v_perm_b32 v19, v17, v25, s41
    v_mfma_f32_16x16x32_bf16 v[232:235], a[28:31], v[128:131], v[232:235]
    buffer_load_dwordx4 v5, s[8:11], s56 offen lds
    v_mfma_f32_16x16x32_bf16 v[236:239], a[24:27], v[124:127], v[236:239]
    s_add_u32 s57, s57, s61
    ds_read_b128 a[64:67], v8 offset:0
    v_lshrrev_b64 v[20:21], 4, v[18:19]
    v_mfma_f32_16x16x32_bf16 v[236:239], a[28:31], v[132:135], v[236:239]
    buffer_load_dwordx2 v[28:29], v3, s[12:15], s57 offen
    v_mfma_f32_16x16x32_bf16 v[240:243], a[32:35], v[120:123], v[240:243]
    ds_read_b128 a[68:71], v9 offset:0
    v_and_or_b32 v18, v18, s44, v1
    v_mfma_f32_16x16x32_bf16 v[240:243], a[36:39], v[128:131], v[240:243]
    s_mov_b32 s56, 198016
    v_and_or_b32 v19, v19, s44, v1
    v_and_or_b32 v20, v20, s44, v1
    v_mfma_f32_16x16x32_bf16 v[244:247], a[32:35], v[124:127], v[244:247]
    s_addk_i32 m0, 4096
    ds_read_b128 a[72:75], v8 offset:2048
    v_and_or_b32 v21, v21, s44, v1
    v_mfma_f32_16x16x32_bf16 v[244:247], a[36:39], v[132:135], v[244:247]
    buffer_load_dwordx4 v5, s[8:11], s56 offen lds
    v_mfma_f32_16x16x32_bf16 v[248:251], a[40:43], v[120:123], v[248:251]
    ds_read_b128 a[76:79], v9 offset:2048
    v_perm_b32 v108, v54, v55, v18
    v_mfma_f32_16x16x32_bf16 v[248:251], a[44:47], v[128:131], v[248:251]
    v_perm_b32 v109, v54, v55, v20
    v_perm_b32 v110, v54, v55, v19
    v_mfma_f32_16x16x32_bf16 v[252:255], a[40:43], v[124:127], v[252:255]
    s_waitcnt lgkmcnt(2)
    ds_read_b128 a[80:83], v8 offset:4096
    v_perm_b32 v111, v54, v55, v21
    v_mfma_f32_16x16x32_bf16 v[252:255], a[44:47], v[132:135], v[252:255]
    s_addk_i32 s56, 128
    v_perm_b32 v18, v17, v25, s42
    v_perm_b32 v19, v17, v25, s43
    v_mfma_f32_16x16x32_bf16 v[136:139], a[48:51], v[56:59], v[136:139]
    s_addk_i32 m0, 4096
    ds_read_b128 a[84:87], v9 offset:4096
    v_lshrrev_b64 v[20:21], 4, v[18:19]
    v_mfma_f32_16x16x32_bf16 v[136:139], a[52:55], v[64:67], v[136:139]
    buffer_load_dwordx4 v5, s[8:11], s56 offen lds
    v_mfma_f32_16x16x32_bf16 v[140:143], a[48:51], v[60:63], v[140:143]
    ds_read_b128 a[88:91], v8 offset:6144
    v_and_or_b32 v18, v18, s44, v1
    v_mfma_f32_16x16x32_bf16 v[140:143], a[52:55], v[68:71], v[140:143]
    v_and_or_b32 v19, v19, s44, v1
    v_and_or_b32 v20, v20, s44, v1
    v_mfma_f32_16x16x32_bf16 v[144:147], a[56:59], v[56:59], v[144:147]
    ds_read_b128 a[92:95], v9 offset:6144
    v_and_or_b32 v21, v21, s44, v1
    v_mfma_f32_16x16x32_bf16 v[144:147], a[60:63], v[64:67], v[144:147]
    s_addk_i32 s56, 128
    v_perm_b32 v116, v54, v55, v18
    v_perm_b32 v117, v54, v55, v20
    v_mfma_f32_16x16x32_bf16 v[148:151], a[56:59], v[60:63], v[148:151]
    s_addk_i32 m0, 4096
    ds_read_b128 a[0:3], v8 offset:8192
    v_perm_b32 v118, v54, v55, v19
    v_mfma_f32_16x16x32_bf16 v[148:151], a[60:63], v[68:71], v[148:151]
    buffer_load_dwordx4 v5, s[8:11], s56 offen lds
    v_mfma_f32_16x16x32_bf16 v[152:155], a[64:67], v[56:59], v[152:155]
L_hopA4:
    s_cbranch_execz L_hopret
    ds_read_b128 a[4:7], v9 offset:8192
    v_perm_b32 v119, v54, v55, v21
    v_mfma_f32_16x16x32_bf16 v[152:155], a[68:71], v[64:67], v[152:155]
    s_waitcnt vmcnt(11) lgkmcnt(2)
    ds_read_b128 v[48:51], v2 offset:1536
    v_lshrrev_b64 v[16:17], 2, v[26:27]
    v_mfma_f32_16x16x32_bf16 v[156:159], a[64:67], v[60:63], v[156:159]
    ds_read_b128 a[8:11], v8 offset:10240
    v_perm_b32 v18, v16, v26, s40
    v_mfma_f32_16x16x32_bf16 v[156:159], a[68:71], v[68:71], v[156:159]
    s_addk_i32 s56, 128
    v_perm_b32 v19, v16, v26, s41
    v_lshrrev_b64 v[20:21], 4, v[18:19]
    v_mfma_f32_16x16x32_bf16 v[160:163], a[72:75], v[56:59], v[160:163]
    s_addk_i32 m0, 4096
    ds_read_b128 a[12:15], v9 offset:10240
    v_and_or_b32 v18, v18, s44, v1
    v_mfma_f32_16x16x32_bf16 v[160:163], a[76:79], v[64:67], v[160:163]
    buffer_load_dwordx4 v5, s[8:11], s56 offen lds
    v_mfma_f32_16x16x32_bf16 v[164:167], a[72:75], v[60:63], v[164:167]
    ds_read_b128 a[16:19], v8 offset:12288
    v_and_or_b32 v19, v19, s44, v1
    v_mfma_f32_16x16x32_bf16 v[164:167], a[76:79], v[68:71], v[164:167]
    v_and_or_b32 v20, v20, s44, v1
    v_and_or_b32 v21, v21, s44, v1
    v_mfma_f32_16x16x32_bf16 v[168:171], a[80:83], v[56:59], v[168:171]
    s_waitcnt lgkmcnt(2)
    ds_read_b128 a[20:23], v9 offset:12288
    v_perm_b32 v120, v48, v49, v18
    v_mfma_f32_16x16x32_bf16 v[168:171], a[84:87], v[64:67], v[168:171]
    s_addk_i32 s56, 128
    v_perm_b32 v121, v48, v49, v20
    v_perm_b32 v122, v48, v49, v19
    v_mfma_f32_16x16x32_bf16 v[172:175], a[80:83], v[60:63], v[172:175]
    s_addk_i32 m0, 4096
    ds_read_b128 a[24:27], v8 offset:14336
    v_perm_b32 v123, v48, v49, v21
    v_mfma_f32_16x16x32_bf16 v[172:175], a[84:87], v[68:71], v[172:175]
    buffer_load_dwordx4 v5, s[8:11], s56 offen lds
    v_mfma_f32_16x16x32_bf16 v[176:179], a[88:91], v[56:59], v[176:179]
    ds_read_b128 a[28:31], v9 offset:14336
    v_perm_b32 v18, v16, v26, s42
    v_mfma_f32_16x16x32_bf16 v[176:179], a[92:95], v[64:67], v[176:179]
    v_perm_b32 v19, v16, v26, s43
    v_lshrrev_b64 v[20:21], 4, v[18:19]
    v_mfma_f32_16x16x32_bf16 v[180:183], a[88:91], v[60:63], v[180:183]
    ds_read_b128 a[32:35], v8 offset:16384
    v_and_or_b32 v18, v18, s44, v1
    v_mfma_f32_16x16x32_bf16 v[180:183], a[92:95], v[68:71], v[180:183]
    s_mov_b32 s56, 263552
    v_and_or_b32 v19, v19, s44, v1
    v_and_or_b32 v20, v20, s44, v1
    v_mfma_f32_16x16x32_bf16 v[184:187], a[0:3], v[56:59], v[184:187]
    s_addk_i32 m0, 4096
    ds_read_b128 a[36:39], v9 offset:16384
    v_and_or_b32 v21, v21, s44, v1
    v_mfma_f32_16x16x32_bf16 v[184:187], a[4:7], v[64:67], v[184:187]
    buffer_load_dwordx4 v5, s[8:11], s56 offen lds
    v_mfma_f32_16x16x32_bf16 v[188:191], a[0:3], v[60:63], v[188:191]
    ds_read_b128 a[40:43], v8 offset:18432
    v_perm_b32 v128, v48, v49, v18
    v_mfma_f32_16x16x32_bf16 v[188:191], a[4:7], v[68:71], v[188:191]
    v_perm_b32 v129, v48, v49, v20
    v_perm_b32 v130, v48, v49, v19
    v_mfma_f32_16x16x32_bf16 v[192:195], a[8:11], v[56:59], v[192:195]
    s_waitcnt lgkmcnt(2)
    ds_read_b128 a[44:47], v9 offset:18432
    v_perm_b32 v131, v48, v49, v21
    v_mfma_f32_16x16x32_bf16 v[192:195], a[12:15], v[64:67], v[192:195]
    s_addk_i32 s56, 128
    v_perm_b32 v18, v17, v27, s40
    v_perm_b32 v19, v17, v27, s41
    v_mfma_f32_16x16x32_bf16 v[196:199], a[8:11], v[60:63], v[196:199]
    s_addk_i32 m0, 4096
    ds_read_b128 a[48:51], v8 offset:20480
    v_lshrrev_b64 v[20:21], 4, v[18:19]
    v_mfma_f32_16x16x32_bf16 v[196:199], a[12:15], v[68:71], v[196:199]
    buffer_load_dwordx4 v5, s[8:11], s56 offen lds
    v_mfma_f32_16x16x32_bf16 v[200:203], a[16:19], v[56:59], v[200:203]
    ds_read_b128 a[52:55], v9 offset:20480
    v_and_or_b32 v18, v18, s44, v1
    v_mfma_f32_16x16x32_bf16 v[200:203], a[20:23], v[64:67], v[200:203]
    v_and_or_b32 v19, v19, s44, v1
    v_and_or_b32 v20, v20, s44, v1
    v_mfma_f32_16x16x32_bf16 v[204:207], a[16:19], v[60:63], v[204:207]
    ds_read_b128 a[56:59], v8 offset:22528
    v_and_or_b32 v21, v21, s44, v1
    v_mfma_f32_16x16x32_bf16 v[204:207], a[20:23], v[68:71], v[204:207]
    v_perm_b32 v124, v50, v51, v18
    v_perm_b32 v125, v50, v51, v20
    v_mfma_f32_16x16x32_bf16 v[208:211], a[24:27], v[56:59], v[208:211]
    ds_read_b128 a[60:63], v9 offset:22528
    v_perm_b32 v126, v50, v51, v19
    v_mfma_f32_16x16x32_bf16 v[208:211], a[28:31], v[64:67], v[208:211]
    v_perm_b32 v127, v50, v51, v21
    v_perm_b32 v18, v17, v27, s42
    v_mfma_f32_16x16x32_bf16 v[212:215], a[24:27], v[60:63], v[212:215]
    ds_read_b128 a[64:67], v8 offset:24576
    v_perm_b32 v19, v17, v27, s43
    v_mfma_f32_16x16x32_bf16 v[212:215], a[28:31], v[68:71], v[212:215]
    v_lshrrev_b64 v[20:21], 4, v[18:19]
    v_and_or_b32 v18, v18, s44, v1
    v_mfma_f32_16x16x32_bf16 v[216:219], a[32:35], v[56:59], v[216:219]
    s_waitcnt lgkmcnt(2)
    ds_read_b128 a[68:71], v9 offset:24576
    v_and_or_b32 v19, v19, s44, v1
    v_mfma_f32_16x16x32_bf16 v[216:219], a[36:39], v[64:67], v[216:219]
    v_and_or_b32 v20, v20, s44, v1
    v_and_or_b32 v21, v21, s44, v1
    v_mfma_f32_16x16x32_bf16 v[220:223], a[32:35], v[60:63], v[220:223]
    ds_read_b128 a[72:75], v8 offset:28672
    v_perm_b32 v132, v50, v51, v18
    v_mfma_f32_16x16x32_bf16 v[220:223], a[36:39], v[68:71], v[220:223]
    v_perm_b32 v133, v50, v51, v20
    v_perm_b32 v134, v50, v51, v19
    v_mfma_f32_16x16x32_bf16 v[224:227], a[40:43], v[56:59], v[224:227]
    ds_read_b128 a[76:79], v9 offset:28672
    v_perm_b32 v135, v50, v51, v21
    v_mfma_f32_16x16x32_bf16 v[224:227], a[44:47], v[64:67], v[224:227]
    s_waitcnt vmcnt(7) lgkmcnt(2)
    v_lshrrev_b64 v[16:17], 2, v[28:29]
    v_perm_b32 v18, v16, v28, s40
    v_mfma_f32_16x16x32_bf16 v[228:231], a[40:43], v[60:63], v[228:231]
    ds_read_b128 a[80:83], v8 offset:30720
    v_perm_b32 v19, v16, v28, s41
    v_mfma_f32_16x16x32_bf16 v[228:231], a[44:47], v[68:71], v[228:231]
    ds_read_b128 v[52:55], v2 offset:1792
    v_lshrrev_b64 v[20:21], 4, v[18:19]
    v_mfma_f32_16x16x32_bf16 v[232:235], a[48:51], v[56:59], v[232:235]
    ds_read_b128 a[84:87], v9 offset:30720
    v_and_or_b32 v18, v18, s44, v1
    v_mfma_f32_16x16x32_bf16 v[232:235], a[52:55], v[64:67], v[232:235]
    v_and_or_b32 v19, v19, s44, v1
    v_and_or_b32 v20, v20, s44, v1
    v_mfma_f32_16x16x32_bf16 v[236:239], a[48:51], v[60:63], v[236:239]
    ds_read_b128 a[88:91], v8 offset:32768
    v_and_or_b32 v21, v21, s44, v1
    v_mfma_f32_16x16x32_bf16 v[236:239], a[52:55], v[68:71], v[236:239]
    v_mfma_f32_16x16x32_bf16 v[240:243], a[56:59], v[56:59], v[240:243]
    ds_read_b128 a[92:95], v9 offset:32768
    v_mfma_f32_16x16x32_bf16 v[240:243], a[60:63], v[64:67], v[240:243]
    v_mfma_f32_16x16x32_bf16 v[244:247], a[56:59], v[60:63], v[244:247]
    ds_read_b128 a[0:3], v8 offset:34816
    v_mfma_f32_16x16x32_bf16 v[244:247], a[60:63], v[68:71], v[244:247]
    s_addk_i32 s56, 128
    v_mfma_f32_16x16x32_bf16 v[248:251], a[64:67], v[56:59], v[248:251]
    s_waitcnt vmcnt(4) lgkmcnt(2)
    ds_read_b128 a[4:7], v9 offset:34816
    v_perm_b32 v56, v52, v53, v18
    v_mfma_f32_16x16x32_bf16 v[248:251], a[68:71], v[64:67], v[248:251]
    s_barrier
    v_mfma_f32_16x16x32_bf16 v[252:255], a[64:67], v[60:63], v[252:255]
    s_addk_i32 m0, 4096
    ds_read_b128 a[8:11], v8 offset:36864
    v_perm_b32 v57, v52, v53, v20
    v_mfma_f32_16x16x32_bf16 v[252:255], a[68:71], v[68:71], v[252:255]
    buffer_load_dwordx4 v5, s[8:11], s56 offen lds
    v_mfma_f32_16x16x32_bf16 v[136:139], a[72:75], v[72:75], v[136:139]
    ds_read_b128 a[12:15], v9 offset:36864
    v_perm_b32 v58, v52, v53, v19
    v_mfma_f32_16x16x32_bf16 v[136:139], a[76:79], v[80:83], v[136:139]
    v_perm_b32 v59, v52, v53, v21
    v_perm_b32 v18, v16, v28, s42
    v_mfma_f32_16x16x32_bf16 v[140:143], a[72:75], v[76:79], v[140:143]
    ds_read_b128 a[16:19], v8 offset:38912
    v_perm_b32 v19, v16, v28, s43
    v_mfma_f32_16x16x32_bf16 v[140:143], a[76:79], v[84:87], v[140:143]
    s_addk_i32 s56, 128
    v_lshrrev_b64 v[20:21], 4, v[18:19]
    v_and_or_b32 v18, v18, s44, v1
    v_mfma_f32_16x16x32_bf16 v[144:147], a[80:83], v[72:75], v[144:147]
    s_addk_i32 m0, 4096
    ds_read_b128 a[20:23], v9 offset:38912
    v_and_or_b32 v19, v19, s44, v1
    v_mfma_f32_16x16x32_bf16 v[144:147], a[84:87], v[80:83], v[144:147]
    buffer_load_dwordx4 v5, s[8:11], s56 offen lds
    v_mfma_f32_16x16x32_bf16 v[148:151], a[80:83], v[76:79], v[148:151]
    ds_read_b128 a[24:27], v8 offset:40960
    v_and_or_b32 v20, v20, s44, v1
    v_mfma_f32_16x16x32_bf16 v[148:151], a[84:87], v[84:87], v[148:151]
    v_and_or_b32 v21, v21, s44, v1
    v_perm_b32 v64, v52, v53, v18
    v_mfma_f32_16x16x32_bf16 v[136:139], a[88:91], v[88:91], v[136:139]
    s_waitcnt lgkmcnt(2)
    ds_read_b128 a[28:31], v9 offset:40960
    v_perm_b32 v65, v52, v53, v20
    v_mfma_f32_16x16x32_bf16 v[136:139], a[92:95], v[96:99], v[136:139]
    s_addk_i32 s56, 128
    v_perm_b32 v66, v52, v53, v19
    v_perm_b32 v67, v52, v53, v21
    v_mfma_f32_16x16x32_bf16 v[140:143], a[88:91], v[92:95], v[140:143]
    s_addk_i32 m0, 4096
    ds_read_b128 a[32:35], v8 offset:43008
    v_perm_b32 v18, v17, v29, s40
    v_mfma_f32_16x16x32_bf16 v[140:143], a[92:95], v[100:103], v[140:143]
    buffer_load_dwordx4 v5, s[8:11], s56 offen lds
    v_mfma_f32_16x16x32_bf16 v[144:147], a[0:3], v[88:91], v[144:147]
    ds_read_b128 a[36:39], v9 offset:43008
    v_perm_b32 v19, v17, v29, s41
    v_mfma_f32_16x16x32_bf16 v[144:147], a[4:7], v[96:99], v[144:147]
    v_lshrrev_b64 v[20:21], 4, v[18:19]
    v_and_or_b32 v18, v18, s44, v1
    v_mfma_f32_16x16x32_bf16 v[148:151], a[0:3], v[92:95], v[148:151]
    ds_read_b128 a[40:43], v8 offset:45056
    v_and_or_b32 v19, v19, s44, v1
    v_mfma_f32_16x16x32_bf16 v[148:151], a[4:7], v[100:103], v[148:151]
    s_mov_b32 s56, 329088
    v_and_or_b32 v20, v20, s44, v1
    v_and_or_b32 v21, v21, s44, v1
    v_mfma_f32_16x16x32_bf16 v[136:139], a[8:11], v[104:107], v[136:139]
    s_addk_i32 m0, 4096
    ds_read_b128 a[44:47], v9 offset:45056
    v_perm_b32 v60, v54, v55, v18
    v_mfma_f32_16x16x32_bf16 v[136:139], a[12:15], v[112:115], v[136:139]
    buffer_load_dwordx4 v5, s[8:11], s56 offen lds
    v_mfma_f32_16x16x32_bf16 v[140:143], a[8:11], v[108:111], v[140:143]
    ds_read_b128 a[48:51], v8 offset:47104
    v_perm_b32 v61, v54, v55, v20
    v_mfma_f32_16x16x32_bf16 v[140:143], a[12:15], v[116:119], v[140:143]
    v_perm_b32 v62, v54, v55, v19
    v_perm_b32 v63, v54, v55, v21
    v_mfma_f32_16x16x32_bf16 v[144:147], a[16:19], v[104:107], v[144:147]
    s_waitcnt lgkmcnt(2)
    ds_read_b128 a[52:55], v9 offset:47104
    v_perm_b32 v18, v17, v29, s42
    v_mfma_f32_16x16x32_bf16 v[144:147], a[20:23], v[112:115], v[144:147]
    s_addk_i32 s56, 128
    v_perm_b32 v19, v17, v29, s43
    v_lshrrev_b64 v[20:21], 4, v[18:19]
    v_mfma_f32_16x16x32_bf16 v[148:151], a[16:19], v[108:111], v[148:151]
    s_addk_i32 m0, 4096
    ds_read_b128 a[56:59], v8 offset:49152
    v_and_or_b32 v18, v18, s44, v1
    v_mfma_f32_16x16x32_bf16 v[148:151], a[20:23], v[116:119], v[148:151]
    buffer_load_dwordx4 v5, s[8:11], s56 offen lds
    v_mfma_f32_16x16x32_bf16 v[136:139], a[24:27], v[120:123], v[136:139]
    ds_read_b128 a[60:63], v9 offset:49152
    v_and_or_b32 v19, v19, s44, v1
    v_mfma_f32_16x16x32_bf16 v[136:139], a[28:31], v[128:131], v[136:139]
    v_and_or_b32 v20, v20, s44, v1
    v_and_or_b32 v21, v21, s44, v1
    v_mfma_f32_16x16x32_bf16 v[140:143], a[24:27], v[124:127], v[140:143]
    ds_read_b128 a[64:67], v8 offset:53248
    v_perm_b32 v68, v54, v55, v18
    v_mfma_f32_16x16x32_bf16 v[140:143], a[28:31], v[132:135], v[140:143]
    s_addk_i32 s56, 128
    v_perm_b32 v69, v54, v55, v20
    v_perm_b32 v70, v54, v55, v19
    v_mfma_f32_16x16x32_bf16 v[144:147], a[32:35], v[120:123], v[144:147]
    s_addk_i32 m0, 4096
    ds_read_b128 a[68:71], v9 offset:53248
    v_perm_b32 v71, v54, v55, v21
    v_mfma_f32_16x16x32_bf16 v[144:147], a[36:39], v[128:131], v[144:147]
    buffer_load_dwordx4 v5, s[8:11], s56 offen lds
    v_mfma_f32_16x16x32_bf16 v[148:151], a[32:35], v[124:127], v[148:151]
    ds_read_b128 a[72:75], v8 offset:57344
    v_mfma_f32_16x16x32_bf16 v[148:151], a[36:39], v[132:135], v[148:151]
    v_mfma_f32_16x16x32_bf16 v[136:139], a[40:43], v[56:59], v[136:139]
    s_waitcnt lgkmcnt(2)
    ds_read_b128 a[76:79], v9 offset:57344
    v_mfma_f32_16x16x32_bf16 v[136:139], a[44:47], v[64:67], v[136:139]
    s_addk_i32 s56, 128
    v_mfma_f32_16x16x32_bf16 v[140:143], a[40:43], v[60:63], v[140:143]
    s_addk_i32 m0, 4096
    ds_read_b128 a[80:83], v8 offset:61440
    v_mfma_f32_16x16x32_bf16 v[140:143], a[44:47], v[68:71], v[140:143]
    buffer_load_dwordx4 v5, s[8:11], s56 offen lds
    v_mfma_f32_16x16x32_bf16 v[144:147], a[48:51], v[56:59], v[144:147]
    ds_read_b128 a[84:87], v9 offset:61440
    v_mfma_f32_16x16x32_bf16 v[144:147], a[52:55], v[64:67], v[144:147]
    v_mfma_f32_16x16x32_bf16 v[148:151], a[48:51], v[60:63], v[148:151]
    ds_read_b128 a[88:91], v10 offset:0
    v_mfma_f32_16x16x32_bf16 v[148:151], a[52:55], v[68:71], v[148:151]
    s_addk_i32 s56, 128
    v_mfma_f32_16x16x32_bf16 v[152:155], a[56:59], v[72:75], v[152:155]
    s_addk_i32 m0, 4096
    ds_read_b128 a[92:95], v11 offset:0
    v_mfma_f32_16x16x32_bf16 v[152:155], a[60:63], v[80:83], v[152:155]
    buffer_load_dwordx4 v5, s[8:11], s56 offen lds
    v_mfma_f32_16x16x32_bf16 v[152:155], a[64:67], v[88:91], v[152:155]
    s_waitcnt lgkmcnt(2)
    ds_read_b128 a[0:3], v8 offset:51200
    v_mfma_f32_16x16x32_bf16 v[152:155], a[68:71], v[96:99], v[152:155]
    v_mfma_f32_16x16x32_bf16 v[152:155], a[72:75], v[104:107], v[152:155]
    ds_read_b128 a[4:7], v9 offset:51200
    v_mfma_f32_16x16x32_bf16 v[152:155], a[76:79], v[112:115], v[152:155]
    s_mov_b32 s56, 394624
    v_mfma_f32_16x16x32_bf16 v[152:155], a[80:83], v[120:123], v[152:155]
    s_waitcnt lgkmcnt(2)
    s_addk_i32 m0, 4096
    ds_read_b128 a[8:11], v8 offset:55296
    v_mfma_f32_16x16x32_bf16 v[152:155], a[84:87], v[128:131], v[152:155]
    buffer_load_dwordx4 v5, s[8:11], s56 offen lds
    v_mfma_f32_16x16x32_bf16 v[152:155], a[88:91], v[56:59], v[152:155]
    s_movk_i32 s58, 0
    ds_read_b128 a[12:15], v9 offset:55296
    v_cvt_pk_bf16_f32 v136, v136, v140
    v_mfma_f32_16x16x32_bf16 v[152:155], a[92:95], v[64:67], v[152:155]
    buffer_store_dword v136, v4, s[24:27], s58 offen sc1 nt
    v_mfma_f32_16x16x32_bf16 v[156:159], a[56:59], v[76:79], v[156:159]
    ds_read_b128 a[16:19], v8 offset:59392
    v_mfma_f32_16x16x32_bf16 v[156:159], a[60:63], v[84:87], v[156:159]
    s_addk_i32 s56, 128
    v_mfma_f32_16x16x32_bf16 v[156:159], a[64:67], v[92:95], v[156:159]
    s_add_u32 m0, s47, 0
    ds_read_b128 a[20:23], v9 offset:59392
    v_mfma_f32_16x16x32_bf16 v[156:159], a[68:71], v[100:103], v[156:159]
    buffer_load_dwordx4 v5, s[8:11], s56 offen lds
    v_mfma_f32_16x16x32_bf16 v[156:159], a[72:75], v[108:111], v[156:159]
    s_addk_i32 s58, 7168
    ds_read_b128 a[24:27], v8 offset:63488
    v_cvt_pk_bf16_f32 v137, v137, v141
    v_mfma_f32_16x16x32_bf16 v[156:159], a[76:79], v[116:119], v[156:159]
    buffer_store_dword v137, v4, s[24:27], s58 offen sc1 nt
    v_mfma_f32_16x16x32_bf16 v[156:159], a[80:83], v[124:127], v[156:159]
    ds_read_b128 a[28:31], v9 offset:63488
    v_mfma_f32_16x16x32_bf16 v[156:159], a[84:87], v[132:135], v[156:159]
    s_addk_i32 s56, 128
    v_mfma_f32_16x16x32_bf16 v[156:159], a[88:91], v[60:63], v[156:159]
    s_waitcnt lgkmcnt(2)
    s_addk_i32 m0, 4096
    ds_read_b128 a[32:35], v10 offset:2048
    v_mfma_f32_16x16x32_bf16 v[156:159], a[92:95], v[68:71], v[156:159]
    buffer_load_dwordx4 v5, s[8:11], s56 offen lds
    v_mfma_f32_16x16x32_bf16 v[160:163], a[0:3], v[72:75], v[160:163]
    s_addk_i32 s58, 7168
    ds_read_b128 a[36:39], v11 offset:2048
    v_cvt_pk_bf16_f32 v138, v138, v142
    v_mfma_f32_16x16x32_bf16 v[160:163], a[4:7], v[80:83], v[160:163]
    buffer_store_dword v138, v4, s[24:27], s58 offen sc1 nt
    v_mfma_f32_16x16x32_bf16 v[160:163], a[8:11], v[88:91], v[160:163]
    ds_read_b128 a[40:43], v10 offset:4096
    v_mfma_f32_16x16x32_bf16 v[160:163], a[12:15], v[96:99], v[160:163]
    s_addk_i32 s56, 128
    v_mfma_f32_16x16x32_bf16 v[160:163], a[16:19], v[104:107], v[160:163]
    s_waitcnt lgkmcnt(2)
    s_addk_i32 m0, 4096
    ds_read_b128 a[44:47], v11 offset:4096
    v_mfma_f32_16x16x32_bf16 v[160:163], a[20:23], v[112:115], v[160:163]
    buffer_load_dwordx4 v5, s[8:11], s56 offen lds
    v_mfma_f32_16x16x32_bf16 v[160:163], a[24:27], v[120:123], v[160:163]
    s_addk_i32 s58, 7168
    ds_read_b128 a[48:51], v10 offset:8192
    v_cvt_pk_bf16_f32 v139, v139, v143
    v_mfma_f32_16x16x32_bf16 v[160:163], a[28:31], v[128:131], v[160:163]
    buffer_store_dword v139, v4, s[24:27], s58 offen sc1 nt
    v_mfma_f32_16x16x32_bf16 v[160:163], a[32:35], v[56:59], v[160:163]
    s_waitcnt lgkmcnt(2)
    ds_read_b128 a[52:55], v11 offset:8192
    v_mfma_f32_16x16x32_bf16 v[160:163], a[36:39], v[64:67], v[160:163]
    s_addk_i32 s56, 128
    v_mfma_f32_16x16x32_bf16 v[164:167], a[0:3], v[76:79], v[164:167]
    s_addk_i32 m0, 4096
    ds_read_b128 a[56:59], v10 offset:12288
    v_mfma_f32_16x16x32_bf16 v[164:167], a[4:7], v[84:87], v[164:167]
    buffer_load_dwordx4 v5, s[8:11], s56 offen lds
    v_mfma_f32_16x16x32_bf16 v[164:167], a[8:11], v[92:95], v[164:167]
    s_add_u32 s58, s58, s63
    ds_read_b128 a[60:63], v11 offset:12288
    v_cvt_pk_bf16_f32 v144, v144, v148
    v_mfma_f32_16x16x32_bf16 v[164:167], a[12:15], v[100:103], v[164:167]
    buffer_store_dword v144, v4, s[24:27], s58 offen sc1 nt
    v_mfma_f32_16x16x32_bf16 v[164:167], a[16:19], v[108:111], v[164:167]
    ds_read_b128 a[64:67], v10 offset:16384
    v_mfma_f32_16x16x32_bf16 v[164:167], a[20:23], v[116:119], v[164:167]
    s_mov_b32 s56, 460160
    v_mfma_f32_16x16x32_bf16 v[164:167], a[24:27], v[124:127], v[164:167]
    s_addk_i32 m0, 4096
    ds_read_b128 a[68:71], v11 offset:16384
    v_mfma_f32_16x16x32_bf16 v[164:167], a[28:31], v[132:135], v[164:167]
    buffer_load_dwordx4 v6, s[8:11], s56 offen lds
    v_mfma_f32_16x16x32_bf16 v[164:167], a[32:35], v[60:63], v[164:167]
    s_addk_i32 s58, 7168
    ds_read_b128 a[72:75], v10 offset:20480
    v_cvt_pk_bf16_f32 v145, v145, v149
    v_mfma_f32_16x16x32_bf16 v[164:167], a[36:39], v[68:71], v[164:167]
    buffer_store_dword v145, v4, s[24:27], s58 offen sc1 nt
    v_mfma_f32_16x16x32_bf16 v[168:171], a[40:43], v[72:75], v[168:171]
    s_waitcnt lgkmcnt(2)
    ds_read_b128 a[76:79], v11 offset:20480
    v_mfma_f32_16x16x32_bf16 v[168:171], a[44:47], v[80:83], v[168:171]
    s_addk_i32 s56, 256
    v_mfma_f32_16x16x32_bf16 v[168:171], a[48:51], v[88:91], v[168:171]
    s_addk_i32 m0, 4096
    ds_read_b128 a[80:83], v10 offset:6144
    v_mfma_f32_16x16x32_bf16 v[168:171], a[52:55], v[96:99], v[168:171]
    buffer_load_dwordx4 v6, s[8:11], s56 offen lds
    v_mfma_f32_16x16x32_bf16 v[168:171], a[56:59], v[104:107], v[168:171]
    s_addk_i32 s58, 7168
    ds_read_b128 a[84:87], v11 offset:6144
    v_cvt_pk_bf16_f32 v146, v146, v150
    v_mfma_f32_16x16x32_bf16 v[168:171], a[60:63], v[112:115], v[168:171]
    buffer_store_dword v146, v4, s[24:27], s58 offen sc1 nt
    v_mfma_f32_16x16x32_bf16 v[168:171], a[64:67], v[120:123], v[168:171]
    s_waitcnt lgkmcnt(2)
    ds_read_b128 a[88:91], v10 offset:10240
    v_mfma_f32_16x16x32_bf16 v[168:171], a[68:71], v[128:131], v[168:171]
    s_addk_i32 s56, 256
    v_mfma_f32_16x16x32_bf16 v[168:171], a[72:75], v[56:59], v[168:171]
    s_addk_i32 m0, 4096
    ds_read_b128 a[92:95], v11 offset:10240
    v_mfma_f32_16x16x32_bf16 v[168:171], a[76:79], v[64:67], v[168:171]
    buffer_load_dwordx4 v6, s[8:11], s56 offen lds
    v_mfma_f32_16x16x32_bf16 v[172:175], a[40:43], v[76:79], v[172:175]
    s_addk_i32 s58, 7168
    ds_read_b128 a[0:3], v10 offset:14336
    v_cvt_pk_bf16_f32 v147, v147, v151
    v_mfma_f32_16x16x32_bf16 v[172:175], a[44:47], v[84:87], v[172:175]
    buffer_store_dword v147, v4, s[24:27], s58 offen sc1 nt
    v_mfma_f32_16x16x32_bf16 v[172:175], a[48:51], v[92:95], v[172:175]
    s_add_u32 s58, s58, s63
    ds_read_b128 a[4:7], v11 offset:14336
    v_cvt_pk_bf16_f32 v152, v152, v156
    v_mfma_f32_16x16x32_bf16 v[172:175], a[52:55], v[100:103], v[172:175]
    buffer_store_dword v152, v4, s[24:27], s58 offen sc1 nt
    v_mfma_f32_16x16x32_bf16 v[172:175], a[56:59], v[108:111], v[172:175]
    ds_read_b128 a[8:11], v10 offset:18432
    v_mfma_f32_16x16x32_bf16 v[172:175], a[60:63], v[116:119], v[172:175]
    v_mfma_f32_16x16x32_bf16 v[172:175], a[64:67], v[124:127], v[172:175]
    s_addk_i32 s58, 7168
    ds_read_b128 a[12:15], v11 offset:18432
    v_cvt_pk_bf16_f32 v153, v153, v157
    v_mfma_f32_16x16x32_bf16 v[172:175], a[68:71], v[132:135], v[172:175]
    buffer_store_dword v153, v4, s[24:27], s58 offen sc1 nt
    v_mfma_f32_16x16x32_bf16 v[172:175], a[72:75], v[60:63], v[172:175]
    ds_read_b128 a[16:19], v10 offset:22528
    v_mfma_f32_16x16x32_bf16 v[172:175], a[76:79], v[68:71], v[172:175]
    s_waitcnt lgkmcnt(2)
    v_mfma_f32_16x16x32_bf16 v[176:179], a[80:83], v[72:75], v[176:179]
    s_addk_i32 s58, 7168
    ds_read_b128 a[20:23], v11 offset:22528
    v_cvt_pk_bf16_f32 v154, v154, v158
    v_mfma_f32_16x16x32_bf16 v[176:179], a[84:87], v[80:83], v[176:179]
    buffer_store_dword v154, v4, s[24:27], s58 offen sc1 nt
    v_mfma_f32_16x16x32_bf16 v[176:179], a[88:91], v[88:91], v[176:179]
    ds_read_b128 a[24:27], v10 offset:24576
    v_mfma_f32_16x16x32_bf16 v[176:179], a[92:95], v[96:99], v[176:179]
    v_mfma_f32_16x16x32_bf16 v[176:179], a[0:3], v[104:107], v[176:179]
    s_addk_i32 s58, 7168
    ds_read_b128 a[28:31], v11 offset:24576
    v_cvt_pk_bf16_f32 v155, v155, v159
    v_mfma_f32_16x16x32_bf16 v[176:179], a[4:7], v[112:115], v[176:179]
    buffer_store_dword v155, v4, s[24:27], s58 offen sc1 nt
    v_mfma_f32_16x16x32_bf16 v[176:179], a[8:11], v[120:123], v[176:179]
    s_waitcnt lgkmcnt(2)
    ds_read_b128 a[32:35], v10 offset:28672
    v_mfma_f32_16x16x32_bf16 v[176:179], a[12:15], v[128:131], v[176:179]
    v_mfma_f32_16x16x32_bf16 v[176:179], a[16:19], v[56:59], v[176:179]
    ds_read_b128 a[36:39], v11 offset:28672
    v_mfma_f32_16x16x32_bf16 v[176:179], a[20:23], v[64:67], v[176:179]
    v_mfma_f32_16x16x32_bf16 v[180:183], a[80:83], v[76:79], v[180:183]
    s_add_u32 s58, s58, s63
    ds_read_b128 a[40:43], v10 offset:32768
    v_cvt_pk_bf16_f32 v160, v160, v164
    v_mfma_f32_16x16x32_bf16 v[180:183], a[84:87], v[84:87], v[180:183]
    buffer_store_dword v160, v4, s[24:27], s58 offen sc1 nt
    v_mfma_f32_16x16x32_bf16 v[180:183], a[88:91], v[92:95], v[180:183]
    s_waitcnt vmcnt(21) lgkmcnt(2)
    ds_read_b128 a[44:47], v11 offset:32768
    v_mfma_f32_16x16x32_bf16 v[180:183], a[92:95], v[100:103], v[180:183]
    s_barrier
    v_mfma_f32_16x16x32_bf16 v[180:183], a[0:3], v[108:111], v[180:183]
    s_addk_i32 s58, 7168
    ds_read_b128 a[48:51], v10 offset:36864
    v_cvt_pk_bf16_f32 v161, v161, v165
    v_mfma_f32_16x16x32_bf16 v[180:183], a[4:7], v[116:119], v[180:183]
    buffer_store_dword v161, v4, s[24:27], s58 offen sc1 nt
    v_mfma_f32_16x16x32_bf16 v[180:183], a[8:11], v[124:127], v[180:183]
    ds_read_b128 a[52:55], v11 offset:36864
    v_mfma_f32_16x16x32_bf16 v[180:183], a[12:15], v[132:135], v[180:183]
    v_mfma_f32_16x16x32_bf16 v[180:183], a[16:19], v[60:63], v[180:183]
    s_addk_i32 s58, 7168
    ds_read_b128 a[56:59], v10 offset:40960
    v_cvt_pk_bf16_f32 v162, v162, v166
    v_mfma_f32_16x16x32_bf16 v[180:183], a[20:23], v[68:71], v[180:183]
    buffer_store_dword v162, v4, s[24:27], s58 offen sc1 nt
    v_mfma_f32_16x16x32_bf16 v[184:187], a[24:27], v[72:75], v[184:187]
    ds_read_b128 a[60:63], v11 offset:40960
    v_mfma_f32_16x16x32_bf16 v[184:187], a[28:31], v[80:83], v[184:187]
    s_waitcnt lgkmcnt(2)
    v_mfma_f32_16x16x32_bf16 v[184:187], a[32:35], v[88:91], v[184:187]
    s_addk_i32 s58, 7168
    ds_read_b128 a[64:67], v10 offset:26624
    v_cvt_pk_bf16_f32 v163, v163, v167
    v_mfma_f32_16x16x32_bf16 v[184:187], a[36:39], v[96:99], v[184:187]
    buffer_store_dword v163, v4, s[24:27], s58 offen sc1 nt
    v_mfma_f32_16x16x32_bf16 v[184:187], a[40:43], v[104:107], v[184:187]
    ds_read_b128 a[68:71], v11 offset:26624
    v_mfma_f32_16x16x32_bf16 v[184:187], a[44:47], v[112:115], v[184:187]
    s_waitcnt lgkmcnt(2)
    v_mfma_f32_16x16x32_bf16 v[184:187], a[48:51], v[120:123], v[184:187]
    s_add_u32 s58, s58, s63
    ds_read_b128 a[72:75], v10 offset:30720
    v_cvt_pk_bf16_f32 v168, v168, v172
    v_mfma_f32_16x16x32_bf16 v[184:187], a[52:55], v[128:131], v[184:187]
    buffer_store_dword v168, v4, s[24:27], s58 offen sc1 nt
    v_mfma_f32_16x16x32_bf16 v[184:187], a[56:59], v[56:59], v[184:187]
    ds_read_b128 a[76:79], v11 offset:30720
    v_mfma_f32_16x16x32_bf16 v[184:187], a[60:63], v[64:67], v[184:187]
    v_mfma_f32_16x16x32_bf16 v[188:191], a[24:27], v[76:79], v[188:191]
    s_addk_i32 s58, 7168
    ds_read_b128 a[80:83], v10 offset:34816
    v_cvt_pk_bf16_f32 v169, v169, v173
    v_mfma_f32_16x16x32_bf16 v[188:191], a[28:31], v[84:87], v[188:191]
    buffer_store_dword v169, v4, s[24:27], s58 offen sc1 nt
    v_mfma_f32_16x16x32_bf16 v[188:191], a[32:35], v[92:95], v[188:191]
    ds_read_b128 a[84:87], v11 offset:34816
    v_mfma_f32_16x16x32_bf16 v[188:191], a[36:39], v[100:103], v[188:191]
    v_mfma_f32_16x16x32_bf16 v[188:191], a[40:43], v[108:111], v[188:191]
    s_addk_i32 s58, 7168
    ds_read_b128 a[88:91], v10 offset:38912
    v_cvt_pk_bf16_f32 v170, v170, v174
    v_mfma_f32_16x16x32_bf16 v[188:191], a[44:47], v[116:119], v[188:191]
    buffer_store_dword v170, v4, s[24:27], s58 offen sc1 nt
    v_mfma_f32_16x16x32_bf16 v[188:191], a[48:51], v[124:127], v[188:191]
    ds_read_b128 a[92:95], v11 offset:38912
    v_mfma_f32_16x16x32_bf16 v[188:191], a[52:55], v[132:135], v[188:191]
    s_waitcnt lgkmcnt(2)
    v_mfma_f32_16x16x32_bf16 v[188:191], a[56:59], v[60:63], v[188:191]
    s_addk_i32 s58, 7168
    ds_read_b128 a[0:3], v10 offset:43008
    v_cvt_pk_bf16_f32 v171, v171, v175
    v_mfma_f32_16x16x32_bf16 v[188:191], a[60:63], v[68:71], v[188:191]
    buffer_store_dword v171, v4, s[24:27], s58 offen sc1 nt
    v_mfma_f32_16x16x32_bf16 v[192:195], a[64:67], v[72:75], v[192:195]
    ds_read_b128 a[4:7], v11 offset:43008
    v_mfma_f32_16x16x32_bf16 v[192:195], a[68:71], v[80:83], v[192:195]
    v_mfma_f32_16x16x32_bf16 v[192:195], a[72:75], v[88:91], v[192:195]
    ds_read_b128 a[8:11], v10 offset:45056
    v_mfma_f32_16x16x32_bf16 v[192:195], a[76:79], v[96:99], v[192:195]
    s_waitcnt lgkmcnt(2)
    v_mfma_f32_16x16x32_bf16 v[192:195], a[80:83], v[104:107], v[192:195]
    s_add_u32 s58, s58, s63
    ds_read_b128 a[12:15], v11 offset:45056
    v_cvt_pk_bf16_f32 v176, v176, v180
    v_mfma_f32_16x16x32_bf16 v[192:195], a[84:87], v[112:115], v[192:195]
    buffer_store_dword v176, v4, s[24:27], s58 offen sc1 nt
    v_mfma_f32_16x16x32_bf16 v[192:195], a[88:91], v[120:123], v[192:195]
    ds_read_b128 a[16:19], v10 offset:49152
    v_mfma_f32_16x16x32_bf16 v[192:195], a[92:95], v[128:131], v[192:195]
    s_waitcnt lgkmcnt(2)
    v_mfma_f32_16x16x32_bf16 v[192:195], a[0:3], v[56:59], v[192:195]
    s_addk_i32 s58, 7168
    ds_read_b128 a[20:23], v11 offset:49152
    v_cvt_pk_bf16_f32 v177, v177, v181
    v_mfma_f32_16x16x32_bf16 v[192:195], a[4:7], v[64:67], v[192:195]
    buffer_store_dword v177, v4, s[24:27], s58 offen sc1 nt
    v_mfma_f32_16x16x32_bf16 v[196:199], a[64:67], v[76:79], v[196:199]
    ds_read_b128 a[24:27], v10 offset:53248
    v_mfma_f32_16x16x32_bf16 v[196:199], a[68:71], v[84:87], v[196:199]
L_hopA5:
    s_cbranch_execz L_hopret
    v_mfma_f32_16x16x32_bf16 v[196:199], a[72:75], v[92:95], v[196:199]
    s_addk_i32 s58, 7168
    ds_read_b128 a[28:31], v11 offset:53248
    v_cvt_pk_bf16_f32 v178, v178, v182
    v_mfma_f32_16x16x32_bf16 v[196:199], a[76:79], v[100:103], v[196:199]
    buffer_store_dword v178, v4, s[24:27], s58 offen sc1 nt
    v_mfma_f32_16x16x32_bf16 v[196:199], a[80:83], v[108:111], v[196:199]
    ds_read_b128 a[32:35], v10 offset:57344
    v_mfma_f32_16x16x32_bf16 v[196:199], a[84:87], v[116:119], v[196:199]
    v_mfma_f32_16x16x32_bf16 v[196:199], a[88:91], v[124:127], v[196:199]
    s_addk_i32 s58, 7168
    ds_read_b128 a[36:39], v11 offset:57344
    v_cvt_pk_bf16_f32 v179, v179, v183
    v_mfma_f32_16x16x32_bf16 v[196:199], a[92:95], v[132:135], v[196:199]
    buffer_store_dword v179, v4, s[24:27], s58 offen sc1 nt
    v_mfma_f32_16x16x32_bf16 v[196:199], a[0:3], v[60:63], v[196:199]
    ds_read_b128 a[40:43], v10 offset:61440
    v_mfma_f32_16x16x32_bf16 v[196:199], a[4:7], v[68:71], v[196:199]
    s_waitcnt lgkmcnt(2)
    v_mfma_f32_16x16x32_bf16 v[200:203], a[8:11], v[72:75], v[200:203]
    s_add_u32 s58, s58, s63
    ds_read_b128 a[44:47], v11 offset:61440
    v_cvt_pk_bf16_f32 v184, v184, v188
    v_mfma_f32_16x16x32_bf16 v[200:203], a[12:15], v[80:83], v[200:203]
    buffer_store_dword v184, v4, s[24:27], s58 offen sc1 nt
    v_mfma_f32_16x16x32_bf16 v[200:203], a[16:19], v[88:91], v[200:203]
    ds_read_b128 a[48:51], v10 offset:47104
    v_mfma_f32_16x16x32_bf16 v[200:203], a[20:23], v[96:99], v[200:203]
    v_mfma_f32_16x16x32_bf16 v[200:203], a[24:27], v[104:107], v[200:203]
    s_addk_i32 s58, 7168
    ds_read_b128 a[52:55], v11 offset:47104
    v_cvt_pk_bf16_f32 v185, v185, v189
    v_mfma_f32_16x16x32_bf16 v[200:203], a[28:31], v[112:115], v[200:203]
    buffer_store_dword v185, v4, s[24:27], s58 offen sc1 nt
    v_mfma_f32_16x16x32_bf16 v[200:203], a[32:35], v[120:123], v[200:203]
    s_waitcnt lgkmcnt(2)
    ds_read_b128 a[56:59], v10 offset:51200
    v_mfma_f32_16x16x32_bf16 v[200:203], a[36:39], v[128:131], v[200:203]
    v_mfma_f32_16x16x32_bf16 v[200:203], a[40:43], v[56:59], v[200:203]
    s_addk_i32 s58, 7168
    ds_read_b128 a[60:63], v11 offset:51200
    v_cvt_pk_bf16_f32 v186, v186, v190
    v_mfma_f32_16x16x32_bf16 v[200:203], a[44:47], v[64:67], v[200:203]
    buffer_store_dword v186, v4, s[24:27], s58 offen sc1 nt
    v_mfma_f32_16x16x32_bf16 v[204:207], a[8:11], v[76:79], v[204:207]
    ds_read_b128 a[64:67], v10 offset:55296
    v_mfma_f32_16x16x32_bf16 v[204:207], a[12:15], v[84:87], v[204:207]
    v_mfma_f32_16x16x32_bf16 v[204:207], a[16:19], v[92:95], v[204:207]
    s_addk_i32 s58, 7168
    ds_read_b128 a[68:71], v11 offset:55296
    v_cvt_pk_bf16_f32 v187, v187, v191
    v_mfma_f32_16x16x32_bf16 v[204:207], a[20:23], v[100:103], v[204:207]
    buffer_store_dword v187, v4, s[24:27], s58 offen sc1 nt
    v_mfma_f32_16x16x32_bf16 v[204:207], a[24:27], v[108:111], v[204:207]
    ds_read_b128 a[72:75], v10 offset:59392
    v_mfma_f32_16x16x32_bf16 v[204:207], a[28:31], v[116:119], v[204:207]
    v_mfma_f32_16x16x32_bf16 v[204:207], a[32:35], v[124:127], v[204:207]
    ds_read_b128 a[76:79], v11 offset:59392
    v_mfma_f32_16x16x32_bf16 v[204:207], a[36:39], v[132:135], v[204:207]
    s_waitcnt lgkmcnt(2)
    v_mfma_f32_16x16x32_bf16 v[204:207], a[40:43], v[60:63], v[204:207]
    s_add_u32 s58, s58, s63
    ds_read_b128 a[80:83], v10 offset:63488
    v_cvt_pk_bf16_f32 v192, v192, v196
    v_mfma_f32_16x16x32_bf16 v[204:207], a[44:47], v[68:71], v[204:207]
    buffer_store_dword v192, v4, s[24:27], s58 offen sc1 nt
    v_mfma_f32_16x16x32_bf16 v[208:211], a[48:51], v[72:75], v[208:211]
    ds_read_b128 a[84:87], v11 offset:63488
    v_mfma_f32_16x16x32_bf16 v[208:211], a[52:55], v[80:83], v[208:211]
    v_mfma_f32_16x16x32_bf16 v[208:211], a[56:59], v[88:91], v[208:211]
    s_addk_i32 s58, 7168
    ds_read_b128 a[88:91], v12 offset:0
    v_cvt_pk_bf16_f32 v193, v193, v197
    v_mfma_f32_16x16x32_bf16 v[208:211], a[60:63], v[96:99], v[208:211]
    buffer_store_dword v193, v4, s[24:27], s58 offen sc1 nt
    v_mfma_f32_16x16x32_bf16 v[208:211], a[64:67], v[104:107], v[208:211]
    ds_read_b128 a[92:95], v13 offset:0
    v_mfma_f32_16x16x32_bf16 v[208:211], a[68:71], v[112:115], v[208:211]
    s_waitcnt lgkmcnt(2)
    v_mfma_f32_16x16x32_bf16 v[208:211], a[72:75], v[120:123], v[208:211]
    s_addk_i32 s58, 7168
    ds_read_b128 a[0:3], v12 offset:4096
    v_cvt_pk_bf16_f32 v194, v194, v198
    v_mfma_f32_16x16x32_bf16 v[208:211], a[76:79], v[128:131], v[208:211]
    buffer_store_dword v194, v4, s[24:27], s58 offen sc1 nt
    v_mfma_f32_16x16x32_bf16 v[208:211], a[80:83], v[56:59], v[208:211]
    ds_read_b128 a[4:7], v13 offset:4096
    v_mfma_f32_16x16x32_bf16 v[208:211], a[84:87], v[64:67], v[208:211]
    v_mfma_f32_16x16x32_bf16 v[212:215], a[48:51], v[76:79], v[212:215]
    s_addk_i32 s58, 7168
    ds_read_b128 a[8:11], v12 offset:8192
    v_cvt_pk_bf16_f32 v195, v195, v199
    v_mfma_f32_16x16x32_bf16 v[212:215], a[52:55], v[84:87], v[212:215]
    buffer_store_dword v195, v4, s[24:27], s58 offen sc1 nt
    v_mfma_f32_16x16x32_bf16 v[212:215], a[56:59], v[92:95], v[212:215]
    ds_read_b128 a[12:15], v13 offset:8192
    v_mfma_f32_16x16x32_bf16 v[212:215], a[60:63], v[100:103], v[212:215]
    v_mfma_f32_16x16x32_bf16 v[212:215], a[64:67], v[108:111], v[212:215]
    s_add_u32 s58, s58, s63
    ds_read_b128 a[16:19], v12 offset:12288
    v_cvt_pk_bf16_f32 v200, v200, v204
    v_mfma_f32_16x16x32_bf16 v[212:215], a[68:71], v[116:119], v[212:215]
    buffer_store_dword v200, v4, s[24:27], s58 offen sc1 nt
    v_mfma_f32_16x16x32_bf16 v[212:215], a[72:75], v[124:127], v[212:215]
    ds_read_b128 a[20:23], v13 offset:12288
    v_mfma_f32_16x16x32_bf16 v[212:215], a[76:79], v[132:135], v[212:215]
    s_waitcnt lgkmcnt(2)
    v_mfma_f32_16x16x32_bf16 v[212:215], a[80:83], v[60:63], v[212:215]
    s_addk_i32 s58, 7168
    ds_read_b128 a[24:27], v12 offset:16384
    v_cvt_pk_bf16_f32 v201, v201, v205
    v_mfma_f32_16x16x32_bf16 v[212:215], a[84:87], v[68:71], v[212:215]
    buffer_store_dword v201, v4, s[24:27], s58 offen sc1 nt
    v_mfma_f32_16x16x32_bf16 v[216:219], a[88:91], v[72:75], v[216:219]
    ds_read_b128 a[28:31], v13 offset:16384
    v_mfma_f32_16x16x32_bf16 v[216:219], a[92:95], v[80:83], v[216:219]
    v_mfma_f32_16x16x32_bf16 v[216:219], a[0:3], v[88:91], v[216:219]
    s_addk_i32 s58, 7168
    ds_read_b128 a[32:35], v12 offset:2048
    v_cvt_pk_bf16_f32 v202, v202, v206
    v_mfma_f32_16x16x32_bf16 v[216:219], a[4:7], v[96:99], v[216:219]
    buffer_store_dword v202, v4, s[24:27], s58 offen sc1 nt
    v_mfma_f32_16x16x32_bf16 v[216:219], a[8:11], v[104:107], v[216:219]
    ds_read_b128 a[36:39], v13 offset:2048
    v_mfma_f32_16x16x32_bf16 v[216:219], a[12:15], v[112:115], v[216:219]
    s_waitcnt lgkmcnt(2)
    v_mfma_f32_16x16x32_bf16 v[216:219], a[16:19], v[120:123], v[216:219]
    s_addk_i32 s58, 7168
    ds_read_b128 a[40:43], v12 offset:6144
    v_cvt_pk_bf16_f32 v203, v203, v207
    v_mfma_f32_16x16x32_bf16 v[216:219], a[20:23], v[128:131], v[216:219]
    buffer_store_dword v203, v4, s[24:27], s58 offen sc1 nt
    v_mfma_f32_16x16x32_bf16 v[216:219], a[24:27], v[56:59], v[216:219]
    ds_read_b128 a[44:47], v13 offset:6144
    v_mfma_f32_16x16x32_bf16 v[216:219], a[28:31], v[64:67], v[216:219]
    v_mfma_f32_16x16x32_bf16 v[220:223], a[88:91], v[76:79], v[220:223]
    ds_read_b128 a[48:51], v12 offset:10240
    v_mfma_f32_16x16x32_bf16 v[220:223], a[92:95], v[84:87], v[220:223]
    v_mfma_f32_16x16x32_bf16 v[220:223], a[0:3], v[92:95], v[220:223]
    s_add_u32 s58, s58, s63
    ds_read_b128 a[52:55], v13 offset:10240
    v_cvt_pk_bf16_f32 v208, v208, v212
    v_mfma_f32_16x16x32_bf16 v[220:223], a[4:7], v[100:103], v[220:223]
    buffer_store_dword v208, v4, s[24:27], s58 offen sc1 nt
    v_mfma_f32_16x16x32_bf16 v[220:223], a[8:11], v[108:111], v[220:223]
    ds_read_b128 a[56:59], v12 offset:14336
    v_mfma_f32_16x16x32_bf16 v[220:223], a[12:15], v[116:119], v[220:223]
    v_mfma_f32_16x16x32_bf16 v[220:223], a[16:19], v[124:127], v[220:223]
    s_addk_i32 s58, 7168
    ds_read_b128 a[60:63], v13 offset:14336
    v_cvt_pk_bf16_f32 v209, v209, v213
    v_mfma_f32_16x16x32_bf16 v[220:223], a[20:23], v[132:135], v[220:223]
    buffer_store_dword v209, v4, s[24:27], s58 offen sc1 nt
    v_mfma_f32_16x16x32_bf16 v[220:223], a[24:27], v[60:63], v[220:223]
    ds_read_b128 a[64:67], v12 offset:18432
    v_mfma_f32_16x16x32_bf16 v[220:223], a[28:31], v[68:71], v[220:223]
    s_waitcnt lgkmcnt(2)
    v_mfma_f32_16x16x32_bf16 v[224:227], a[32:35], v[72:75], v[224:227]
    s_waitcnt vmcnt(31)
    ds_read_b128 a[68:71], v13 offset:18432
    v_mfma_f32_16x16x32_bf16 v[224:227], a[36:39], v[80:83], v[224:227]
    s_barrier
    v_mfma_f32_16x16x32_bf16 v[224:227], a[40:43], v[88:91], v[224:227]
    s_addk_i32 s58, 7168
    ds_read_b128 a[72:75], v12 offset:20480
    v_cvt_pk_bf16_f32 v210, v210, v214
    v_mfma_f32_16x16x32_bf16 v[224:227], a[44:47], v[96:99], v[224:227]
    buffer_store_dword v210, v4, s[24:27], s58 offen sc1 nt
    v_mfma_f32_16x16x32_bf16 v[224:227], a[48:51], v[104:107], v[224:227]
    s_addk_i32 s58, 7168
    ds_read_b128 a[76:79], v13 offset:20480
    v_cvt_pk_bf16_f32 v211, v211, v215
    v_mfma_f32_16x16x32_bf16 v[224:227], a[52:55], v[112:115], v[224:227]
    buffer_store_dword v211, v4, s[24:27], s58 offen sc1 nt
    v_mfma_f32_16x16x32_bf16 v[224:227], a[56:59], v[120:123], v[224:227]
    s_waitcnt lgkmcnt(2)
    ds_read_b128 a[80:83], v8 offset:0
    v_mfma_f32_16x16x32_bf16 v[224:227], a[60:63], v[128:131], v[224:227]
    v_mfma_f32_16x16x32_bf16 v[224:227], a[64:67], v[56:59], v[224:227]
    s_add_u32 s58, s58, s63
    ds_read_b128 a[84:87], v9 offset:0
    v_cvt_pk_bf16_f32 v216, v216, v220
    v_mfma_f32_16x16x32_bf16 v[224:227], a[68:71], v[64:67], v[224:227]
    buffer_store_dword v216, v4, s[24:27], s58 offen sc1 nt
    v_mfma_f32_16x16x32_bf16 v[228:231], a[32:35], v[76:79], v[228:231]
    ds_read_b128 a[88:91], v8 offset:4096
    v_mfma_f32_16x16x32_bf16 v[228:231], a[36:39], v[84:87], v[228:231]
    v_mfma_f32_16x16x32_bf16 v[228:231], a[40:43], v[92:95], v[228:231]
    s_addk_i32 s58, 7168
    ds_read_b128 a[92:95], v9 offset:4096
    v_cvt_pk_bf16_f32 v217, v217, v221
    v_mfma_f32_16x16x32_bf16 v[228:231], a[44:47], v[100:103], v[228:231]
    buffer_store_dword v217, v4, s[24:27], s58 offen sc1 nt
    v_mfma_f32_16x16x32_bf16 v[228:231], a[48:51], v[108:111], v[228:231]
    ds_read_b128 a[0:3], v8 offset:8192
    v_mfma_f32_16x16x32_bf16 v[228:231], a[52:55], v[116:119], v[228:231]
    v_mfma_f32_16x16x32_bf16 v[228:231], a[56:59], v[124:127], v[228:231]
    s_addk_i32 s58, 7168
    ds_read_b128 a[4:7], v9 offset:8192
    v_cvt_pk_bf16_f32 v218, v218, v222
    v_mfma_f32_16x16x32_bf16 v[228:231], a[60:63], v[132:135], v[228:231]
    buffer_store_dword v218, v4, s[24:27], s58 offen sc1 nt
    v_mfma_f32_16x16x32_bf16 v[228:231], a[64:67], v[60:63], v[228:231]
    ds_read_b128 a[8:11], v8 offset:12288
    v_mfma_f32_16x16x32_bf16 v[228:231], a[68:71], v[68:71], v[228:231]
    s_waitcnt lgkmcnt(2)
    v_mfma_f32_16x16x32_bf16 v[232:235], a[72:75], v[72:75], v[232:235]
    s_addk_i32 s58, 7168
    ds_read_b128 a[12:15], v9 offset:12288
    v_cvt_pk_bf16_f32 v219, v219, v223
    v_mfma_f32_16x16x32_bf16 v[232:235], a[76:79], v[80:83], v[232:235]
    buffer_store_dword v219, v4, s[24:27], s58 offen sc1 nt
    v_mfma_f32_16x16x32_bf16 v[232:235], a[80:83], v[88:91], v[232:235]
    ds_read_b128 a[16:19], v12 offset:22528
    v_mfma_f32_16x16x32_bf16 v[232:235], a[84:87], v[96:99], v[232:235]
    v_mfma_f32_16x16x32_bf16 v[232:235], a[88:91], v[104:107], v[232:235]
    ds_read_b128 a[20:23], v13 offset:22528
    v_mfma_f32_16x16x32_bf16 v[232:235], a[92:95], v[112:115], v[232:235]
    v_mfma_f32_16x16x32_bf16 v[232:235], a[0:3], v[120:123], v[232:235]
    s_waitcnt lgkmcnt(2)
    ds_read_b128 a[24:27], v8 offset:2048
    v_mfma_f32_16x16x32_bf16 v[232:235], a[4:7], v[128:131], v[232:235]
    v_mfma_f32_16x16x32_bf16 v[232:235], a[8:11], v[56:59], v[232:235]
    s_add_u32 s58, s58, s63
    ds_read_b128 a[28:31], v9 offset:2048
    v_cvt_pk_bf16_f32 v224, v224, v228
    v_mfma_f32_16x16x32_bf16 v[232:235], a[12:15], v[64:67], v[232:235]
    buffer_store_dword v224, v4, s[24:27], s58 offen sc1 nt
    v_mfma_f32_16x16x32_bf16 v[236:239], a[72:75], v[76:79], v[236:239]
    ds_read_b128 a[32:35], v8 offset:6144
    v_mfma_f32_16x16x32_bf16 v[236:239], a[76:79], v[84:87], v[236:239]
    v_mfma_f32_16x16x32_bf16 v[236:239], a[80:83], v[92:95], v[236:239]
    s_addk_i32 s58, 7168
    ds_read_b128 a[36:39], v9 offset:6144
    v_cvt_pk_bf16_f32 v225, v225, v229
    v_mfma_f32_16x16x32_bf16 v[236:239], a[84:87], v[100:103], v[236:239]
    buffer_store_dword v225, v4, s[24:27], s58 offen sc1 nt
    v_mfma_f32_16x16x32_bf16 v[236:239], a[88:91], v[108:111], v[236:239]
    ds_read_b128 a[40:43], v8 offset:10240
    v_mfma_f32_16x16x32_bf16 v[236:239], a[92:95], v[116:119], v[236:239]
    v_mfma_f32_16x16x32_bf16 v[236:239], a[0:3], v[124:127], v[236:239]
    s_addk_i32 s58, 7168
    ds_read_b128 a[44:47], v9 offset:10240
    v_cvt_pk_bf16_f32 v226, v226, v230
    v_mfma_f32_16x16x32_bf16 v[236:239], a[4:7], v[132:135], v[236:239]
    buffer_store_dword v226, v4, s[24:27], s58 offen sc1 nt
    v_mfma_f32_16x16x32_bf16 v[236:239], a[8:11], v[60:63], v[236:239]
    ds_read_b128 a[48:51], v8 offset:14336
    v_mfma_f32_16x16x32_bf16 v[236:239], a[12:15], v[68:71], v[236:239]
    s_waitcnt lgkmcnt(2)
    v_mfma_f32_16x16x32_bf16 v[240:243], a[16:19], v[72:75], v[240:243]
    s_addk_i32 s58, 7168
    ds_read_b128 a[52:55], v9 offset:14336
    v_cvt_pk_bf16_f32 v227, v227, v231
    v_mfma_f32_16x16x32_bf16 v[240:243], a[20:23], v[80:83], v[240:243]
    buffer_store_dword v227, v4, s[24:27], s58 offen sc1 nt
    v_mfma_f32_16x16x32_bf16 v[240:243], a[24:27], v[88:91], v[240:243]
    ds_read_b128 a[56:59], v8 offset:16384
    v_mfma_f32_16x16x32_bf16 v[240:243], a[28:31], v[96:99], v[240:243]
    v_mfma_f32_16x16x32_bf16 v[240:243], a[32:35], v[104:107], v[240:243]
    ds_read_b128 a[60:63], v9 offset:16384
    v_mfma_f32_16x16x32_bf16 v[240:243], a[36:39], v[112:115], v[240:243]
    v_mfma_f32_16x16x32_bf16 v[240:243], a[40:43], v[120:123], v[240:243]
    s_waitcnt lgkmcnt(2)
    ds_read_b128 a[64:67], v8 offset:18432
    v_mfma_f32_16x16x32_bf16 v[240:243], a[44:47], v[128:131], v[240:243]
    v_mfma_f32_16x16x32_bf16 v[240:243], a[48:51], v[56:59], v[240:243]
    s_add_u32 s58, s58, s63
    ds_read_b128 a[68:71], v9 offset:18432
    v_cvt_pk_bf16_f32 v232, v232, v236
    v_mfma_f32_16x16x32_bf16 v[240:243], a[52:55], v[64:67], v[240:243]
    buffer_store_dword v232, v4, s[24:27], s58 offen sc1 nt
    v_mfma_f32_16x16x32_bf16 v[244:247], a[16:19], v[76:79], v[244:247]
    ds_read_b128 a[72:75], v8 offset:20480
    v_mfma_f32_16x16x32_bf16 v[244:247], a[20:23], v[84:87], v[244:247]
    v_mfma_f32_16x16x32_bf16 v[244:247], a[24:27], v[92:95], v[244:247]
    s_addk_i32 s58, 7168
    ds_read_b128 a[76:79], v9 offset:20480
    v_cvt_pk_bf16_f32 v233, v233, v237
    v_mfma_f32_16x16x32_bf16 v[244:247], a[28:31], v[100:103], v[244:247]
    buffer_store_dword v233, v4, s[24:27], s58 offen sc1 nt
    v_mfma_f32_16x16x32_bf16 v[244:247], a[32:35], v[108:111], v[244:247]
    ds_read_b128 a[80:83], v8 offset:22528
    v_mfma_f32_16x16x32_bf16 v[244:247], a[36:39], v[116:119], v[244:247]
    v_mfma_f32_16x16x32_bf16 v[244:247], a[40:43], v[124:127], v[244:247]
    s_addk_i32 s58, 7168
    ds_read_b128 a[84:87], v9 offset:22528
    v_cvt_pk_bf16_f32 v234, v234, v238
    v_mfma_f32_16x16x32_bf16 v[244:247], a[44:47], v[132:135], v[244:247]
    buffer_store_dword v234, v4, s[24:27], s58 offen sc1 nt
    v_mfma_f32_16x16x32_bf16 v[244:247], a[48:51], v[60:63], v[244:247]
    ds_read_b128 a[88:91], v8 offset:24576
    v_mfma_f32_16x16x32_bf16 v[244:247], a[52:55], v[68:71], v[244:247]
    s_waitcnt lgkmcnt(2)
    v_mfma_f32_16x16x32_bf16 v[248:251], a[56:59], v[72:75], v[248:251]
    s_addk_i32 s58, 7168
    ds_read_b128 a[92:95], v9 offset:24576
    v_cvt_pk_bf16_f32 v235, v235, v239
    v_mfma_f32_16x16x32_bf16 v[248:251], a[60:63], v[80:83], v[248:251]
    buffer_store_dword v235, v4, s[24:27], s58 offen sc1 nt
    v_mfma_f32_16x16x32_bf16 v[248:251], a[64:67], v[88:91], v[248:251]
    v_mfma_f32_16x16x32_bf16 v[248:251], a[68:71], v[96:99], v[248:251]
    v_mfma_f32_16x16x32_bf16 v[248:251], a[72:75], v[104:107], v[248:251]
    v_mfma_f32_16x16x32_bf16 v[248:251], a[76:79], v[112:115], v[248:251]
    v_mfma_f32_16x16x32_bf16 v[248:251], a[80:83], v[120:123], v[248:251]
    s_waitcnt lgkmcnt(0)
    v_mfma_f32_16x16x32_bf16 v[248:251], a[84:87], v[128:131], v[248:251]
    s_add_u32 s58, s58, s63
    v_cvt_pk_bf16_f32 v240, v240, v244
    v_mfma_f32_16x16x32_bf16 v[248:251], a[88:91], v[56:59], v[248:251]
    buffer_store_dword v240, v4, s[24:27], s58 offen sc1 nt
    v_mfma_f32_16x16x32_bf16 v[248:251], a[92:95], v[64:67], v[248:251]
    s_addk_i32 s58, 7168
    v_cvt_pk_bf16_f32 v241, v241, v245
    v_mfma_f32_16x16x32_bf16 v[252:255], a[56:59], v[76:79], v[252:255]
    buffer_store_dword v241, v4, s[24:27], s58 offen sc1 nt
    v_mfma_f32_16x16x32_bf16 v[252:255], a[60:63], v[84:87], v[252:255]
    s_addk_i32 s58, 7168
    v_cvt_pk_bf16_f32 v242, v242, v246
    v_mfma_f32_16x16x32_bf16 v[252:255], a[64:67], v[92:95], v[252:255]
    buffer_store_dword v242, v4, s[24:27], s58 offen sc1 nt
    v_mfma_f32_16x16x32_bf16 v[252:255], a[68:71], v[100:103], v[252:255]
    s_addk_i32 s58, 7168
    v_cvt_pk_bf16_f32 v243, v243, v247
    v_mfma_f32_16x16x32_bf16 v[252:255], a[72:75], v[108:111], v[252:255]
    buffer_store_dword v243, v4, s[24:27], s58 offen sc1 nt
    v_mfma_f32_16x16x32_bf16 v[252:255], a[76:79], v[116:119], v[252:255]
    v_mfma_f32_16x16x32_bf16 v[252:255], a[80:83], v[124:127], v[252:255]
    v_mfma_f32_16x16x32_bf16 v[252:255], a[84:87], v[132:135], v[252:255]
    v_mfma_f32_16x16x32_bf16 v[252:255], a[88:91], v[60:63], v[252:255]
    v_mfma_f32_16x16x32_bf16 v[252:255], a[92:95], v[68:71], v[252:255]
    s_mov_b32 s4, 1605632
    s_mov_b32 s5, 1612800
    s_mov_b32 s6, 1619968
    s_mov_b32 s7, 1627136
    s_nop 3
    v_cvt_pk_bf16_f32 v248, v248, v252
    v_cvt_pk_bf16_f32 v249, v249, v253
    v_cvt_pk_bf16_f32 v250, v250, v254
    v_cvt_pk_bf16_f32 v251, v251, v255
    buffer_store_dword v248, v4, s[24:27], s4 offen sc1 nt
    buffer_store_dword v249, v4, s[24:27], s5 offen sc1 nt
    buffer_store_dword v250, v4, s[24:27], s6 offen sc1 nt
    buffer_store_dword v251, v4, s[24:27], s7 offen sc1 nt
L_mainendA:
    s_endpgm
L_helper:
    s_cmp_eq_u32 s3, 2
    s_cselect_b32 s3, 28, 30
    s_sub_u32 s3, s53, s3
    s_lshr_b32 s4, s3, 1
    s_mul_i32 s4, s4, 240
    s_and_b32 s5, s3, 1
    s_lshl_b32 s5, s5, 3
    s_add_u32 s4, s4, s5
    s_add_u32 s4, s4, 224
    s_lshl_b32 s4, s4, 11
    s_mov_b32 s18, 114688
    s_mov_b32 s19, 0x20000
    s_mov_b32 s22, 114688
    s_mov_b32 s23, 0x20000
    s_mov_b32 s14, 917504
    s_mov_b32 s15, 0x20000
    s_mov_b32 s10, 4194304
    s_mov_b32 s11, 0x20000
    v_lshrrev_b32 v1, 1, v0
    v_min_u32 v1, 111, v1
    v_lshlrev_b32 v1, 7, v1
    s_mul_i32 s5, s3, 14336
    v_add_u32 v1, s5, v1
    v_lshrrev_b32 v2, 2, v0
    v_min_u32 v2, 55, v2
    v_lshlrev_b32 v2, 7, v2
    s_mul_i32 s5, s3, 7168
    v_add_u32 v2, s5, v2
    v_lshrrev_b32 v3, 5, v0
    v_lshlrev_b32 v3, 11, v3
    v_bfe_u32 v4, v0, 2, 3
    v_lshl_add_u32 v3, v4, 7, v3
    v_add_u32 v3, s4, v3
    s_waitcnt lgkmcnt(0)
    s_mov_b32 s5, 114688
    buffer_load_dword v5, v1, s[12:15], s5 offen
    s_mov_b32 s5, 28672
    buffer_load_dword v5, v2, s[16:19], s5 offen
    buffer_load_dword v5, v2, s[20:23], s5 offen
    s_mov_b32 s5, 172032
    buffer_load_dword v5, v1, s[12:15], s5 offen
    s_mov_b32 s5, 229376
    buffer_load_dword v5, v1, s[12:15], s5 offen
    s_mov_b32 s5, 286720
    buffer_load_dword v5, v1, s[12:15], s5 offen
    s_mov_b32 s5, 344064
    buffer_load_dword v5, v1, s[12:15], s5 offen
    s_mov_b32 s5, 57344
    buffer_load_dword v5, v2, s[16:19], s5 offen
    buffer_load_dword v5, v2, s[20:23], s5 offen
    s_mov_b32 s5, 86016
    buffer_load_dword v5, v2, s[16:19], s5 offen
    buffer_load_dword v5, v2, s[20:23], s5 offen
    s_mov_b32 s5, 401408
    buffer_load_dword v5, v1, s[12:15], s5 offen
    s_mov_b32 s5, 458752
    buffer_load_dword v5, v1, s[12:15], s5 offen
    s_mov_b32 s5, 516096
    buffer_load_dword v5, v1, s[12:15], s5 offen
    s_mov_b32 s5, 573440
    buffer_load_dword v5, v1, s[12:15], s5 offen
    s_mov_b32 s5, 630784
    buffer_load_dword v5, v1, s[12:15], s5 offen
    s_mov_b32 s5, 688128
    buffer_load_dword v5, v1, s[12:15], s5 offen
    s_mov_b32 s5, 745472
    buffer_load_dword v5, v1, s[12:15], s5 offen
    s_mov_b32 s5, 802816
    buffer_load_dword v5, v1, s[12:15], s5 offen
    s_mov_b32 s5, 860160
    buffer_load_dword v5, v1, s[12:15], s5 offen
    s_endpgm
.p2align 12
L_hopB1:
    s_cbranch_execz L_hopB5
L_mainB:
    s_waitcnt vmcnt(9)
    s_barrier
    ds_read_b128 a[0:3], v8 offset:0
    ds_read_b128 a[4:7], v9 offset:0
    ds_read_b128 a[8:11], v8 offset:2048
    ds_read_b128 a[12:15], v9 offset:2048
    ds_read_b128 a[16:19], v8 offset:4096
    s_waitcnt lgkmcnt(3)
    v_mfma_f32_16x16x32_bf16 v[136:139], a[0:3], v[56:59], 0
    ds_read_b128 a[20:23], v9 offset:4096
    v_lshrrev_b64 v[16:17], 2, v[24:25]
    v_mfma_f32_16x16x32_bf16 v[136:139], a[4:7], v[64:67], v[136:139]
    s_add_u32 s56, s56, s62
    v_perm_b32 v18, v16, v24, s40
    v_perm_b32 v19, v16, v24, s41
    v_lshrrev_b64 v[20:21], 4, v[18:19]
    v_and_or_b32 v18, v18, s44, v1
    v_mfma_f32_16x16x32_bf16 v[140:143], a[0:3], v[60:63], 0
    s_waitcnt lgkmcnt(3)
    s_addk_i32 m0, 4096
    ds_read_b128 a[24:27], v8 offset:6144
    v_mfma_f32_16x16x32_bf16 v[140:143], a[4:7], v[68:71], v[140:143]
    buffer_load_dwordx4 v5, s[8:11], s56 offen lds
    v_mfma_f32_16x16x32_bf16 v[144:147], a[8:11], v[56:59], 0
    s_waitcnt lgkmcnt(2)
    ds_read_b128 a[28:31], v9 offset:6144
    v_and_or_b32 v19, v19, s44, v1
    v_mfma_f32_16x16x32_bf16 v[144:147], a[12:15], v[64:67], v[144:147]
    s_add_u32 s56, s56, s62
    v_and_or_b32 v20, v20, s44, v1
    v_and_or_b32 v21, v21, s44, v1
    v_perm_b32 v72, v52, v53, v18
    v_perm_b32 v73, v52, v53, v20
    v_mfma_f32_16x16x32_bf16 v[148:151], a[8:11], v[60:63], 0
    s_add_u32 s57, s57, s61
    ds_read_b128 a[32:35], v8 offset:8192
    v_perm_b32 v74, v52, v53, v19
    v_mfma_f32_16x16x32_bf16 v[148:151], a[12:15], v[68:71], v[148:151]
    buffer_load_dwordx2 v[26:27], v3, s[12:15], s57 offen
    v_mfma_f32_16x16x32_bf16 v[152:155], a[16:19], v[56:59], 0
    s_waitcnt lgkmcnt(2)
    s_addk_i32 m0, 4096
    ds_read_b128 a[36:39], v9 offset:8192
    v_mfma_f32_16x16x32_bf16 v[152:155], a[20:23], v[64:67], v[152:155]
    buffer_load_dwordx4 v5, s[8:11], s56 offen lds
    v_mfma_f32_16x16x32_bf16 v[156:159], a[16:19], v[60:63], 0
    ds_read_b128 a[40:43], v8 offset:10240
    v_perm_b32 v75, v52, v53, v21
    v_mfma_f32_16x16x32_bf16 v[156:159], a[20:23], v[68:71], v[156:159]
    s_add_u32 s56, s56, s62
    v_perm_b32 v18, v16, v24, s42
    v_perm_b32 v19, v16, v24, s43
    v_lshrrev_b64 v[20:21], 4, v[18:19]
    v_and_or_b32 v18, v18, s44, v1
    v_mfma_f32_16x16x32_bf16 v[160:163], a[24:27], v[56:59], 0
    s_waitcnt vmcnt(9) lgkmcnt(2)
    ds_read_b128 a[44:47], v9 offset:10240
    v_and_or_b32 v19, v19, s44, v1
    v_mfma_f32_16x16x32_bf16 v[160:163], a[28:31], v[64:67], v[160:163]
    s_barrier
    v_mfma_f32_16x16x32_bf16 v[164:167], a[24:27], v[60:63], 0
    s_addk_i32 m0, 4096
    ds_read_b128 a[48:51], v8 offset:12288
    v_mfma_f32_16x16x32_bf16 v[164:167], a[28:31], v[68:71], v[164:167]
    buffer_load_dwordx4 v5, s[8:11], s56 offen lds
    v_mfma_f32_16x16x32_bf16 v[168:171], a[32:35], v[56:59], 0
    s_waitcnt lgkmcnt(2)
    ds_read_b128 a[52:55], v9 offset:12288
    v_and_or_b32 v20, v20, s44, v1
    v_mfma_f32_16x16x32_bf16 v[168:171], a[36:39], v[64:67], v[168:171]
    s_movk_i32 s56, 256
    v_and_or_b32 v21, v21, s44, v1
    v_perm_b32 v80, v52, v53, v18
    v_perm_b32 v81, v52, v53, v20
    v_perm_b32 v82, v52, v53, v19
    v_mfma_f32_16x16x32_bf16 v[172:175], a[32:35], v[60:63], 0
    s_addk_i32 m0, 4096
    ds_read_b128 a[56:59], v8 offset:14336
    v_perm_b32 v83, v52, v53, v21
    v_mfma_f32_16x16x32_bf16 v[172:175], a[36:39], v[68:71], v[172:175]
    buffer_load_dwordx4 v5, s[8:11], s56 offen lds
    v_mfma_f32_16x16x32_bf16 v[176:179], a[40:43], v[56:59], 0
    s_waitcnt lgkmcnt(2)
    ds_read_b128 a[60:63], v9 offset:14336
    v_perm_b32 v18, v17, v25, s40
    v_mfma_f32_16x16x32_bf16 v[176:179], a[44:47], v[64:67], v[176:179]
    s_add_u32 s56, s56, s62
    v_perm_b32 v19, v17, v25, s41
    v_lshrrev_b64 v[20:21], 4, v[18:19]
    v_and_or_b32 v18, v18, s44, v1
    v_and_or_b32 v19, v19, s44, v1
    v_mfma_f32_16x16x32_bf16 v[180:183], a[40:43], v[60:63], 0
    s_addk_i32 m0, 4096
    ds_read_b128 a[64:67], v8 offset:16384
    v_and_or_b32 v20, v20, s44, v1
    v_mfma_f32_16x16x32_bf16 v[180:183], a[44:47], v[68:71], v[180:183]
    buffer_load_dwordx4 v5, s[8:11], s56 offen lds
    v_mfma_f32_16x16x32_bf16 v[184:187], a[48:51], v[56:59], 0
    s_waitcnt lgkmcnt(2)
    ds_read_b128 a[68:71], v9 offset:16384
    v_and_or_b32 v21, v21, s44, v1
    v_mfma_f32_16x16x32_bf16 v[184:187], a[52:55], v[64:67], v[184:187]
    s_add_u32 s56, s56, s62
    v_perm_b32 v76, v54, v55, v18
    v_perm_b32 v77, v54, v55, v20
    v_perm_b32 v78, v54, v55, v19
    v_perm_b32 v79, v54, v55, v21
    v_mfma_f32_16x16x32_bf16 v[188:191], a[48:51], v[60:63], 0
    s_addk_i32 m0, 4096
    ds_read_b128 a[72:75], v8 offset:18432
    v_perm_b32 v18, v17, v25, s42
    v_mfma_f32_16x16x32_bf16 v[188:191], a[52:55], v[68:71], v[188:191]
    buffer_load_dwordx4 v5, s[8:11], s56 offen lds
    v_mfma_f32_16x16x32_bf16 v[192:195], a[56:59], v[56:59], 0
    s_waitcnt vmcnt(10) lgkmcnt(2)
    ds_read_b128 a[76:79], v9 offset:18432
    v_mfma_f32_16x16x32_bf16 v[192:195], a[60:63], v[64:67], v[192:195]
    s_barrier
    v_mfma_f32_16x16x32_bf16 v[196:199], a[56:59], v[60:63], 0
    s_movk_i32 s59, 28672
    ds_read_b128 a[80:83], v8 offset:20480
    v_perm_b32 v19, v17, v25, s43
    v_mfma_f32_16x16x32_bf16 v[196:199], a[60:63], v[68:71], v[196:199]
    buffer_load_dword v32, v15, s[16:19], s59 offen
    v_mfma_f32_16x16x32_bf16 v[200:203], a[64:67], v[56:59], 0
    s_waitcnt lgkmcnt(2)
    s_add_u32 s56, s56, s62
    ds_read_b128 a[84:87], v9 offset:20480
    v_mfma_f32_16x16x32_bf16 v[200:203], a[68:71], v[64:67], v[200:203]
    buffer_load_dword v33, v15, s[20:23], s59 offen
    v_mfma_f32_16x16x32_bf16 v[204:207], a[64:67], v[60:63], 0
    s_addk_i32 m0, 4096
    ds_read_b128 a[88:91], v8 offset:22528
    v_lshrrev_b64 v[20:21], 4, v[18:19]
    v_mfma_f32_16x16x32_bf16 v[204:207], a[68:71], v[68:71], v[204:207]
    buffer_load_dwordx4 v5, s[8:11], s56 offen lds
    v_mfma_f32_16x16x32_bf16 v[208:211], a[72:75], v[56:59], 0
    s_waitcnt lgkmcnt(2)
    ds_read_b128 a[92:95], v9 offset:22528
    v_and_or_b32 v18, v18, s44, v1
    v_mfma_f32_16x16x32_bf16 v[208:211], a[76:79], v[64:67], v[208:211]
    s_add_u32 s56, s56, s62
    v_and_or_b32 v19, v19, s44, v1
    v_and_or_b32 v20, v20, s44, v1
    v_and_or_b32 v21, v21, s44, v1
    v_perm_b32 v84, v54, v55, v18
    v_mfma_f32_16x16x32_bf16 v[212:215], a[72:75], v[60:63], 0
    s_add_u32 s57, s57, s61
    ds_read_b128 a[0:3], v8 offset:24576
    v_perm_b32 v85, v54, v55, v20
    v_mfma_f32_16x16x32_bf16 v[212:215], a[76:79], v[68:71], v[212:215]
    buffer_load_dwordx2 v[28:29], v3, s[12:15], s57 offen
    v_mfma_f32_16x16x32_bf16 v[216:219], a[80:83], v[56:59], 0
    s_waitcnt lgkmcnt(2)
    s_addk_i32 m0, 4096
    ds_read_b128 a[4:7], v9 offset:24576
    v_mfma_f32_16x16x32_bf16 v[216:219], a[84:87], v[64:67], v[216:219]
    buffer_load_dwordx4 v5, s[8:11], s56 offen lds
    v_mfma_f32_16x16x32_bf16 v[220:223], a[80:83], v[60:63], 0
    s_waitcnt lgkmcnt(2)
    ds_read_b128 a[8:11], v8 offset:26624
    v_perm_b32 v86, v54, v55, v19
    v_mfma_f32_16x16x32_bf16 v[220:223], a[84:87], v[68:71], v[220:223]
    s_add_u32 s56, s56, s62
    v_perm_b32 v87, v54, v55, v21
    v_mov_b32 v124, v120
    v_mov_b32 v125, v121
    v_mov_b32 v126, v122
    v_mfma_f32_16x16x32_bf16 v[224:227], a[88:91], v[56:59], 0
    s_addk_i32 m0, 4096
    ds_read_b128 a[12:15], v9 offset:26624
    v_mov_b32 v127, v123
    v_mfma_f32_16x16x32_bf16 v[224:227], a[92:95], v[64:67], v[224:227]
    buffer_load_dwordx4 v5, s[8:11], s56 offen lds
    v_mfma_f32_16x16x32_bf16 v[228:231], a[88:91], v[60:63], 0
    ds_read_b128 a[16:19], v8 offset:28672
    v_mfma_f32_16x16x32_bf16 v[228:231], a[92:95], v[68:71], v[228:231]
    s_waitcnt lgkmcnt(2)
    v_permlane16_swap_b32 v120, v124
    v_permlane16_swap_b32 v121, v125
    v_mfma_f32_16x16x32_bf16 v[232:235], a[0:3], v[56:59], 0
    s_waitcnt vmcnt(11)
    ds_read_b128 a[20:23], v9 offset:28672
    v_mfma_f32_16x16x32_bf16 v[232:235], a[4:7], v[64:67], v[232:235]
    s_add_u32 s56, s56, s62
    v_permlane16_swap_b32 v122, v126
    v_permlane16_swap_b32 v123, v127
    v_mfma_f32_16x16x32_bf16 v[236:239], a[0:3], v[60:63], 0
    s_addk_i32 m0, 4096
    ds_read_b128 a[24:27], v8 offset:30720
    v_lshrrev_b64 v[16:17], 2, v[26:27]
    v_mfma_f32_16x16x32_bf16 v[236:239], a[4:7], v[68:71], v[236:239]
    buffer_load_dwordx4 v5, s[8:11], s56 offen lds
    v_mfma_f32_16x16x32_bf16 v[240:243], a[8:11], v[56:59], 0
    s_waitcnt vmcnt(11) lgkmcnt(2)
    ds_read_b128 a[28:31], v9 offset:30720
    v_mfma_f32_16x16x32_bf16 v[240:243], a[12:15], v[64:67], v[240:243]
    s_barrier
    v_mfma_f32_16x16x32_bf16 v[244:247], a[8:11], v[60:63], 0
    s_waitcnt lgkmcnt(2)
    ds_read_b128 a[32:35], v8 offset:32768
    v_perm_b32 v18, v16, v26, s40
    v_mfma_f32_16x16x32_bf16 v[244:247], a[12:15], v[68:71], v[244:247]
    s_movk_i32 s56, 384
    v_perm_b32 v19, v16, v26, s41
    v_lshrrev_b64 v[20:21], 4, v[18:19]
    v_and_or_b32 v18, v18, s44, v1
    v_mfma_f32_16x16x32_bf16 v[136:139], a[16:19], v[72:75], v[136:139]
    s_addk_i32 m0, 4096
    ds_read_b128 a[36:39], v9 offset:32768
    v_and_or_b32 v19, v19, s44, v1
    v_mfma_f32_16x16x32_bf16 v[136:139], a[20:23], v[80:83], v[136:139]
    buffer_load_dwordx4 v5, s[8:11], s56 offen lds
    v_mfma_f32_16x16x32_bf16 v[140:143], a[16:19], v[76:79], v[140:143]
    ds_read_b128 a[40:43], v8 offset:34816
    v_and_or_b32 v20, v20, s44, v1
    v_mfma_f32_16x16x32_bf16 v[140:143], a[20:23], v[84:87], v[140:143]
    s_waitcnt lgkmcnt(2)
    v_and_or_b32 v21, v21, s44, v1
    v_perm_b32 v88, v120, v121, v18
    v_perm_b32 v89, v120, v121, v20
    v_perm_b32 v90, v120, v121, v19
    v_mfma_f32_16x16x32_bf16 v[144:147], a[24:27], v[72:75], v[144:147]
    ds_read_b128 a[44:47], v9 offset:34816
    v_perm_b32 v91, v120, v121, v21
    v_mfma_f32_16x16x32_bf16 v[144:147], a[28:31], v[80:83], v[144:147]
    s_add_u32 s56, s56, s62
    v_perm_b32 v18, v16, v26, s42
    v_perm_b32 v19, v16, v26, s43
    v_lshrrev_b64 v[20:21], 4, v[18:19]
    v_and_or_b32 v18, v18, s44, v1
    v_mfma_f32_16x16x32_bf16 v[148:151], a[24:27], v[76:79], v[148:151]
    s_addk_i32 m0, 4096
    ds_read_b128 a[48:51], v8 offset:36864
    v_and_or_b32 v19, v19, s44, v1
    v_mfma_f32_16x16x32_bf16 v[148:151], a[28:31], v[84:87], v[148:151]
    buffer_load_dwordx4 v5, s[8:11], s56 offen lds
    v_mfma_f32_16x16x32_bf16 v[152:155], a[32:35], v[72:75], v[152:155]
    s_waitcnt lgkmcnt(2)
    ds_read_b128 a[52:55], v9 offset:36864
    v_and_or_b32 v20, v20, s44, v1
    v_mfma_f32_16x16x32_bf16 v[152:155], a[36:39], v[80:83], v[152:155]
    v_and_or_b32 v21, v21, s44, v1
    v_perm_b32 v96, v120, v121, v18
    v_perm_b32 v97, v120, v121, v20
    v_perm_b32 v98, v120, v121, v19
    v_mfma_f32_16x16x32_bf16 v[156:159], a[32:35], v[76:79], v[156:159]
    s_waitcnt lgkmcnt(2)
    ds_read_b128 a[56:59], v8 offset:38912
    v_perm_b32 v99, v120, v121, v21
    v_mfma_f32_16x16x32_bf16 v[156:159], a[36:39], v[84:87], v[156:159]
    s_add_u32 s56, s56, s62
    v_perm_b32 v18, v17, v27, s40
    v_perm_b32 v19, v17, v27, s41
    v_lshrrev_b64 v[20:21], 4, v[18:19]
    v_and_or_b32 v18, v18, s44, v1
    v_mfma_f32_16x16x32_bf16 v[160:163], a[40:43], v[72:75], v[160:163]
    s_addk_i32 m0, 4096
    ds_read_b128 a[60:63], v9 offset:38912
    v_and_or_b32 v19, v19, s44, v1
    v_mfma_f32_16x16x32_bf16 v[160:163], a[44:47], v[80:83], v[160:163]
    buffer_load_dwordx4 v5, s[8:11], s56 offen lds
    v_mfma_f32_16x16x32_bf16 v[164:167], a[40:43], v[76:79], v[164:167]
    ds_read_b128 a[64:67], v8 offset:40960
    v_and_or_b32 v20, v20, s44, v1
    v_mfma_f32_16x16x32_bf16 v[164:167], a[44:47], v[84:87], v[164:167]
    s_waitcnt lgkmcnt(2)
    v_and_or_b32 v21, v21, s44, v1
    v_perm_b32 v92, v122, v123, v18
    v_perm_b32 v93, v122, v123, v20
    v_perm_b32 v94, v122, v123, v19
    v_mfma_f32_16x16x32_bf16 v[168:171], a[48:51], v[72:75], v[168:171]
    ds_read_b128 a[68:71], v9 offset:40960
    v_perm_b32 v95, v122, v123, v21
    v_mfma_f32_16x16x32_bf16 v[168:171], a[52:55], v[80:83], v[168:171]
    s_add_u32 s56, s56, s62
    v_perm_b32 v18, v17, v27, s42
    v_perm_b32 v19, v17, v27, s43
    v_lshrrev_b64 v[20:21], 4, v[18:19]
    v_and_or_b32 v18, v18, s44, v1
    v_mfma_f32_16x16x32_bf16 v[172:175], a[48:51], v[76:79], v[172:175]
    s_addk_i32 m0, 4096
    ds_read_b128 a[72:75], v8 offset:43008
    v_and_or_b32 v19, v19, s44, v1
    v_mfma_f32_16x16x32_bf16 v[172:175], a[52:55], v[84:87], v[172:175]
    buffer_load_dwordx4 v5, s[8:11], s56 offen lds
    v_mfma_f32_16x16x32_bf16 v[176:179], a[56:59], v[72:75], v[176:179]
    s_waitcnt lgkmcnt(2)
    ds_read_b128 a[76:79], v9 offset:43008
    v_and_or_b32 v20, v20, s44, v1
    v_mfma_f32_16x16x32_bf16 v[176:179], a[60:63], v[80:83], v[176:179]
    v_and_or_b32 v21, v21, s44, v1
    v_perm_b32 v100, v122, v123, v18
    v_perm_b32 v101, v122, v123, v20
    v_perm_b32 v102, v122, v123, v19
    v_mfma_f32_16x16x32_bf16 v[180:183], a[56:59], v[76:79], v[180:183]
    s_waitcnt vmcnt(9) lgkmcnt(2)
    ds_read_b128 a[80:83], v8 offset:45056
    v_perm_b32 v103, v122, v123, v21
    v_mfma_f32_16x16x32_bf16 v[180:183], a[60:63], v[84:87], v[180:183]
    s_add_u32 s56, s56, s62
    v_lshlrev_b32 v36, 16, v32
    v_lshlrev_b32 v37, 16, v33
    v_mul_f32 v37, v36, v37
    v_sub_f32 v38, v36, v37
    v_mfma_f32_16x16x32_bf16 v[184:187], a[64:67], v[72:75], v[184:187]
    s_addk_i32 m0, 4096
    ds_read_b128 a[84:87], v9 offset:45056
    v_fma_f32 v39, 2.0, v36, -v37
    v_mfma_f32_16x16x32_bf16 v[184:187], a[68:71], v[80:83], v[184:187]
    buffer_load_dwordx4 v5, s[8:11], s56 offen lds
    v_mfma_f32_16x16x32_bf16 v[188:191], a[64:67], v[76:79], v[188:191]
    ds_read_b128 a[88:91], v8 offset:47104
    v_add_f32 v36, v39, v36
    v_mfma_f32_16x16x32_bf16 v[188:191], a[68:71], v[84:87], v[188:191]
    s_waitcnt lgkmcnt(2)
    v_cvt_pk_bf16_f32 v37, -v37, v38
    v_cvt_pk_bf16_f32 v38, v39, v36
    v_perm_b32 v40, v38, v37, s46
    v_perm_b32 v41, v38, v37, s45
    v_mfma_f32_16x16x32_bf16 v[192:195], a[72:75], v[72:75], v[192:195]
    ds_read_b128 a[92:95], v9 offset:47104
    v_and_b32 v36, 0xffff0000, v32
    v_mfma_f32_16x16x32_bf16 v[192:195], a[76:79], v[80:83], v[192:195]
    s_add_u32 s56, s56, s62
    v_and_b32 v37, 0xffff0000, v33
    v_mul_f32 v37, v36, v37
    v_sub_f32 v38, v36, v37
    v_mfma_f32_16x16x32_bf16 v[196:199], a[72:75], v[76:79], v[196:199]
    s_add_u32 s57, s57, s61
    ds_read_b128 a[0:3], v8 offset:49152
    v_fma_f32 v39, 2.0, v36, -v37
    v_mfma_f32_16x16x32_bf16 v[196:199], a[76:79], v[84:87], v[196:199]
    buffer_load_dwordx2 v[22:23], v3, s[12:15], s57 offen
    v_mfma_f32_16x16x32_bf16 v[200:203], a[80:83], v[72:75], v[200:203]
    s_waitcnt lgkmcnt(2)
    s_addk_i32 m0, 4096
    ds_read_b128 a[4:7], v9 offset:49152
    v_mfma_f32_16x16x32_bf16 v[200:203], a[84:87], v[80:83], v[200:203]
    buffer_load_dwordx4 v5, s[8:11], s56 offen lds
    v_mfma_f32_16x16x32_bf16 v[204:207], a[80:83], v[76:79], v[204:207]
    ds_read_b128 a[8:11], v8 offset:51200
    v_add_f32 v36, v39, v36
    v_mfma_f32_16x16x32_bf16 v[204:207], a[84:87], v[84:87], v[204:207]
    s_add_u32 s56, s56, s62
    v_cvt_pk_bf16_f32 v37, -v37, v38
    v_cvt_pk_bf16_f32 v38, v39, v36
    v_perm_b32 v42, v38, v37, s46
    v_perm_b32 v43, v38, v37, s45
    v_mfma_f32_16x16x32_bf16 v[208:211], a[88:91], v[72:75], v[208:211]
    s_waitcnt vmcnt(7) lgkmcnt(2)
    ds_read_b128 a[12:15], v9 offset:51200
    v_mov_b32 v48, v40
    v_mfma_f32_16x16x32_bf16 v[208:211], a[92:95], v[80:83], v[208:211]
    s_barrier
    v_mfma_f32_16x16x32_bf16 v[212:215], a[88:91], v[76:79], v[212:215]
    s_addk_i32 m0, 4096
    ds_read_b128 a[16:19], v8 offset:53248
    v_mfma_f32_16x16x32_bf16 v[212:215], a[92:95], v[84:87], v[212:215]
    buffer_load_dwordx4 v5, s[8:11], s56 offen lds
    v_mfma_f32_16x16x32_bf16 v[216:219], a[0:3], v[72:75], v[216:219]
    s_waitcnt lgkmcnt(2)
    ds_read_b128 a[20:23], v9 offset:53248
    v_mov_b32 v49, v41
    v_mfma_f32_16x16x32_bf16 v[216:219], a[4:7], v[80:83], v[216:219]
    s_movk_i32 s56, 512
    v_mov_b32 v50, v42
    v_mov_b32 v51, v43
    v_permlane32_swap_b32 v40, v48
    v_mfma_f32_16x16x32_bf16 v[220:223], a[0:3], v[76:79], v[220:223]
    s_addk_i32 m0, 4096
    ds_read_b128 a[24:27], v8 offset:55296
    v_lshrrev_b64 v[16:17], 2, v[28:29]
    v_mfma_f32_16x16x32_bf16 v[220:223], a[4:7], v[84:87], v[220:223]
    buffer_load_dwordx4 v5, s[8:11], s56 offen lds
    v_mfma_f32_16x16x32_bf16 v[224:227], a[8:11], v[72:75], v[224:227]
    s_waitcnt lgkmcnt(2)
    ds_read_b128 a[28:31], v9 offset:55296
    v_perm_b32 v18, v16, v28, s40
    v_mfma_f32_16x16x32_bf16 v[224:227], a[12:15], v[80:83], v[224:227]
    v_permlane32_swap_b32 v41, v49
    v_permlane32_swap_b32 v42, v50
    v_mfma_f32_16x16x32_bf16 v[228:231], a[8:11], v[76:79], v[228:231]
    s_waitcnt lgkmcnt(2)
    ds_read_b128 a[32:35], v8 offset:57344
    v_perm_b32 v19, v16, v28, s41
    v_mfma_f32_16x16x32_bf16 v[228:231], a[12:15], v[84:87], v[228:231]
    s_add_u32 s56, s56, s62
    v_permlane32_swap_b32 v43, v51
    v_mov_b32 v44, v40
    v_mov_b32 v45, v41
    v_mfma_f32_16x16x32_bf16 v[232:235], a[16:19], v[72:75], v[232:235]
    s_addk_i32 m0, 4096
    ds_read_b128 a[36:39], v9 offset:57344
    v_mov_b32 v46, v42
    v_mfma_f32_16x16x32_bf16 v[232:235], a[20:23], v[80:83], v[232:235]
    buffer_load_dwordx4 v5, s[8:11], s56 offen lds
    v_mfma_f32_16x16x32_bf16 v[236:239], a[16:19], v[76:79], v[236:239]
    ds_read_b128 a[40:43], v8 offset:59392
    v_mov_b32 v47, v43
    v_mfma_f32_16x16x32_bf16 v[236:239], a[20:23], v[84:87], v[236:239]
    s_waitcnt lgkmcnt(2)
    v_permlane16_swap_b32 v40, v44
    v_permlane16_swap_b32 v41, v45
    v_mfma_f32_16x16x32_bf16 v[240:243], a[24:27], v[72:75], v[240:243]
    ds_read_b128 a[44:47], v9 offset:59392
    v_lshrrev_b64 v[20:21], 4, v[18:19]
    v_mfma_f32_16x16x32_bf16 v[240:243], a[28:31], v[80:83], v[240:243]
    s_add_u32 s56, s56, s62
    v_permlane16_swap_b32 v42, v46
    v_permlane16_swap_b32 v43, v47
    v_mfma_f32_16x16x32_bf16 v[244:247], a[24:27], v[76:79], v[244:247]
    s_addk_i32 m0, 4096
    ds_read_b128 a[48:51], v8 offset:61440
    v_mov_b32 v52, v48
    v_mfma_f32_16x16x32_bf16 v[244:247], a[28:31], v[84:87], v[244:247]
    buffer_load_dwordx4 v5, s[8:11], s56 offen lds
    v_mfma_f32_16x16x32_bf16 v[136:139], a[32:35], v[88:91], v[136:139]
    s_waitcnt lgkmcnt(2)
    s_add_u32 s57, s57, s61
    ds_read_b128 a[52:55], v9 offset:61440
    v_mfma_f32_16x16x32_bf16 v[136:139], a[36:39], v[96:99], v[136:139]
    buffer_load_dwordx2 v[24:25], v3, s[12:15], s57 offen
    v_mfma_f32_16x16x32_bf16 v[140:143], a[32:35], v[92:95], v[140:143]
    s_waitcnt lgkmcnt(2)
    ds_read_b128 a[56:59], v8 offset:63488
    v_mov_b32 v53, v49
    v_mfma_f32_16x16x32_bf16 v[140:143], a[36:39], v[100:103], v[140:143]
    s_add_u32 s56, s56, s62
    v_mov_b32 v54, v50
    v_mov_b32 v55, v51
    v_permlane16_swap_b32 v48, v52
    v_mfma_f32_16x16x32_bf16 v[144:147], a[40:43], v[88:91], v[144:147]
    s_addk_i32 m0, 4096
    ds_read_b128 a[60:63], v9 offset:63488
    v_and_or_b32 v18, v18, s44, v1
    v_mfma_f32_16x16x32_bf16 v[144:147], a[44:47], v[96:99], v[144:147]
    buffer_load_dwordx4 v5, s[8:11], s56 offen lds
    v_mfma_f32_16x16x32_bf16 v[148:151], a[40:43], v[92:95], v[148:151]
    ds_read_b128 a[64:67], v10 offset:0
    v_and_or_b32 v19, v19, s44, v1
    v_mfma_f32_16x16x32_bf16 v[148:151], a[44:47], v[100:103], v[148:151]
    s_waitcnt lgkmcnt(2)
    v_permlane16_swap_b32 v49, v53
    v_permlane16_swap_b32 v50, v54
    v_mfma_f32_16x16x32_bf16 v[152:155], a[48:51], v[88:91], v[152:155]
    s_addk_i32 s59, 28672
    ds_read_b128 a[68:71], v11 offset:0
    v_and_or_b32 v20, v20, s44, v1
    v_mfma_f32_16x16x32_bf16 v[152:155], a[52:55], v[96:99], v[152:155]
    buffer_load_dword v30, v15, s[16:19], s59 offen
    v_mfma_f32_16x16x32_bf16 v[156:159], a[48:51], v[92:95], v[156:159]
    s_add_u32 s56, s56, s62
    ds_read_b128 a[72:75], v10 offset:2048
    v_and_or_b32 v21, v21, s44, v1
    v_mfma_f32_16x16x32_bf16 v[156:159], a[52:55], v[100:103], v[156:159]
    buffer_load_dword v31, v15, s[20:23], s59 offen
    v_mfma_f32_16x16x32_bf16 v[160:163], a[56:59], v[88:91], v[160:163]
    s_waitcnt lgkmcnt(2)
    s_add_u32 s57, s57, s61
    ds_read_b128 a[76:79], v11 offset:2048
    v_mfma_f32_16x16x32_bf16 v[160:163], a[60:63], v[96:99], v[160:163]
    buffer_load_dwordx2 v[26:27], v3, s[12:15], s57 offen
    v_mfma_f32_16x16x32_bf16 v[164:167], a[56:59], v[92:95], v[164:167]
    s_addk_i32 m0, 4096
    ds_read_b128 a[80:83], v10 offset:4096
    v_perm_b32 v104, v124, v125, v18
    v_mfma_f32_16x16x32_bf16 v[164:167], a[60:63], v[100:103], v[164:167]
    buffer_load_dwordx4 v5, s[8:11], s56 offen lds
    v_mfma_f32_16x16x32_bf16 v[168:171], a[64:67], v[88:91], v[168:171]
    s_waitcnt lgkmcnt(2)
    ds_read_b128 a[84:87], v11 offset:4096
    v_perm_b32 v105, v124, v125, v20
    v_mfma_f32_16x16x32_bf16 v[168:171], a[68:71], v[96:99], v[168:171]
    s_add_u32 s56, s56, s62
    v_permlane16_swap_b32 v51, v55
    v_perm_b32 v106, v124, v125, v19
    v_perm_b32 v107, v124, v125, v21
    v_mfma_f32_16x16x32_bf16 v[172:175], a[64:67], v[92:95], v[172:175]
    s_addk_i32 m0, 4096
    ds_read_b128 a[88:91], v10 offset:6144
    v_perm_b32 v18, v16, v28, s42
    v_mfma_f32_16x16x32_bf16 v[172:175], a[68:71], v[100:103], v[172:175]
    buffer_load_dwordx4 v5, s[8:11], s56 offen lds
    v_mfma_f32_16x16x32_bf16 v[176:179], a[72:75], v[88:91], v[176:179]
    s_waitcnt lgkmcnt(2)
    ds_read_b128 a[92:95], v11 offset:6144
    v_perm_b32 v19, v16, v28, s43
    v_mfma_f32_16x16x32_bf16 v[176:179], a[76:79], v[96:99], v[176:179]
    buffer_load_dword a96, v7, s[8:11], s29 offen
    v_mfma_f32_16x16x32_bf16 v[180:183], a[72:75], v[92:95], v[180:183]
    ds_read_b128 a[0:3], v10 offset:8192
    v_lshrrev_b64 v[20:21], 4, v[18:19]
    v_mfma_f32_16x16x32_bf16 v[180:183], a[76:79], v[100:103], v[180:183]
    v_and_or_b32 v18, v18, s44, v1
    v_and_or_b32 v19, v19, s44, v1
    v_and_or_b32 v20, v20, s44, v1
    v_and_or_b32 v21, v21, s44, v1
    v_mfma_f32_16x16x32_bf16 v[184:187], a[80:83], v[88:91], v[184:187]
    s_waitcnt lgkmcnt(2)
    ds_read_b128 a[4:7], v11 offset:8192
    v_perm_b32 v112, v124, v125, v18
    v_mfma_f32_16x16x32_bf16 v[184:187], a[84:87], v[96:99], v[184:187]
    v_perm_b32 v113, v124, v125, v20
    v_perm_b32 v114, v124, v125, v19
    v_perm_b32 v115, v124, v125, v21
    v_mfma_f32_16x16x32_bf16 v[188:191], a[80:83], v[92:95], v[188:191]
    ds_read_b128 a[8:11], v10 offset:10240
    v_perm_b32 v18, v17, v29, s40
    v_mfma_f32_16x16x32_bf16 v[188:191], a[84:87], v[100:103], v[188:191]
    v_perm_b32 v19, v17, v29, s41
    v_lshrrev_b64 v[20:21], 4, v[18:19]
    v_and_or_b32 v18, v18, s44, v1
    v_and_or_b32 v19, v19, s44, v1
    v_mfma_f32_16x16x32_bf16 v[192:195], a[88:91], v[88:91], v[192:195]
    s_waitcnt lgkmcnt(2)
    ds_read_b128 a[12:15], v11 offset:10240
    v_and_or_b32 v20, v20, s44, v1
    v_mfma_f32_16x16x32_bf16 v[192:195], a[92:95], v[96:99], v[192:195]
    v_and_or_b32 v21, v21, s44, v1
    v_perm_b32 v108, v126, v127, v18
    v_perm_b32 v109, v126, v127, v20
    v_perm_b32 v110, v126, v127, v19
    v_mfma_f32_16x16x32_bf16 v[196:199], a[88:91], v[92:95], v[196:199]
    ds_read_b128 a[16:19], v10 offset:12288
    v_perm_b32 v111, v126, v127, v21
    v_mfma_f32_16x16x32_bf16 v[196:199], a[92:95], v[100:103], v[196:199]
    v_perm_b32 v18, v17, v29, s42
    v_perm_b32 v19, v17, v29, s43
    v_lshrrev_b64 v[20:21], 4, v[18:19]
    v_and_or_b32 v18, v18, s44, v1
    v_mfma_f32_16x16x32_bf16 v[200:203], a[0:3], v[88:91], v[200:203]
    s_waitcnt lgkmcnt(2)
    ds_read_b128 a[20:23], v11 offset:12288
    v_and_or_b32 v19, v19, s44, v1
    v_mfma_f32_16x16x32_bf16 v[200:203], a[4:7], v[96:99], v[200:203]
    v_and_or_b32 v20, v20, s44, v1
    v_and_or_b32 v21, v21, s44, v1
    v_perm_b32 v116, v126, v127, v18
    v_perm_b32 v117, v126, v127, v20
    v_mfma_f32_16x16x32_bf16 v[204:207], a[0:3], v[92:95], v[204:207]
    ds_read_b128 a[24:27], v10 offset:14336
    v_perm_b32 v118, v126, v127, v19
    v_mfma_f32_16x16x32_bf16 v[204:207], a[4:7], v[100:103], v[204:207]
    s_waitcnt vmcnt(13) lgkmcnt(2)
    v_perm_b32 v119, v126, v127, v21
    v_lshrrev_b64 v[16:17], 2, v[22:23]
    v_perm_b32 v18, v16, v22, s40
    v_perm_b32 v19, v16, v22, s41
    v_mfma_f32_16x16x32_bf16 v[208:211], a[8:11], v[88:91], v[208:211]
    ds_read_b128 a[28:31], v11 offset:14336
    v_lshrrev_b64 v[20:21], 4, v[18:19]
    v_mfma_f32_16x16x32_bf16 v[208:211], a[12:15], v[96:99], v[208:211]
    v_and_or_b32 v18, v18, s44, v1
    v_and_or_b32 v19, v19, s44, v1
    v_and_or_b32 v20, v20, s44, v1
    v_and_or_b32 v21, v21, s44, v1
    v_mfma_f32_16x16x32_bf16 v[212:215], a[8:11], v[92:95], v[212:215]
    ds_read_b128 a[32:35], v10 offset:16384
    v_perm_b32 v120, v40, v41, v18
    v_mfma_f32_16x16x32_bf16 v[212:215], a[12:15], v[100:103], v[212:215]
    v_perm_b32 v121, v40, v41, v20
    v_perm_b32 v122, v40, v41, v19
    v_perm_b32 v123, v40, v41, v21
    v_perm_b32 v18, v16, v22, s42
    v_mfma_f32_16x16x32_bf16 v[216:219], a[16:19], v[88:91], v[216:219]
    s_waitcnt lgkmcnt(2)
    ds_read_b128 a[36:39], v11 offset:16384
    v_perm_b32 v19, v16, v22, s43
    v_mfma_f32_16x16x32_bf16 v[216:219], a[20:23], v[96:99], v[216:219]
    s_add_u32 s56, s56, s62
    v_lshrrev_b64 v[20:21], 4, v[18:19]
    v_and_or_b32 v18, v18, s44, v1
    v_and_or_b32 v19, v19, s44, v1
    v_and_or_b32 v20, v20, s44, v1
    v_mfma_f32_16x16x32_bf16 v[220:223], a[16:19], v[92:95], v[220:223]
    s_addk_i32 m0, 4096
    ds_read_b128 a[40:43], v10 offset:18432
    v_and_or_b32 v21, v21, s44, v1
    v_mfma_f32_16x16x32_bf16 v[220:223], a[20:23], v[100:103], v[220:223]
    buffer_load_dwordx4 v5, s[8:11], s56 offen lds
    v_mfma_f32_16x16x32_bf16 v[224:227], a[24:27], v[88:91], v[224:227]
    s_waitcnt vmcnt(9) lgkmcnt(2)
    ds_read_b128 a[44:47], v11 offset:18432
    v_mfma_f32_16x16x32_bf16 v[224:227], a[28:31], v[96:99], v[224:227]
L_hopB2:
    s_cbranch_execz L_hopret
    s_barrier
    v_mfma_f32_16x16x32_bf16 v[228:231], a[24:27], v[92:95], v[228:231]
    s_waitcnt lgkmcnt(2)
    ds_read_b128 a[48:51], v10 offset:20480
    v_perm_b32 v128, v40, v41, v18
    v_mfma_f32_16x16x32_bf16 v[228:231], a[28:31], v[100:103], v[228:231]
    s_movk_i32 s56, 640
    v_perm_b32 v129, v40, v41, v20
    v_perm_b32 v130, v40, v41, v19
    v_perm_b32 v131, v40, v41, v21
    v_perm_b32 v18, v17, v23, s40
    v_mfma_f32_16x16x32_bf16 v[232:235], a[32:35], v[88:91], v[232:235]
    s_addk_i32 m0, 4096
    ds_read_b128 a[52:55], v11 offset:20480
    v_perm_b32 v19, v17, v23, s41
    v_mfma_f32_16x16x32_bf16 v[232:235], a[36:39], v[96:99], v[232:235]
    buffer_load_dwordx4 v5, s[8:11], s56 offen lds
    v_mfma_f32_16x16x32_bf16 v[236:239], a[32:35], v[92:95], v[236:239]
    s_waitcnt lgkmcnt(2)
    ds_read_b128 a[56:59], v10 offset:22528
    v_lshrrev_b64 v[20:21], 4, v[18:19]
    v_mfma_f32_16x16x32_bf16 v[236:239], a[36:39], v[100:103], v[236:239]
    s_add_u32 s56, s56, s62
    v_and_or_b32 v18, v18, s44, v1
    v_and_or_b32 v19, v19, s44, v1
    v_and_or_b32 v20, v20, s44, v1
    v_mfma_f32_16x16x32_bf16 v[240:243], a[40:43], v[88:91], v[240:243]
    s_addk_i32 m0, 4096
    ds_read_b128 a[60:63], v11 offset:22528
    v_and_or_b32 v21, v21, s44, v1
    v_mfma_f32_16x16x32_bf16 v[240:243], a[44:47], v[96:99], v[240:243]
    buffer_load_dwordx4 v5, s[8:11], s56 offen lds
    v_mfma_f32_16x16x32_bf16 v[244:247], a[40:43], v[92:95], v[244:247]
    ds_read_b128 a[64:67], v10 offset:24576
    v_perm_b32 v124, v42, v43, v18
    v_mfma_f32_16x16x32_bf16 v[244:247], a[44:47], v[100:103], v[244:247]
    s_waitcnt lgkmcnt(2)
    v_perm_b32 v125, v42, v43, v20
    v_perm_b32 v126, v42, v43, v19
    v_perm_b32 v127, v42, v43, v21
    v_perm_b32 v18, v17, v23, s42
    v_mfma_f32_16x16x32_bf16 v[136:139], a[48:51], v[104:107], v[136:139]
    ds_read_b128 a[68:71], v11 offset:24576
    v_perm_b32 v19, v17, v23, s43
    v_mfma_f32_16x16x32_bf16 v[136:139], a[52:55], v[112:115], v[136:139]
    s_add_u32 s56, s56, s62
    v_lshrrev_b64 v[20:21], 4, v[18:19]
    v_and_or_b32 v18, v18, s44, v1
    v_and_or_b32 v19, v19, s44, v1
    v_and_or_b32 v20, v20, s44, v1
    v_mfma_f32_16x16x32_bf16 v[140:143], a[48:51], v[108:111], v[140:143]
    s_addk_i32 m0, 4096
    ds_read_b128 a[72:75], v10 offset:26624
    v_and_or_b32 v21, v21, s44, v1
    v_mfma_f32_16x16x32_bf16 v[140:143], a[52:55], v[116:119], v[140:143]
    buffer_load_dwordx4 v5, s[8:11], s56 offen lds
    v_mfma_f32_16x16x32_bf16 v[144:147], a[56:59], v[104:107], v[144:147]
    s_waitcnt lgkmcnt(2)
    ds_read_b128 a[76:79], v11 offset:26624
    ds_read_b128 a[80:83], v10 offset:28672
    v_mfma_f32_16x16x32_bf16 v[144:147], a[60:63], v[112:115], v[144:147]
    v_perm_b32 v132, v42, v43, v18
    v_perm_b32 v133, v42, v43, v20
    v_perm_b32 v134, v42, v43, v19
    v_perm_b32 v135, v42, v43, v21
    v_mfma_f32_16x16x32_bf16 v[148:151], a[56:59], v[108:111], v[148:151]
    s_waitcnt vmcnt(11) lgkmcnt(3)
    ds_read_b128 a[84:87], v11 offset:28672
    v_lshrrev_b64 v[16:17], 2, v[24:25]
    v_mfma_f32_16x16x32_bf16 v[148:151], a[60:63], v[116:119], v[148:151]
    v_perm_b32 v18, v16, v24, s40
    v_perm_b32 v19, v16, v24, s41
    v_lshrrev_b64 v[20:21], 4, v[18:19]
    v_and_or_b32 v18, v18, s44, v1
    v_mfma_f32_16x16x32_bf16 v[152:155], a[64:67], v[104:107], v[152:155]
    s_addk_i32 s59, 28672
    ds_read_b128 a[88:91], v10 offset:30720
    v_and_or_b32 v19, v19, s44, v1
    v_mfma_f32_16x16x32_bf16 v[152:155], a[68:71], v[112:115], v[152:155]
    buffer_load_dword v32, v15, s[16:19], s59 offen
    v_mfma_f32_16x16x32_bf16 v[156:159], a[64:67], v[108:111], v[156:159]
    s_waitcnt lgkmcnt(2)
    s_add_u32 s56, s56, s62
    ds_read_b128 a[92:95], v11 offset:30720
    v_and_or_b32 v20, v20, s44, v1
    v_mfma_f32_16x16x32_bf16 v[156:159], a[68:71], v[116:119], v[156:159]
    buffer_load_dword v33, v15, s[20:23], s59 offen
    v_mfma_f32_16x16x32_bf16 v[160:163], a[72:75], v[104:107], v[160:163]
    s_add_u32 m0, s47, 0
    ds_read_b128 a[0:3], v10 offset:32768
    v_mfma_f32_16x16x32_bf16 v[160:163], a[76:79], v[112:115], v[160:163]
    buffer_load_dwordx4 v5, s[8:11], s56 offen lds
    v_mfma_f32_16x16x32_bf16 v[164:167], a[72:75], v[108:111], v[164:167]
    s_waitcnt lgkmcnt(2)
    ds_read_b128 a[4:7], v11 offset:32768
    v_and_or_b32 v21, v21, s44, v1
    v_mfma_f32_16x16x32_bf16 v[164:167], a[76:79], v[116:119], v[164:167]
    s_add_u32 s56, s56, s62
    v_perm_b32 v56, v44, v45, v18
    v_perm_b32 v57, v44, v45, v20
    v_perm_b32 v58, v44, v45, v19
    v_perm_b32 v59, v44, v45, v21
    v_mfma_f32_16x16x32_bf16 v[168:171], a[80:83], v[104:107], v[168:171]
    s_addk_i32 m0, 4096
    ds_read_b128 a[8:11], v10 offset:34816
    v_perm_b32 v18, v16, v24, s42
    v_mfma_f32_16x16x32_bf16 v[168:171], a[84:87], v[112:115], v[168:171]
    buffer_load_dwordx4 v5, s[8:11], s56 offen lds
    v_mfma_f32_16x16x32_bf16 v[172:175], a[80:83], v[108:111], v[172:175]
    ds_read_b128 a[12:15], v11 offset:34816
    ds_read_b128 a[16:19], v10 offset:36864
    v_mfma_f32_16x16x32_bf16 v[172:175], a[84:87], v[116:119], v[172:175]
    v_perm_b32 v19, v16, v24, s43
    v_lshrrev_b64 v[20:21], 4, v[18:19]
    v_and_or_b32 v18, v18, s44, v1
    v_and_or_b32 v19, v19, s44, v1
    v_mfma_f32_16x16x32_bf16 v[176:179], a[88:91], v[104:107], v[176:179]
    s_waitcnt lgkmcnt(3)
    ds_read_b128 a[20:23], v11 offset:36864
    v_and_or_b32 v20, v20, s44, v1
    v_mfma_f32_16x16x32_bf16 v[176:179], a[92:95], v[112:115], v[176:179]
    s_add_u32 s56, s56, s62
    v_and_or_b32 v21, v21, s44, v1
    v_perm_b32 v64, v44, v45, v18
    v_perm_b32 v65, v44, v45, v20
    v_perm_b32 v66, v44, v45, v19
    v_mfma_f32_16x16x32_bf16 v[180:183], a[88:91], v[108:111], v[180:183]
    s_addk_i32 m0, 4096
    ds_read_b128 a[24:27], v10 offset:38912
    v_perm_b32 v67, v44, v45, v21
    v_mfma_f32_16x16x32_bf16 v[180:183], a[92:95], v[116:119], v[180:183]
    buffer_load_dwordx4 v5, s[8:11], s56 offen lds
    v_mfma_f32_16x16x32_bf16 v[184:187], a[0:3], v[104:107], v[184:187]
    ds_read_b128 a[28:31], v11 offset:38912
    v_perm_b32 v18, v17, v25, s40
    v_mfma_f32_16x16x32_bf16 v[184:187], a[4:7], v[112:115], v[184:187]
    v_perm_b32 v19, v17, v25, s41
    v_lshrrev_b64 v[20:21], 4, v[18:19]
    v_and_or_b32 v18, v18, s44, v1
    v_and_or_b32 v19, v19, s44, v1
    v_mfma_f32_16x16x32_bf16 v[188:191], a[0:3], v[108:111], v[188:191]
    s_waitcnt lgkmcnt(2)
    ds_read_b128 a[32:35], v10 offset:40960
    v_and_or_b32 v20, v20, s44, v1
    v_mfma_f32_16x16x32_bf16 v[188:191], a[4:7], v[116:119], v[188:191]
    s_add_u32 s56, s56, s62
    v_and_or_b32 v21, v21, s44, v1
    v_perm_b32 v60, v46, v47, v18
    v_perm_b32 v61, v46, v47, v20
    v_perm_b32 v62, v46, v47, v19
    v_mfma_f32_16x16x32_bf16 v[192:195], a[8:11], v[104:107], v[192:195]
    s_addk_i32 m0, 4096
    ds_read_b128 a[36:39], v11 offset:40960
    v_perm_b32 v63, v46, v47, v21
    v_mfma_f32_16x16x32_bf16 v[192:195], a[12:15], v[112:115], v[192:195]
    buffer_load_dwordx4 v5, s[8:11], s56 offen lds
    v_mfma_f32_16x16x32_bf16 v[196:199], a[8:11], v[108:111], v[196:199]
    ds_read_b128 a[40:43], v10 offset:43008
    v_perm_b32 v18, v17, v25, s42
    v_mfma_f32_16x16x32_bf16 v[196:199], a[12:15], v[116:119], v[196:199]
    v_perm_b32 v19, v17, v25, s43
    v_lshrrev_b64 v[20:21], 4, v[18:19]
    v_and_or_b32 v18, v18, s44, v1
    v_and_or_b32 v19, v19, s44, v1
    v_mfma_f32_16x16x32_bf16 v[200:203], a[16:19], v[104:107], v[200:203]
    s_waitcnt lgkmcnt(2)
    ds_read_b128 a[44:47], v11 offset:43008
    ds_read_b128 a[48:51], v10 offset:45056
    v_mfma_f32_16x16x32_bf16 v[200:203], a[20:23], v[112:115], v[200:203]
    s_movk_i32 s56, 768
    v_and_or_b32 v20, v20, s44, v1
    v_and_or_b32 v21, v21, s44, v1
    v_perm_b32 v68, v46, v47, v18
    v_mfma_f32_16x16x32_bf16 v[204:207], a[16:19], v[108:111], v[204:207]
    s_addk_i32 m0, 4096
    ds_read_b128 a[52:55], v11 offset:45056
    v_perm_b32 v69, v46, v47, v20
    v_mfma_f32_16x16x32_bf16 v[204:207], a[20:23], v[116:119], v[204:207]
    buffer_load_dwordx4 v5, s[8:11], s56 offen lds
    v_mfma_f32_16x16x32_bf16 v[208:211], a[24:27], v[104:107], v[208:211]
    s_waitcnt vmcnt(15) lgkmcnt(3)
    ds_read_b128 a[56:59], v10 offset:47104
    v_perm_b32 v70, v46, v47, v19
    v_mfma_f32_16x16x32_bf16 v[208:211], a[28:31], v[112:115], v[208:211]
    s_add_u32 s56, s56, s62
    v_perm_b32 v71, v46, v47, v21
    v_lshlrev_b32 v36, 16, v30
    v_lshlrev_b32 v37, 16, v31
    v_mul_f32 v37, v36, v37
    v_mfma_f32_16x16x32_bf16 v[212:215], a[24:27], v[108:111], v[212:215]
    s_add_u32 s57, s57, s61
    ds_read_b128 a[60:63], v11 offset:47104
    v_sub_f32 v38, v36, v37
    v_mfma_f32_16x16x32_bf16 v[212:215], a[28:31], v[116:119], v[212:215]
    buffer_load_dwordx2 v[28:29], v3, s[12:15], s57 offen
    v_mfma_f32_16x16x32_bf16 v[216:219], a[32:35], v[104:107], v[216:219]
    s_addk_i32 m0, 4096
    ds_read_b128 a[64:67], v10 offset:49152
    v_fma_f32 v39, 2.0, v36, -v37
    v_mfma_f32_16x16x32_bf16 v[216:219], a[36:39], v[112:115], v[216:219]
    buffer_load_dwordx4 v5, s[8:11], s56 offen lds
    v_mfma_f32_16x16x32_bf16 v[220:223], a[32:35], v[108:111], v[220:223]
    ds_read_b128 a[68:71], v11 offset:49152
    v_add_f32 v36, v39, v36
    v_mfma_f32_16x16x32_bf16 v[220:223], a[36:39], v[116:119], v[220:223]
    v_cvt_pk_bf16_f32 v37, -v37, v38
    v_cvt_pk_bf16_f32 v38, v39, v36
    v_perm_b32 v40, v38, v37, s46
    v_perm_b32 v41, v38, v37, s45
    v_mfma_f32_16x16x32_bf16 v[224:227], a[40:43], v[104:107], v[224:227]
    s_waitcnt lgkmcnt(2)
    ds_read_b128 a[72:75], v10 offset:51200
    v_and_b32 v36, 0xffff0000, v30
    v_mfma_f32_16x16x32_bf16 v[224:227], a[44:47], v[112:115], v[224:227]
    s_add_u32 s56, s56, s62
    v_and_b32 v37, 0xffff0000, v31
    v_mul_f32 v37, v36, v37
    v_sub_f32 v38, v36, v37
    v_fma_f32 v39, 2.0, v36, -v37
    v_mfma_f32_16x16x32_bf16 v[228:231], a[40:43], v[108:111], v[228:231]
    s_addk_i32 m0, 4096
    ds_read_b128 a[76:79], v11 offset:51200
    ds_read_b128 a[80:83], v10 offset:53248
    v_mfma_f32_16x16x32_bf16 v[228:231], a[44:47], v[116:119], v[228:231]
    buffer_load_dwordx4 v5, s[8:11], s56 offen lds
    v_mfma_f32_16x16x32_bf16 v[232:235], a[48:51], v[104:107], v[232:235]
    ds_read_b128 a[84:87], v11 offset:53248
    v_add_f32 v36, v39, v36
    v_mfma_f32_16x16x32_bf16 v[232:235], a[52:55], v[112:115], v[232:235]
    v_cvt_pk_bf16_f32 v37, -v37, v38
    v_cvt_pk_bf16_f32 v38, v39, v36
    v_perm_b32 v42, v38, v37, s46
    v_perm_b32 v43, v38, v37, s45
    v_mfma_f32_16x16x32_bf16 v[236:239], a[48:51], v[108:111], v[236:239]
    s_waitcnt vmcnt(17) lgkmcnt(3)
    ds_read_b128 a[88:91], v10 offset:55296
    v_lshrrev_b64 v[16:17], 2, v[26:27]
    v_mfma_f32_16x16x32_bf16 v[236:239], a[52:55], v[116:119], v[236:239]
    s_add_u32 s56, s56, s62
    v_perm_b32 v18, v16, v26, s40
    v_perm_b32 v19, v16, v26, s41
    v_lshrrev_b64 v[20:21], 4, v[18:19]
    v_and_or_b32 v18, v18, s44, v1
    v_mfma_f32_16x16x32_bf16 v[240:243], a[56:59], v[104:107], v[240:243]
    s_addk_i32 m0, 4096
    ds_read_b128 a[92:95], v11 offset:55296
    v_and_or_b32 v19, v19, s44, v1
    v_mfma_f32_16x16x32_bf16 v[240:243], a[60:63], v[112:115], v[240:243]
    buffer_load_dwordx4 v5, s[8:11], s56 offen lds
    v_mfma_f32_16x16x32_bf16 v[244:247], a[56:59], v[108:111], v[244:247]
    ds_read_b128 a[0:3], v10 offset:57344
    v_and_or_b32 v20, v20, s44, v1
    v_mfma_f32_16x16x32_bf16 v[244:247], a[60:63], v[116:119], v[244:247]
    v_and_or_b32 v21, v21, s44, v1
    v_perm_b32 v72, v48, v49, v18
    v_perm_b32 v73, v48, v49, v20
    v_perm_b32 v74, v48, v49, v19
    v_mfma_f32_16x16x32_bf16 v[136:139], a[64:67], v[120:123], v[136:139]
    s_waitcnt vmcnt(9) lgkmcnt(2)
    ds_read_b128 a[4:7], v11 offset:57344
    v_perm_b32 v75, v48, v49, v21
    v_mfma_f32_16x16x32_bf16 v[136:139], a[68:71], v[128:131], v[136:139]
    s_add_u32 s56, s56, s62
    v_perm_b32 v18, v16, v26, s42
    v_perm_b32 v19, v16, v26, s43
    v_lshrrev_b64 v[20:21], 4, v[18:19]
    v_and_or_b32 v18, v18, s44, v1
    v_mfma_f32_16x16x32_bf16 v[140:143], a[64:67], v[124:127], v[140:143]
    s_addk_i32 m0, 4096
    ds_read_b128 a[8:11], v10 offset:59392
    v_lshlrev_b32 v36, 16, v32
    v_mfma_f32_16x16x32_bf16 v[140:143], a[68:71], v[132:135], v[140:143]
    buffer_load_dwordx4 v5, s[8:11], s56 offen lds
    v_mfma_f32_16x16x32_bf16 v[144:147], a[72:75], v[120:123], v[144:147]
    s_waitcnt lgkmcnt(2)
    ds_read_b128 a[12:15], v11 offset:59392
    v_lshlrev_b32 v37, 16, v33
    v_mfma_f32_16x16x32_bf16 v[144:147], a[76:79], v[128:131], v[144:147]
    s_barrier
    v_mfma_f32_16x16x32_bf16 v[148:151], a[72:75], v[124:127], v[148:151]
    ds_read_b128 a[16:19], v10 offset:61440
    v_mul_f32 v37, v36, v37
    v_mfma_f32_16x16x32_bf16 v[148:151], a[76:79], v[132:135], v[148:151]
    s_add_u32 s56, s56, s62
    v_sub_f32 v38, v36, v37
    v_fma_f32 v39, 2.0, v36, -v37
    v_add_f32 v36, v39, v36
    v_cvt_pk_bf16_f32 v37, -v37, v38
    v_mfma_f32_16x16x32_bf16 v[152:155], a[80:83], v[120:123], v[152:155]
    s_addk_i32 m0, 4096
    ds_read_b128 a[20:23], v11 offset:61440
    v_cvt_pk_bf16_f32 v38, v39, v36
    v_mfma_f32_16x16x32_bf16 v[152:155], a[84:87], v[128:131], v[152:155]
    buffer_load_dwordx4 v5, s[8:11], s56 offen lds
    v_mfma_f32_16x16x32_bf16 v[156:159], a[80:83], v[124:127], v[156:159]
    ds_read_b128 a[24:27], v10 offset:63488
    v_perm_b32 v44, v38, v37, s46
    v_mfma_f32_16x16x32_bf16 v[156:159], a[84:87], v[132:135], v[156:159]
    v_perm_b32 v45, v38, v37, s45
    v_and_b32 v36, 0xffff0000, v32
    v_and_b32 v37, 0xffff0000, v33
    v_mul_f32 v37, v36, v37
    v_mfma_f32_16x16x32_bf16 v[160:163], a[88:91], v[120:123], v[160:163]
    ds_read_b128 a[28:31], v11 offset:63488
    v_sub_f32 v38, v36, v37
    v_mfma_f32_16x16x32_bf16 v[160:163], a[92:95], v[128:131], v[160:163]
    s_add_u32 s56, s56, s62
    v_fma_f32 v39, 2.0, v36, -v37
    v_add_f32 v36, v39, v36
    v_cvt_pk_bf16_f32 v37, -v37, v38
    v_mfma_f32_16x16x32_bf16 v[164:167], a[88:91], v[124:127], v[164:167]
    s_add_u32 s57, s57, s61
    ds_read_b128 a[32:35], v12 offset:0
    v_cvt_pk_bf16_f32 v38, v39, v36
    v_mfma_f32_16x16x32_bf16 v[164:167], a[92:95], v[132:135], v[164:167]
    buffer_load_dwordx2 v[22:23], v3, s[12:15], s57 offen
    v_mfma_f32_16x16x32_bf16 v[168:171], a[0:3], v[120:123], v[168:171]
    s_waitcnt lgkmcnt(2)
    s_addk_i32 m0, 4096
    ds_read_b128 a[36:39], v13 offset:0
    v_perm_b32 v46, v38, v37, s46
    v_mfma_f32_16x16x32_bf16 v[168:171], a[4:7], v[128:131], v[168:171]
    buffer_load_dwordx4 v5, s[8:11], s56 offen lds
    v_mfma_f32_16x16x32_bf16 v[172:175], a[0:3], v[124:127], v[172:175]
    ds_read_b128 a[40:43], v12 offset:2048
    v_perm_b32 v47, v38, v37, s45
    v_mfma_f32_16x16x32_bf16 v[172:175], a[4:7], v[132:135], v[172:175]
    s_movk_i32 s56, 896
    v_and_or_b32 v19, v19, s44, v1
    v_and_or_b32 v20, v20, s44, v1
    v_mfma_f32_16x16x32_bf16 v[176:179], a[8:11], v[120:123], v[176:179]
    s_addk_i32 m0, 4096
    ds_read_b128 a[44:47], v13 offset:2048
    v_and_or_b32 v21, v21, s44, v1
    v_mfma_f32_16x16x32_bf16 v[176:179], a[12:15], v[128:131], v[176:179]
    buffer_load_dwordx4 v5, s[8:11], s56 offen lds
    v_mfma_f32_16x16x32_bf16 v[180:183], a[8:11], v[124:127], v[180:183]
    ds_read_b128 a[48:51], v12 offset:4096
    v_perm_b32 v80, v48, v49, v18
    v_mfma_f32_16x16x32_bf16 v[180:183], a[12:15], v[132:135], v[180:183]
    v_perm_b32 v81, v48, v49, v20
    v_perm_b32 v82, v48, v49, v19
    v_mfma_f32_16x16x32_bf16 v[184:187], a[16:19], v[120:123], v[184:187]
    ds_read_b128 a[52:55], v13 offset:4096
    v_perm_b32 v83, v48, v49, v21
    v_mfma_f32_16x16x32_bf16 v[184:187], a[20:23], v[128:131], v[184:187]
    s_add_u32 s56, s56, s62
    v_perm_b32 v18, v17, v27, s40
    v_perm_b32 v19, v17, v27, s41
    v_mfma_f32_16x16x32_bf16 v[188:191], a[16:19], v[124:127], v[188:191]
    s_addk_i32 m0, 4096
    ds_read_b128 a[56:59], v12 offset:6144
    v_lshrrev_b64 v[20:21], 4, v[18:19]
    v_mfma_f32_16x16x32_bf16 v[188:191], a[20:23], v[132:135], v[188:191]
    buffer_load_dwordx4 v5, s[8:11], s56 offen lds
    v_mfma_f32_16x16x32_bf16 v[192:195], a[24:27], v[120:123], v[192:195]
    s_waitcnt lgkmcnt(2)
    ds_read_b128 a[60:63], v13 offset:6144
    v_and_or_b32 v18, v18, s44, v1
    v_mfma_f32_16x16x32_bf16 v[192:195], a[28:31], v[128:131], v[192:195]
    v_and_or_b32 v19, v19, s44, v1
    v_and_or_b32 v20, v20, s44, v1
    v_mfma_f32_16x16x32_bf16 v[196:199], a[24:27], v[124:127], v[196:199]
    ds_read_b128 a[64:67], v12 offset:8192
    v_and_or_b32 v21, v21, s44, v1
    v_mfma_f32_16x16x32_bf16 v[196:199], a[28:31], v[132:135], v[196:199]
    s_add_u32 s56, s56, s62
    v_perm_b32 v76, v50, v51, v18
    v_perm_b32 v77, v50, v51, v20
    v_mfma_f32_16x16x32_bf16 v[200:203], a[32:35], v[120:123], v[200:203]
    s_add_u32 s57, s57, s61
    ds_read_b128 a[68:71], v13 offset:8192
    v_perm_b32 v78, v50, v51, v19
    v_mfma_f32_16x16x32_bf16 v[200:203], a[36:39], v[128:131], v[200:203]
    buffer_load_dwordx2 v[24:25], v3, s[12:15], s57 offen
    v_mfma_f32_16x16x32_bf16 v[204:207], a[32:35], v[124:127], v[204:207]
    s_addk_i32 m0, 4096
    ds_read_b128 a[72:75], v12 offset:10240
    v_perm_b32 v79, v50, v51, v21
    v_mfma_f32_16x16x32_bf16 v[204:207], a[36:39], v[132:135], v[204:207]
    buffer_load_dwordx4 v5, s[8:11], s56 offen lds
    v_mfma_f32_16x16x32_bf16 v[208:211], a[40:43], v[120:123], v[208:211]
    ds_read_b128 a[76:79], v13 offset:10240
    v_perm_b32 v18, v17, v27, s42
    v_mfma_f32_16x16x32_bf16 v[208:211], a[44:47], v[128:131], v[208:211]
    s_add_u32 s56, s56, s62
    v_perm_b32 v19, v17, v27, s43
    v_lshrrev_b64 v[20:21], 4, v[18:19]
    v_mfma_f32_16x16x32_bf16 v[212:215], a[40:43], v[124:127], v[212:215]
    s_addk_i32 m0, 4096
    ds_read_b128 a[80:83], v12 offset:12288
    v_and_or_b32 v18, v18, s44, v1
    v_mfma_f32_16x16x32_bf16 v[212:215], a[44:47], v[132:135], v[212:215]
    buffer_load_dwordx4 v5, s[8:11], s56 offen lds
    v_mfma_f32_16x16x32_bf16 v[216:219], a[48:51], v[120:123], v[216:219]
    s_waitcnt lgkmcnt(2)
    ds_read_b128 a[84:87], v13 offset:12288
    v_and_or_b32 v19, v19, s44, v1
    v_mfma_f32_16x16x32_bf16 v[216:219], a[52:55], v[128:131], v[216:219]
    v_and_or_b32 v20, v20, s44, v1
    v_and_or_b32 v21, v21, s44, v1
    v_mfma_f32_16x16x32_bf16 v[220:223], a[48:51], v[124:127], v[220:223]
    s_waitcnt vmcnt(9) lgkmcnt(2)
    ds_read_b128 a[88:91], v12 offset:14336
    v_perm_b32 v84, v50, v51, v18
    v_mfma_f32_16x16x32_bf16 v[220:223], a[52:55], v[132:135], v[220:223]
    s_barrier
    v_mfma_f32_16x16x32_bf16 v[224:227], a[56:59], v[120:123], v[224:227]
    ds_read_b128 a[92:95], v13 offset:14336
    v_perm_b32 v85, v50, v51, v20
    v_mfma_f32_16x16x32_bf16 v[224:227], a[60:63], v[128:131], v[224:227]
    buffer_load_dword a96, v7, s[8:11], s30 offen
    v_mfma_f32_16x16x32_bf16 v[228:231], a[56:59], v[124:127], v[228:231]
    ds_read_b128 a[0:3], v12 offset:16384
    v_perm_b32 v86, v50, v51, v19
    v_mfma_f32_16x16x32_bf16 v[228:231], a[60:63], v[132:135], v[228:231]
    v_perm_b32 v87, v50, v51, v21
    v_lshrrev_b64 v[16:17], 2, v[28:29]
    v_mfma_f32_16x16x32_bf16 v[232:235], a[64:67], v[120:123], v[232:235]
    ds_read_b128 a[4:7], v13 offset:16384
    v_perm_b32 v18, v16, v28, s40
    v_mfma_f32_16x16x32_bf16 v[232:235], a[68:71], v[128:131], v[232:235]
    v_perm_b32 v19, v16, v28, s41
    v_lshrrev_b64 v[20:21], 4, v[18:19]
    v_mfma_f32_16x16x32_bf16 v[236:239], a[64:67], v[124:127], v[236:239]
    ds_read_b128 a[8:11], v12 offset:18432
    v_and_or_b32 v18, v18, s44, v1
    v_mfma_f32_16x16x32_bf16 v[236:239], a[68:71], v[132:135], v[236:239]
    v_and_or_b32 v19, v19, s44, v1
    v_and_or_b32 v20, v20, s44, v1
    v_mfma_f32_16x16x32_bf16 v[240:243], a[72:75], v[120:123], v[240:243]
    ds_read_b128 a[12:15], v13 offset:18432
    v_and_or_b32 v21, v21, s44, v1
    v_mfma_f32_16x16x32_bf16 v[240:243], a[76:79], v[128:131], v[240:243]
    v_perm_b32 v88, v52, v53, v18
    v_perm_b32 v89, v52, v53, v20
    v_mfma_f32_16x16x32_bf16 v[244:247], a[72:75], v[124:127], v[244:247]
    ds_read_b128 a[16:19], v12 offset:20480
    v_perm_b32 v90, v52, v53, v19
    v_mfma_f32_16x16x32_bf16 v[244:247], a[76:79], v[132:135], v[244:247]
    s_waitcnt lgkmcnt(2)
    v_perm_b32 v91, v52, v53, v21
    v_perm_b32 v18, v16, v28, s42
    v_mfma_f32_16x16x32_bf16 v[136:139], a[80:83], v[56:59], v[136:139]
    ds_read_b128 a[20:23], v13 offset:20480
    v_perm_b32 v19, v16, v28, s43
    v_mfma_f32_16x16x32_bf16 v[136:139], a[84:87], v[64:67], v[136:139]
    v_lshrrev_b64 v[20:21], 4, v[18:19]
    v_and_or_b32 v18, v18, s44, v1
    v_mfma_f32_16x16x32_bf16 v[140:143], a[80:83], v[60:63], v[140:143]
    ds_read_b128 a[24:27], v12 offset:22528
    v_and_or_b32 v19, v19, s44, v1
    v_mfma_f32_16x16x32_bf16 v[140:143], a[84:87], v[68:71], v[140:143]
    v_and_or_b32 v20, v20, s44, v1
    v_and_or_b32 v21, v21, s44, v1
    v_mfma_f32_16x16x32_bf16 v[144:147], a[88:91], v[56:59], v[144:147]
    ds_read_b128 a[28:31], v13 offset:22528
    v_perm_b32 v96, v52, v53, v18
    v_mfma_f32_16x16x32_bf16 v[144:147], a[92:95], v[64:67], v[144:147]
    v_perm_b32 v97, v52, v53, v20
    v_perm_b32 v98, v52, v53, v19
    v_mfma_f32_16x16x32_bf16 v[148:151], a[88:91], v[60:63], v[148:151]
    ds_read_b128 a[32:35], v8 offset:0
    v_perm_b32 v99, v52, v53, v21
    v_mfma_f32_16x16x32_bf16 v[148:151], a[92:95], v[68:71], v[148:151]
    v_perm_b32 v18, v17, v29, s40
    v_perm_b32 v19, v17, v29, s41
    v_mfma_f32_16x16x32_bf16 v[152:155], a[0:3], v[56:59], v[152:155]
    ds_read_b128 a[36:39], v9 offset:0
    v_lshrrev_b64 v[20:21], 4, v[18:19]
    v_mfma_f32_16x16x32_bf16 v[152:155], a[4:7], v[64:67], v[152:155]
    v_and_or_b32 v18, v18, s44, v1
    v_and_or_b32 v19, v19, s44, v1
    v_mfma_f32_16x16x32_bf16 v[156:159], a[0:3], v[60:63], v[156:159]
    ds_read_b128 a[40:43], v8 offset:2048
    v_and_or_b32 v20, v20, s44, v1
    v_mfma_f32_16x16x32_bf16 v[156:159], a[4:7], v[68:71], v[156:159]
    v_and_or_b32 v21, v21, s44, v1
    v_perm_b32 v92, v54, v55, v18
    v_mfma_f32_16x16x32_bf16 v[160:163], a[8:11], v[56:59], v[160:163]
    s_waitcnt lgkmcnt(2)
    ds_read_b128 a[44:47], v9 offset:2048
    v_perm_b32 v93, v54, v55, v20
    v_mfma_f32_16x16x32_bf16 v[160:163], a[12:15], v[64:67], v[160:163]
    v_perm_b32 v94, v54, v55, v19
    v_perm_b32 v95, v54, v55, v21
    v_mfma_f32_16x16x32_bf16 v[164:167], a[8:11], v[60:63], v[164:167]
    ds_read_b128 a[48:51], v8 offset:4096
    v_perm_b32 v18, v17, v29, s42
    v_mfma_f32_16x16x32_bf16 v[164:167], a[12:15], v[68:71], v[164:167]
    v_perm_b32 v19, v17, v29, s43
    v_lshrrev_b64 v[20:21], 4, v[18:19]
    v_mfma_f32_16x16x32_bf16 v[168:171], a[16:19], v[56:59], v[168:171]
    ds_read_b128 a[52:55], v9 offset:4096
    v_and_or_b32 v18, v18, s44, v1
    v_mfma_f32_16x16x32_bf16 v[168:171], a[20:23], v[64:67], v[168:171]
    v_and_or_b32 v19, v19, s44, v1
    v_and_or_b32 v20, v20, s44, v1
    v_mfma_f32_16x16x32_bf16 v[172:175], a[16:19], v[60:63], v[172:175]
    ds_read_b128 a[56:59], v8 offset:6144
    v_and_or_b32 v21, v21, s44, v1
    v_mfma_f32_16x16x32_bf16 v[172:175], a[20:23], v[68:71], v[172:175]
    v_perm_b32 v100, v54, v55, v18
    v_perm_b32 v101, v54, v55, v20
    v_mfma_f32_16x16x32_bf16 v[176:179], a[24:27], v[56:59], v[176:179]
    ds_read_b128 a[60:63], v9 offset:6144
    v_perm_b32 v102, v54, v55, v19
    v_mfma_f32_16x16x32_bf16 v[176:179], a[28:31], v[64:67], v[176:179]
    s_waitcnt vmcnt(7) lgkmcnt(2)
    v_perm_b32 v103, v54, v55, v21
    v_lshrrev_b64 v[16:17], 2, v[22:23]
    v_mfma_f32_16x16x32_bf16 v[180:183], a[24:27], v[60:63], v[180:183]
    ds_read_b128 a[64:67], v8 offset:8192
    v_perm_b32 v18, v16, v22, s40
    v_mfma_f32_16x16x32_bf16 v[180:183], a[28:31], v[68:71], v[180:183]
    ds_write_b128 v14, v[40:43] offset:0
    v_mfma_f32_16x16x32_bf16 v[184:187], a[32:35], v[56:59], v[184:187]
    s_add_u32 s56, s56, s62
    ds_read_b128 a[68:71], v9 offset:8192
    v_perm_b32 v19, v16, v22, s41
    v_mfma_f32_16x16x32_bf16 v[184:187], a[36:39], v[64:67], v[184:187]
    ds_write_b128 v14, v[44:47] offset:1024
    v_mfma_f32_16x16x32_bf16 v[188:191], a[32:35], v[60:63], v[188:191]
    s_addk_i32 m0, 4096
    ds_read_b128 a[72:75], v8 offset:10240
    v_lshrrev_b64 v[20:21], 4, v[18:19]
    v_mfma_f32_16x16x32_bf16 v[188:191], a[36:39], v[68:71], v[188:191]
    buffer_load_dwordx4 v5, s[8:11], s56 offen lds
    v_mfma_f32_16x16x32_bf16 v[192:195], a[40:43], v[56:59], v[192:195]
    ds_read_b128 a[76:79], v9 offset:10240
    v_and_or_b32 v18, v18, s44, v1
    v_mfma_f32_16x16x32_bf16 v[192:195], a[44:47], v[64:67], v[192:195]
    s_add_u32 s56, s56, s62
    v_and_or_b32 v19, v19, s44, v1
    v_and_or_b32 v20, v20, s44, v1
    v_mfma_f32_16x16x32_bf16 v[196:199], a[40:43], v[60:63], v[196:199]
    s_addk_i32 m0, 4096
    ds_read_b128 a[80:83], v8 offset:12288
    v_and_or_b32 v21, v21, s44, v1
    v_mfma_f32_16x16x32_bf16 v[196:199], a[44:47], v[68:71], v[196:199]
    buffer_load_dwordx4 v5, s[8:11], s56 offen lds
    v_mfma_f32_16x16x32_bf16 v[200:203], a[48:51], v[56:59], v[200:203]
    ds_read_b128 a[84:87], v9 offset:12288
    v_mfma_f32_16x16x32_bf16 v[200:203], a[52:55], v[64:67], v[200:203]
    s_waitcnt lgkmcnt(2)
    ds_read_b128 v[48:51], v2 offset:0
    v_mfma_f32_16x16x32_bf16 v[204:207], a[48:51], v[60:63], v[204:207]
    ds_read_b128 a[88:91], v8 offset:14336
    v_mfma_f32_16x16x32_bf16 v[204:207], a[52:55], v[68:71], v[204:207]
    s_add_u32 s56, s56, s62
    v_mfma_f32_16x16x32_bf16 v[208:211], a[56:59], v[56:59], v[208:211]
    s_addk_i32 m0, 4096
    ds_read_b128 a[92:95], v9 offset:14336
    v_mfma_f32_16x16x32_bf16 v[208:211], a[60:63], v[64:67], v[208:211]
    buffer_load_dwordx4 v5, s[8:11], s56 offen lds
    v_mfma_f32_16x16x32_bf16 v[212:215], a[56:59], v[60:63], v[212:215]
L_hopB3:
    s_cbranch_execz L_hopret
    ds_read_b128 a[0:3], v8 offset:16384
    v_mfma_f32_16x16x32_bf16 v[212:215], a[60:63], v[68:71], v[212:215]
    s_waitcnt lgkmcnt(2)
    v_perm_b32 v104, v48, v49, v18
    v_perm_b32 v105, v48, v49, v20
    v_mfma_f32_16x16x32_bf16 v[216:219], a[64:67], v[56:59], v[216:219]
    ds_read_b128 a[4:7], v9 offset:16384
    v_perm_b32 v106, v48, v49, v19
    v_mfma_f32_16x16x32_bf16 v[216:219], a[68:71], v[64:67], v[216:219]
    s_movk_i32 s56, 1024
    v_perm_b32 v107, v48, v49, v21
    v_perm_b32 v18, v16, v22, s42
    v_mfma_f32_16x16x32_bf16 v[220:223], a[64:67], v[60:63], v[220:223]
    s_addk_i32 m0, 4096
    ds_read_b128 a[8:11], v8 offset:18432
    v_perm_b32 v19, v16, v22, s43
    v_mfma_f32_16x16x32_bf16 v[220:223], a[68:71], v[68:71], v[220:223]
    buffer_load_dwordx4 v5, s[8:11], s56 offen lds
    v_mfma_f32_16x16x32_bf16 v[224:227], a[72:75], v[56:59], v[224:227]
    ds_read_b128 a[12:15], v9 offset:18432
    v_lshrrev_b64 v[20:21], 4, v[18:19]
    v_mfma_f32_16x16x32_bf16 v[224:227], a[76:79], v[64:67], v[224:227]
    v_and_or_b32 v18, v18, s44, v1
    v_and_or_b32 v19, v19, s44, v1
    v_mfma_f32_16x16x32_bf16 v[228:231], a[72:75], v[60:63], v[228:231]
    ds_read_b128 a[16:19], v8 offset:20480
    v_and_or_b32 v20, v20, s44, v1
    v_mfma_f32_16x16x32_bf16 v[228:231], a[76:79], v[68:71], v[228:231]
    s_add_u32 s56, s56, s62
    v_and_or_b32 v21, v21, s44, v1
    v_perm_b32 v112, v48, v49, v18
    v_mfma_f32_16x16x32_bf16 v[232:235], a[80:83], v[56:59], v[232:235]
    s_addk_i32 m0, 4096
    ds_read_b128 a[20:23], v9 offset:20480
    v_perm_b32 v113, v48, v49, v20
    v_mfma_f32_16x16x32_bf16 v[232:235], a[84:87], v[64:67], v[232:235]
    buffer_load_dwordx4 v5, s[8:11], s56 offen lds
    v_mfma_f32_16x16x32_bf16 v[236:239], a[80:83], v[60:63], v[236:239]
    ds_read_b128 a[24:27], v8 offset:22528
    v_perm_b32 v114, v48, v49, v19
    v_mfma_f32_16x16x32_bf16 v[236:239], a[84:87], v[68:71], v[236:239]
    v_perm_b32 v115, v48, v49, v21
    v_perm_b32 v18, v17, v23, s40
    v_mfma_f32_16x16x32_bf16 v[240:243], a[88:91], v[56:59], v[240:243]
    s_waitcnt lgkmcnt(2)
    ds_read_b128 a[28:31], v9 offset:22528
    v_perm_b32 v19, v17, v23, s41
    v_mfma_f32_16x16x32_bf16 v[240:243], a[92:95], v[64:67], v[240:243]
    s_add_u32 s56, s56, s62
    v_lshrrev_b64 v[20:21], 4, v[18:19]
    v_and_or_b32 v18, v18, s44, v1
    v_mfma_f32_16x16x32_bf16 v[244:247], a[88:91], v[60:63], v[244:247]
    s_addk_i32 m0, 4096
    ds_read_b128 a[32:35], v8 offset:24576
    v_and_or_b32 v19, v19, s44, v1
    v_mfma_f32_16x16x32_bf16 v[244:247], a[92:95], v[68:71], v[244:247]
    buffer_load_dwordx4 v5, s[8:11], s56 offen lds
    v_mfma_f32_16x16x32_bf16 v[136:139], a[0:3], v[72:75], v[136:139]
    s_add_u32 s57, s57, s61
    ds_read_b128 a[36:39], v9 offset:24576
    v_and_or_b32 v20, v20, s44, v1
    v_mfma_f32_16x16x32_bf16 v[136:139], a[4:7], v[80:83], v[136:139]
    buffer_load_dwordx2 v[26:27], v3, s[12:15], s57 offen
    v_mfma_f32_16x16x32_bf16 v[140:143], a[0:3], v[76:79], v[140:143]
    ds_read_b128 a[40:43], v8 offset:26624
    v_and_or_b32 v21, v21, s44, v1
    v_mfma_f32_16x16x32_bf16 v[140:143], a[4:7], v[84:87], v[140:143]
    s_add_u32 s56, s56, s62
    v_perm_b32 v108, v50, v51, v18
    v_perm_b32 v109, v50, v51, v20
    v_mfma_f32_16x16x32_bf16 v[144:147], a[8:11], v[72:75], v[144:147]
    s_addk_i32 m0, 4096
    ds_read_b128 a[44:47], v9 offset:26624
    v_perm_b32 v110, v50, v51, v19
    v_mfma_f32_16x16x32_bf16 v[144:147], a[12:15], v[80:83], v[144:147]
    buffer_load_dwordx4 v5, s[8:11], s56 offen lds
    v_mfma_f32_16x16x32_bf16 v[148:151], a[8:11], v[76:79], v[148:151]
    ds_read_b128 a[48:51], v8 offset:28672
    v_perm_b32 v111, v50, v51, v21
    v_mfma_f32_16x16x32_bf16 v[148:151], a[12:15], v[84:87], v[148:151]
    v_perm_b32 v18, v17, v23, s42
    v_perm_b32 v19, v17, v23, s43
    v_mfma_f32_16x16x32_bf16 v[152:155], a[16:19], v[72:75], v[152:155]
    s_waitcnt lgkmcnt(2)
    ds_read_b128 a[52:55], v9 offset:28672
    v_lshrrev_b64 v[20:21], 4, v[18:19]
    v_mfma_f32_16x16x32_bf16 v[152:155], a[20:23], v[80:83], v[152:155]
    s_add_u32 s56, s56, s62
    v_and_or_b32 v18, v18, s44, v1
    v_and_or_b32 v19, v19, s44, v1
    v_mfma_f32_16x16x32_bf16 v[156:159], a[16:19], v[76:79], v[156:159]
    s_addk_i32 m0, 4096
    ds_read_b128 a[56:59], v8 offset:30720
    v_and_or_b32 v20, v20, s44, v1
    v_mfma_f32_16x16x32_bf16 v[156:159], a[20:23], v[84:87], v[156:159]
    buffer_load_dwordx4 v5, s[8:11], s56 offen lds
    v_mfma_f32_16x16x32_bf16 v[160:163], a[24:27], v[72:75], v[160:163]
    s_waitcnt vmcnt(10) lgkmcnt(2)
    ds_read_b128 a[60:63], v9 offset:30720
    v_and_or_b32 v21, v21, s44, v1
    v_mfma_f32_16x16x32_bf16 v[160:163], a[28:31], v[80:83], v[160:163]
    s_barrier
    v_mfma_f32_16x16x32_bf16 v[164:167], a[24:27], v[76:79], v[164:167]
    ds_read_b128 a[64:67], v8 offset:32768
    v_perm_b32 v116, v50, v51, v18
    v_mfma_f32_16x16x32_bf16 v[164:167], a[28:31], v[84:87], v[164:167]
    s_add_u32 s56, s56, s62
    ds_read_b128 v[52:55], v2 offset:256
    v_perm_b32 v117, v50, v51, v20
    v_mfma_f32_16x16x32_bf16 v[168:171], a[32:35], v[72:75], v[168:171]
    s_addk_i32 m0, 4096
    ds_read_b128 a[68:71], v9 offset:32768
    v_perm_b32 v118, v50, v51, v19
    v_mfma_f32_16x16x32_bf16 v[168:171], a[36:39], v[80:83], v[168:171]
    buffer_load_dwordx4 v5, s[8:11], s56 offen lds
    v_mfma_f32_16x16x32_bf16 v[172:175], a[32:35], v[76:79], v[172:175]
    ds_read_b128 a[72:75], v8 offset:34816
    v_perm_b32 v119, v50, v51, v21
    v_mfma_f32_16x16x32_bf16 v[172:175], a[36:39], v[84:87], v[172:175]
    v_lshrrev_b64 v[16:17], 2, v[24:25]
    v_perm_b32 v18, v16, v24, s40
    v_mfma_f32_16x16x32_bf16 v[176:179], a[40:43], v[72:75], v[176:179]
    ds_read_b128 a[76:79], v9 offset:34816
    v_perm_b32 v19, v16, v24, s41
    v_mfma_f32_16x16x32_bf16 v[176:179], a[44:47], v[80:83], v[176:179]
    s_add_u32 s56, s56, s62
    v_lshrrev_b64 v[20:21], 4, v[18:19]
    v_and_or_b32 v18, v18, s44, v1
    v_mfma_f32_16x16x32_bf16 v[180:183], a[40:43], v[76:79], v[180:183]
    s_addk_i32 m0, 4096
    ds_read_b128 a[80:83], v8 offset:36864
    v_and_or_b32 v19, v19, s44, v1
    v_mfma_f32_16x16x32_bf16 v[180:183], a[44:47], v[84:87], v[180:183]
    buffer_load_dwordx4 v5, s[8:11], s56 offen lds
    v_mfma_f32_16x16x32_bf16 v[184:187], a[48:51], v[72:75], v[184:187]
    s_waitcnt lgkmcnt(2)
    ds_read_b128 a[84:87], v9 offset:36864
    v_and_or_b32 v20, v20, s44, v1
    v_mfma_f32_16x16x32_bf16 v[184:187], a[52:55], v[80:83], v[184:187]
    v_and_or_b32 v21, v21, s44, v1
    v_perm_b32 v120, v52, v53, v18
    v_mfma_f32_16x16x32_bf16 v[188:191], a[48:51], v[76:79], v[188:191]
    ds_read_b128 a[88:91], v8 offset:38912
    v_perm_b32 v121, v52, v53, v20
    v_mfma_f32_16x16x32_bf16 v[188:191], a[52:55], v[84:87], v[188:191]
    s_movk_i32 s56, 1152
    v_perm_b32 v122, v52, v53, v19
    v_perm_b32 v123, v52, v53, v21
    v_mfma_f32_16x16x32_bf16 v[192:195], a[56:59], v[72:75], v[192:195]
    s_addk_i32 m0, 4096
    ds_read_b128 a[92:95], v9 offset:38912
    v_perm_b32 v18, v16, v24, s42
    v_mfma_f32_16x16x32_bf16 v[192:195], a[60:63], v[80:83], v[192:195]
    buffer_load_dwordx4 v5, s[8:11], s56 offen lds
    v_mfma_f32_16x16x32_bf16 v[196:199], a[56:59], v[76:79], v[196:199]
    ds_read_b128 a[0:3], v8 offset:40960
    v_perm_b32 v19, v16, v24, s43
    v_mfma_f32_16x16x32_bf16 v[196:199], a[60:63], v[84:87], v[196:199]
    v_lshrrev_b64 v[20:21], 4, v[18:19]
    v_and_or_b32 v18, v18, s44, v1
    v_mfma_f32_16x16x32_bf16 v[200:203], a[64:67], v[72:75], v[200:203]
    ds_read_b128 a[4:7], v9 offset:40960
    v_and_or_b32 v19, v19, s44, v1
    v_mfma_f32_16x16x32_bf16 v[200:203], a[68:71], v[80:83], v[200:203]
    s_add_u32 s56, s56, s62
    v_and_or_b32 v20, v20, s44, v1
    v_and_or_b32 v21, v21, s44, v1
    v_mfma_f32_16x16x32_bf16 v[204:207], a[64:67], v[76:79], v[204:207]
    s_addk_i32 m0, 4096
    ds_read_b128 a[8:11], v8 offset:43008
    v_perm_b32 v128, v52, v53, v18
    v_mfma_f32_16x16x32_bf16 v[204:207], a[68:71], v[84:87], v[204:207]
    buffer_load_dwordx4 v5, s[8:11], s56 offen lds
    v_mfma_f32_16x16x32_bf16 v[208:211], a[72:75], v[72:75], v[208:211]
    s_waitcnt lgkmcnt(2)
    ds_read_b128 a[12:15], v9 offset:43008
    v_perm_b32 v129, v52, v53, v20
    v_mfma_f32_16x16x32_bf16 v[208:211], a[76:79], v[80:83], v[208:211]
    v_perm_b32 v130, v52, v53, v19
    v_perm_b32 v131, v52, v53, v21
    v_mfma_f32_16x16x32_bf16 v[212:215], a[72:75], v[76:79], v[212:215]
    ds_read_b128 a[16:19], v8 offset:45056
    v_perm_b32 v18, v17, v25, s40
    v_mfma_f32_16x16x32_bf16 v[212:215], a[76:79], v[84:87], v[212:215]
    s_add_u32 s56, s56, s62
    v_perm_b32 v19, v17, v25, s41
    v_lshrrev_b64 v[20:21], 4, v[18:19]
    v_mfma_f32_16x16x32_bf16 v[216:219], a[80:83], v[72:75], v[216:219]
    s_addk_i32 m0, 4096
    ds_read_b128 a[20:23], v9 offset:45056
    v_and_or_b32 v18, v18, s44, v1
    v_mfma_f32_16x16x32_bf16 v[216:219], a[84:87], v[80:83], v[216:219]
    buffer_load_dwordx4 v5, s[8:11], s56 offen lds
    v_mfma_f32_16x16x32_bf16 v[220:223], a[80:83], v[76:79], v[220:223]
    s_add_u32 s57, s57, s61
    ds_read_b128 a[24:27], v8 offset:47104
    v_and_or_b32 v19, v19, s44, v1
    v_mfma_f32_16x16x32_bf16 v[220:223], a[84:87], v[84:87], v[220:223]
    buffer_load_dwordx2 v[28:29], v3, s[12:15], s57 offen
    v_mfma_f32_16x16x32_bf16 v[224:227], a[88:91], v[72:75], v[224:227]
    ds_read_b128 a[28:31], v9 offset:47104
    v_and_or_b32 v20, v20, s44, v1
    v_mfma_f32_16x16x32_bf16 v[224:227], a[92:95], v[80:83], v[224:227]
    s_add_u32 s56, s56, s62
    v_and_or_b32 v21, v21, s44, v1
    v_perm_b32 v124, v54, v55, v18
    v_mfma_f32_16x16x32_bf16 v[228:231], a[88:91], v[76:79], v[228:231]
    s_addk_i32 m0, 4096
    ds_read_b128 a[32:35], v8 offset:49152
    v_perm_b32 v125, v54, v55, v20
    v_mfma_f32_16x16x32_bf16 v[228:231], a[92:95], v[84:87], v[228:231]
    buffer_load_dwordx4 v5, s[8:11], s56 offen lds
    v_mfma_f32_16x16x32_bf16 v[232:235], a[0:3], v[72:75], v[232:235]
    s_waitcnt lgkmcnt(2)
    ds_read_b128 a[36:39], v9 offset:49152
    v_perm_b32 v126, v54, v55, v19
    v_mfma_f32_16x16x32_bf16 v[232:235], a[4:7], v[80:83], v[232:235]
    v_perm_b32 v127, v54, v55, v21
    v_perm_b32 v18, v17, v25, s42
    v_mfma_f32_16x16x32_bf16 v[236:239], a[0:3], v[76:79], v[236:239]
    ds_read_b128 a[40:43], v8 offset:51200
    v_perm_b32 v19, v17, v25, s43
    v_mfma_f32_16x16x32_bf16 v[236:239], a[4:7], v[84:87], v[236:239]
    s_add_u32 s56, s56, s62
    v_lshrrev_b64 v[20:21], 4, v[18:19]
    v_and_or_b32 v18, v18, s44, v1
    v_mfma_f32_16x16x32_bf16 v[240:243], a[8:11], v[72:75], v[240:243]
    s_addk_i32 m0, 4096
    ds_read_b128 a[44:47], v9 offset:51200
    v_and_or_b32 v19, v19, s44, v1
    v_mfma_f32_16x16x32_bf16 v[240:243], a[12:15], v[80:83], v[240:243]
    buffer_load_dwordx4 v5, s[8:11], s56 offen lds
    v_mfma_f32_16x16x32_bf16 v[244:247], a[8:11], v[76:79], v[244:247]
    ds_read_b128 a[48:51], v8 offset:53248
    v_and_or_b32 v20, v20, s44, v1
    v_mfma_f32_16x16x32_bf16 v[244:247], a[12:15], v[84:87], v[244:247]
    v_and_or_b32 v21, v21, s44, v1
    v_perm_b32 v132, v54, v55, v18
    v_mfma_f32_16x16x32_bf16 v[136:139], a[16:19], v[88:91], v[136:139]
    ds_read_b128 a[52:55], v9 offset:53248
    v_perm_b32 v133, v54, v55, v20
    v_mfma_f32_16x16x32_bf16 v[136:139], a[20:23], v[96:99], v[136:139]
    s_add_u32 s56, s56, s62
    ds_read_b128 v[48:51], v2 offset:512
    v_perm_b32 v134, v54, v55, v19
    v_mfma_f32_16x16x32_bf16 v[140:143], a[16:19], v[92:95], v[140:143]
    s_addk_i32 m0, 4096
    ds_read_b128 a[56:59], v8 offset:55296
    v_perm_b32 v135, v54, v55, v21
    v_mfma_f32_16x16x32_bf16 v[140:143], a[20:23], v[100:103], v[140:143]
    buffer_load_dwordx4 v5, s[8:11], s56 offen lds
    v_mfma_f32_16x16x32_bf16 v[144:147], a[24:27], v[88:91], v[144:147]
    s_waitcnt vmcnt(11) lgkmcnt(3)
    ds_read_b128 a[60:63], v9 offset:55296
    v_lshrrev_b64 v[16:17], 2, v[26:27]
    v_mfma_f32_16x16x32_bf16 v[144:147], a[28:31], v[96:99], v[144:147]
    v_perm_b32 v18, v16, v26, s40
    v_perm_b32 v19, v16, v26, s41
    v_mfma_f32_16x16x32_bf16 v[148:151], a[24:27], v[92:95], v[148:151]
    ds_read_b128 a[64:67], v8 offset:57344
    v_lshrrev_b64 v[20:21], 4, v[18:19]
    v_mfma_f32_16x16x32_bf16 v[148:151], a[28:31], v[100:103], v[148:151]
    s_add_u32 s56, s56, s62
    v_and_or_b32 v18, v18, s44, v1
    v_and_or_b32 v19, v19, s44, v1
    v_mfma_f32_16x16x32_bf16 v[152:155], a[32:35], v[88:91], v[152:155]
    s_addk_i32 m0, 4096
    ds_read_b128 a[68:71], v9 offset:57344
    v_and_or_b32 v20, v20, s44, v1
    v_mfma_f32_16x16x32_bf16 v[152:155], a[36:39], v[96:99], v[152:155]
    buffer_load_dwordx4 v5, s[8:11], s56 offen lds
    v_mfma_f32_16x16x32_bf16 v[156:159], a[32:35], v[92:95], v[156:159]
    s_waitcnt lgkmcnt(2)
    ds_read_b128 a[72:75], v8 offset:59392
    v_and_or_b32 v21, v21, s44, v1
    v_mfma_f32_16x16x32_bf16 v[156:159], a[36:39], v[100:103], v[156:159]
    s_movk_i32 s56, 1280
    v_perm_b32 v56, v48, v49, v18
    v_perm_b32 v57, v48, v49, v20
    v_mfma_f32_16x16x32_bf16 v[160:163], a[40:43], v[88:91], v[160:163]
    s_waitcnt vmcnt(8) lgkmcnt(2)
    ds_read_b128 a[76:79], v9 offset:59392
    v_perm_b32 v58, v48, v49, v19
    v_mfma_f32_16x16x32_bf16 v[160:163], a[44:47], v[96:99], v[160:163]
    s_barrier
    v_mfma_f32_16x16x32_bf16 v[164:167], a[40:43], v[92:95], v[164:167]
    s_addk_i32 m0, 4096
    ds_read_b128 a[80:83], v8 offset:61440
    v_perm_b32 v59, v48, v49, v21
    v_mfma_f32_16x16x32_bf16 v[164:167], a[44:47], v[100:103], v[164:167]
    buffer_load_dwordx4 v5, s[8:11], s56 offen lds
    v_mfma_f32_16x16x32_bf16 v[168:171], a[48:51], v[88:91], v[168:171]
    ds_read_b128 a[84:87], v9 offset:61440
    v_perm_b32 v18, v16, v26, s42
    v_mfma_f32_16x16x32_bf16 v[168:171], a[52:55], v[96:99], v[168:171]
    v_perm_b32 v19, v16, v26, s43
    v_lshrrev_b64 v[20:21], 4, v[18:19]
    v_mfma_f32_16x16x32_bf16 v[172:175], a[48:51], v[92:95], v[172:175]
    ds_read_b128 a[88:91], v8 offset:63488
    v_and_or_b32 v18, v18, s44, v1
    v_mfma_f32_16x16x32_bf16 v[172:175], a[52:55], v[100:103], v[172:175]
    s_add_u32 s56, s56, s62
    v_and_or_b32 v19, v19, s44, v1
    v_and_or_b32 v20, v20, s44, v1
    v_mfma_f32_16x16x32_bf16 v[176:179], a[56:59], v[88:91], v[176:179]
    s_addk_i32 m0, 4096
    ds_read_b128 a[92:95], v9 offset:63488
    v_and_or_b32 v21, v21, s44, v1
    v_mfma_f32_16x16x32_bf16 v[176:179], a[60:63], v[96:99], v[176:179]
    buffer_load_dwordx4 v5, s[8:11], s56 offen lds
    v_mfma_f32_16x16x32_bf16 v[180:183], a[56:59], v[92:95], v[180:183]
    ds_read_b128 a[0:3], v10 offset:0
    v_perm_b32 v64, v48, v49, v18
    v_mfma_f32_16x16x32_bf16 v[180:183], a[60:63], v[100:103], v[180:183]
    v_perm_b32 v65, v48, v49, v20
    v_perm_b32 v66, v48, v49, v19
    v_mfma_f32_16x16x32_bf16 v[184:187], a[64:67], v[88:91], v[184:187]
    s_waitcnt lgkmcnt(2)
    ds_read_b128 a[4:7], v11 offset:0
    v_perm_b32 v67, v48, v49, v21
    v_mfma_f32_16x16x32_bf16 v[184:187], a[68:71], v[96:99], v[184:187]
    s_add_u32 s56, s56, s62
    v_perm_b32 v18, v17, v27, s40
    v_perm_b32 v19, v17, v27, s41
    v_mfma_f32_16x16x32_bf16 v[188:191], a[64:67], v[92:95], v[188:191]
    s_addk_i32 m0, 4096
    ds_read_b128 a[8:11], v10 offset:2048
    v_lshrrev_b64 v[20:21], 4, v[18:19]
    v_mfma_f32_16x16x32_bf16 v[188:191], a[68:71], v[100:103], v[188:191]
    buffer_load_dwordx4 v5, s[8:11], s56 offen lds
    v_mfma_f32_16x16x32_bf16 v[192:195], a[72:75], v[88:91], v[192:195]
    s_add_u32 s57, s57, s61
    ds_read_b128 a[12:15], v11 offset:2048
    v_and_or_b32 v18, v18, s44, v1
    v_mfma_f32_16x16x32_bf16 v[192:195], a[76:79], v[96:99], v[192:195]
    buffer_load_dwordx2 v[22:23], v3, s[12:15], s57 offen
    v_mfma_f32_16x16x32_bf16 v[196:199], a[72:75], v[92:95], v[196:199]
    ds_read_b128 a[16:19], v10 offset:4096
    v_and_or_b32 v19, v19, s44, v1
    v_mfma_f32_16x16x32_bf16 v[196:199], a[76:79], v[100:103], v[196:199]
    s_add_u32 s56, s56, s62
    v_and_or_b32 v20, v20, s44, v1
    v_and_or_b32 v21, v21, s44, v1
    v_mfma_f32_16x16x32_bf16 v[200:203], a[80:83], v[88:91], v[200:203]
    s_addk_i32 m0, 4096
    ds_read_b128 a[20:23], v11 offset:4096
    v_perm_b32 v60, v50, v51, v18
    v_mfma_f32_16x16x32_bf16 v[200:203], a[84:87], v[96:99], v[200:203]
    buffer_load_dwordx4 v5, s[8:11], s56 offen lds
    v_mfma_f32_16x16x32_bf16 v[204:207], a[80:83], v[92:95], v[204:207]
    ds_read_b128 a[24:27], v10 offset:6144
    v_perm_b32 v61, v50, v51, v20
    v_mfma_f32_16x16x32_bf16 v[204:207], a[84:87], v[100:103], v[204:207]
    v_perm_b32 v62, v50, v51, v19
    v_perm_b32 v63, v50, v51, v21
    v_mfma_f32_16x16x32_bf16 v[208:211], a[88:91], v[88:91], v[208:211]
    s_waitcnt lgkmcnt(2)
    ds_read_b128 a[28:31], v11 offset:6144
    v_perm_b32 v18, v17, v27, s42
    v_mfma_f32_16x16x32_bf16 v[208:211], a[92:95], v[96:99], v[208:211]
    s_add_u32 s56, s56, s62
    v_perm_b32 v19, v17, v27, s43
    v_lshrrev_b64 v[20:21], 4, v[18:19]
    v_mfma_f32_16x16x32_bf16 v[212:215], a[88:91], v[92:95], v[212:215]
    s_addk_i32 m0, 4096
    ds_read_b128 a[32:35], v10 offset:8192
    v_and_or_b32 v18, v18, s44, v1
    v_mfma_f32_16x16x32_bf16 v[212:215], a[92:95], v[100:103], v[212:215]
    buffer_load_dwordx4 v5, s[8:11], s56 offen lds
    v_mfma_f32_16x16x32_bf16 v[216:219], a[0:3], v[88:91], v[216:219]
    ds_read_b128 a[36:39], v11 offset:8192
    v_and_or_b32 v19, v19, s44, v1
    v_mfma_f32_16x16x32_bf16 v[216:219], a[4:7], v[96:99], v[216:219]
    v_and_or_b32 v20, v20, s44, v1
    v_and_or_b32 v21, v21, s44, v1
    v_mfma_f32_16x16x32_bf16 v[220:223], a[0:3], v[92:95], v[220:223]
    ds_read_b128 a[40:43], v10 offset:10240
    v_perm_b32 v68, v50, v51, v18
    v_mfma_f32_16x16x32_bf16 v[220:223], a[4:7], v[100:103], v[220:223]
    s_add_u32 s56, s56, s62
    ds_read_b128 v[52:55], v2 offset:768
    v_perm_b32 v69, v50, v51, v20
    v_mfma_f32_16x16x32_bf16 v[224:227], a[8:11], v[88:91], v[224:227]
    s_addk_i32 m0, 4096
    ds_read_b128 a[44:47], v11 offset:10240
    v_perm_b32 v70, v50, v51, v19
    v_mfma_f32_16x16x32_bf16 v[224:227], a[12:15], v[96:99], v[224:227]
    buffer_load_dwordx4 v5, s[8:11], s56 offen lds
    v_mfma_f32_16x16x32_bf16 v[228:231], a[8:11], v[92:95], v[228:231]
    ds_read_b128 a[48:51], v10 offset:12288
    v_perm_b32 v71, v50, v51, v21
    v_mfma_f32_16x16x32_bf16 v[228:231], a[12:15], v[100:103], v[228:231]
    s_waitcnt vmcnt(11) lgkmcnt(3)
    v_lshrrev_b64 v[16:17], 2, v[28:29]
    v_perm_b32 v18, v16, v28, s40
    v_mfma_f32_16x16x32_bf16 v[232:235], a[16:19], v[88:91], v[232:235]
    ds_read_b128 a[52:55], v11 offset:12288
    v_perm_b32 v19, v16, v28, s41
    v_mfma_f32_16x16x32_bf16 v[232:235], a[20:23], v[96:99], v[232:235]
    s_add_u32 s56, s56, s62
    v_lshrrev_b64 v[20:21], 4, v[18:19]
    v_and_or_b32 v18, v18, s44, v1
    v_mfma_f32_16x16x32_bf16 v[236:239], a[16:19], v[92:95], v[236:239]
    s_add_u32 m0, s47, 0
    ds_read_b128 a[56:59], v10 offset:14336
    v_and_or_b32 v19, v19, s44, v1
    v_mfma_f32_16x16x32_bf16 v[236:239], a[20:23], v[100:103], v[236:239]
    buffer_load_dwordx4 v5, s[8:11], s56 offen lds
    v_mfma_f32_16x16x32_bf16 v[240:243], a[24:27], v[88:91], v[240:243]
    ds_read_b128 a[60:63], v11 offset:14336
    v_and_or_b32 v20, v20, s44, v1
    v_mfma_f32_16x16x32_bf16 v[240:243], a[28:31], v[96:99], v[240:243]
    s_waitcnt lgkmcnt(2)
    v_and_or_b32 v21, v21, s44, v1
    v_perm_b32 v72, v52, v53, v18
    v_mfma_f32_16x16x32_bf16 v[244:247], a[24:27], v[92:95], v[244:247]
    ds_read_b128 a[64:67], v10 offset:16384
    v_perm_b32 v73, v52, v53, v20
    v_mfma_f32_16x16x32_bf16 v[244:247], a[28:31], v[100:103], v[244:247]
    s_movk_i32 s56, 1408
    v_perm_b32 v74, v52, v53, v19
    v_perm_b32 v75, v52, v53, v21
    v_mfma_f32_16x16x32_bf16 v[136:139], a[32:35], v[104:107], v[136:139]
    s_addk_i32 m0, 4096
    ds_read_b128 a[68:71], v11 offset:16384
    v_perm_b32 v18, v16, v28, s42
    v_mfma_f32_16x16x32_bf16 v[136:139], a[36:39], v[112:115], v[136:139]
    buffer_load_dwordx4 v5, s[8:11], s56 offen lds
    v_mfma_f32_16x16x32_bf16 v[140:143], a[32:35], v[108:111], v[140:143]
    ds_read_b128 a[72:75], v10 offset:18432
    v_perm_b32 v19, v16, v28, s43
    v_mfma_f32_16x16x32_bf16 v[140:143], a[36:39], v[116:119], v[140:143]
    v_lshrrev_b64 v[20:21], 4, v[18:19]
    v_and_or_b32 v18, v18, s44, v1
    v_mfma_f32_16x16x32_bf16 v[144:147], a[40:43], v[104:107], v[144:147]
    ds_read_b128 a[76:79], v11 offset:18432
    v_and_or_b32 v19, v19, s44, v1
    v_mfma_f32_16x16x32_bf16 v[144:147], a[44:47], v[112:115], v[144:147]
    s_addk_i32 s56, 128
    v_and_or_b32 v20, v20, s44, v1
    v_and_or_b32 v21, v21, s44, v1
    v_mfma_f32_16x16x32_bf16 v[148:151], a[40:43], v[108:111], v[148:151]
    s_addk_i32 m0, 4096
    ds_read_b128 a[80:83], v10 offset:20480
    v_perm_b32 v80, v52, v53, v18
    v_mfma_f32_16x16x32_bf16 v[148:151], a[44:47], v[116:119], v[148:151]
    buffer_load_dwordx4 v5, s[8:11], s56 offen lds
    v_mfma_f32_16x16x32_bf16 v[152:155], a[48:51], v[104:107], v[152:155]
    ds_read_b128 a[84:87], v11 offset:20480
    v_perm_b32 v81, v52, v53, v20
    v_mfma_f32_16x16x32_bf16 v[152:155], a[52:55], v[112:115], v[152:155]
    v_perm_b32 v82, v52, v53, v19
    v_perm_b32 v83, v52, v53, v21
    v_mfma_f32_16x16x32_bf16 v[156:159], a[48:51], v[108:111], v[156:159]
    s_waitcnt lgkmcnt(2)
    ds_read_b128 a[88:91], v10 offset:22528
    v_perm_b32 v18, v17, v29, s40
    v_mfma_f32_16x16x32_bf16 v[156:159], a[52:55], v[116:119], v[156:159]
    s_addk_i32 s56, 128
    v_perm_b32 v19, v17, v29, s41
    v_lshrrev_b64 v[20:21], 4, v[18:19]
    v_mfma_f32_16x16x32_bf16 v[160:163], a[56:59], v[104:107], v[160:163]
    s_addk_i32 m0, 4096
    ds_read_b128 a[92:95], v11 offset:22528
    v_and_or_b32 v18, v18, s44, v1
    v_mfma_f32_16x16x32_bf16 v[160:163], a[60:63], v[112:115], v[160:163]
    buffer_load_dwordx4 v5, s[8:11], s56 offen lds
    v_mfma_f32_16x16x32_bf16 v[164:167], a[56:59], v[108:111], v[164:167]
    ds_read_b128 a[0:3], v10 offset:24576
    v_and_or_b32 v19, v19, s44, v1
    v_mfma_f32_16x16x32_bf16 v[164:167], a[60:63], v[116:119], v[164:167]
    s_addk_i32 s56, 128
    v_and_or_b32 v20, v20, s44, v1
    v_and_or_b32 v21, v21, s44, v1
    v_mfma_f32_16x16x32_bf16 v[168:171], a[64:67], v[104:107], v[168:171]
    s_add_u32 s57, s57, s61
    ds_read_b128 a[4:7], v11 offset:24576
    v_perm_b32 v76, v54, v55, v18
    v_mfma_f32_16x16x32_bf16 v[168:171], a[68:71], v[112:115], v[168:171]
    buffer_load_dwordx2 v[24:25], v3, s[12:15], s57 offen
    v_mfma_f32_16x16x32_bf16 v[172:175], a[64:67], v[108:111], v[172:175]
    s_addk_i32 m0, 4096
    ds_read_b128 a[8:11], v10 offset:26624
    v_perm_b32 v77, v54, v55, v20
    v_mfma_f32_16x16x32_bf16 v[172:175], a[68:71], v[116:119], v[172:175]
    buffer_load_dwordx4 v5, s[8:11], s56 offen lds
    v_mfma_f32_16x16x32_bf16 v[176:179], a[72:75], v[104:107], v[176:179]
    ds_read_b128 a[12:15], v11 offset:26624
    v_perm_b32 v78, v54, v55, v19
    v_mfma_f32_16x16x32_bf16 v[176:179], a[76:79], v[112:115], v[176:179]
    v_perm_b32 v79, v54, v55, v21
    v_perm_b32 v18, v17, v29, s42
    v_mfma_f32_16x16x32_bf16 v[180:183], a[72:75], v[108:111], v[180:183]
    s_waitcnt lgkmcnt(2)
    ds_read_b128 a[16:19], v10 offset:28672
    v_perm_b32 v19, v17, v29, s43
    v_mfma_f32_16x16x32_bf16 v[180:183], a[76:79], v[116:119], v[180:183]
    s_addk_i32 s56, 128
    v_lshrrev_b64 v[20:21], 4, v[18:19]
    v_and_or_b32 v18, v18, s44, v1
    v_mfma_f32_16x16x32_bf16 v[184:187], a[80:83], v[104:107], v[184:187]
    s_addk_i32 m0, 4096
    ds_read_b128 a[20:23], v11 offset:28672
    v_and_or_b32 v19, v19, s44, v1
    v_mfma_f32_16x16x32_bf16 v[184:187], a[84:87], v[112:115], v[184:187]
    buffer_load_dwordx4 v5, s[8:11], s56 offen lds
    v_mfma_f32_16x16x32_bf16 v[188:191], a[80:83], v[108:111], v[188:191]
    ds_read_b128 a[24:27], v10 offset:30720
    v_and_or_b32 v20, v20, s44, v1
    v_mfma_f32_16x16x32_bf16 v[188:191], a[84:87], v[116:119], v[188:191]
    v_and_or_b32 v21, v21, s44, v1
    v_perm_b32 v84, v54, v55, v18
    v_mfma_f32_16x16x32_bf16 v[192:195], a[88:91], v[104:107], v[192:195]
    ds_read_b128 a[28:31], v11 offset:30720
    v_perm_b32 v85, v54, v55, v20
    v_mfma_f32_16x16x32_bf16 v[192:195], a[92:95], v[112:115], v[192:195]
    s_mov_b32 s56, 66944
    ds_read_b128 v[48:51], v2 offset:1024
    v_perm_b32 v86, v54, v55, v19
    v_mfma_f32_16x16x32_bf16 v[196:199], a[88:91], v[108:111], v[196:199]
    s_addk_i32 m0, 4096
    ds_read_b128 a[32:35], v10 offset:32768
    v_perm_b32 v87, v54, v55, v21
    v_mfma_f32_16x16x32_bf16 v[196:199], a[92:95], v[116:119], v[196:199]
    buffer_load_dwordx4 v5, s[8:11], s56 offen lds
    v_mfma_f32_16x16x32_bf16 v[200:203], a[0:3], v[104:107], v[200:203]
    s_waitcnt vmcnt(11) lgkmcnt(3)
    ds_read_b128 a[36:39], v11 offset:32768
    v_lshrrev_b64 v[16:17], 2, v[22:23]
    v_mfma_f32_16x16x32_bf16 v[200:203], a[4:7], v[112:115], v[200:203]
    v_perm_b32 v18, v16, v22, s40
    v_perm_b32 v19, v16, v22, s41
    v_mfma_f32_16x16x32_bf16 v[204:207], a[0:3], v[108:111], v[204:207]
    ds_read_b128 a[40:43], v10 offset:34816
    v_lshrrev_b64 v[20:21], 4, v[18:19]
    v_mfma_f32_16x16x32_bf16 v[204:207], a[4:7], v[116:119], v[204:207]
    s_addk_i32 s56, 128
    v_and_or_b32 v18, v18, s44, v1
    v_and_or_b32 v19, v19, s44, v1
    v_mfma_f32_16x16x32_bf16 v[208:211], a[8:11], v[104:107], v[208:211]
    s_waitcnt vmcnt(8) lgkmcnt(2)
    ds_read_b128 a[44:47], v11 offset:34816
    v_and_or_b32 v20, v20, s44, v1
    v_mfma_f32_16x16x32_bf16 v[208:211], a[12:15], v[112:115], v[208:211]
    s_barrier
    v_mfma_f32_16x16x32_bf16 v[212:215], a[8:11], v[108:111], v[212:215]
    s_addk_i32 m0, 4096
    ds_read_b128 a[48:51], v10 offset:36864
    v_and_or_b32 v21, v21, s44, v1
    v_mfma_f32_16x16x32_bf16 v[212:215], a[12:15], v[116:119], v[212:215]
    buffer_load_dwordx4 v5, s[8:11], s56 offen lds
    v_mfma_f32_16x16x32_bf16 v[216:219], a[16:19], v[104:107], v[216:219]
L_hopB4:
    s_cbranch_execz L_hopret
    ds_read_b128 a[52:55], v11 offset:36864
    v_perm_b32 v88, v48, v49, v18
    v_mfma_f32_16x16x32_bf16 v[216:219], a[20:23], v[112:115], v[216:219]
    s_addk_i32 s56, 128
    v_perm_b32 v89, v48, v49, v20
    v_perm_b32 v90, v48, v49, v19
    v_mfma_f32_16x16x32_bf16 v[220:223], a[16:19], v[108:111], v[220:223]
    s_addk_i32 m0, 4096
    ds_read_b128 a[56:59], v10 offset:38912
    v_perm_b32 v91, v48, v49, v21
    v_mfma_f32_16x16x32_bf16 v[220:223], a[20:23], v[116:119], v[220:223]
    buffer_load_dwordx4 v5, s[8:11], s56 offen lds
    v_mfma_f32_16x16x32_bf16 v[224:227], a[24:27], v[104:107], v[224:227]
    ds_read_b128 a[60:63], v11 offset:38912
    v_perm_b32 v18, v16, v22, s42
    v_mfma_f32_16x16x32_bf16 v[224:227], a[28:31], v[112:115], v[224:227]
    v_perm_b32 v19, v16, v22, s43
    v_lshrrev_b64 v[20:21], 4, v[18:19]
    v_mfma_f32_16x16x32_bf16 v[228:231], a[24:27], v[108:111], v[228:231]
    s_waitcnt lgkmcnt(2)
    ds_read_b128 a[64:67], v10 offset:40960
    v_and_or_b32 v18, v18, s44, v1
    v_mfma_f32_16x16x32_bf16 v[228:231], a[28:31], v[116:119], v[228:231]
    s_addk_i32 s56, 128
    v_and_or_b32 v19, v19, s44, v1
    v_and_or_b32 v20, v20, s44, v1
    v_mfma_f32_16x16x32_bf16 v[232:235], a[32:35], v[104:107], v[232:235]
    s_addk_i32 m0, 4096
    ds_read_b128 a[68:71], v11 offset:40960
    v_and_or_b32 v21, v21, s44, v1
    v_mfma_f32_16x16x32_bf16 v[232:235], a[36:39], v[112:115], v[232:235]
    buffer_load_dwordx4 v5, s[8:11], s56 offen lds
    v_mfma_f32_16x16x32_bf16 v[236:239], a[32:35], v[108:111], v[236:239]
    ds_read_b128 a[72:75], v10 offset:43008
    v_perm_b32 v96, v48, v49, v18
    v_mfma_f32_16x16x32_bf16 v[236:239], a[36:39], v[116:119], v[236:239]
    v_perm_b32 v97, v48, v49, v20
    v_perm_b32 v98, v48, v49, v19
    v_mfma_f32_16x16x32_bf16 v[240:243], a[40:43], v[104:107], v[240:243]
    ds_read_b128 a[76:79], v11 offset:43008
    v_perm_b32 v99, v48, v49, v21
    v_mfma_f32_16x16x32_bf16 v[240:243], a[44:47], v[112:115], v[240:243]
    s_addk_i32 s56, 128
    v_perm_b32 v18, v17, v23, s40
    v_perm_b32 v19, v17, v23, s41
    v_mfma_f32_16x16x32_bf16 v[244:247], a[40:43], v[108:111], v[244:247]
    s_addk_i32 m0, 4096
    ds_read_b128 a[80:83], v10 offset:45056
    v_lshrrev_b64 v[20:21], 4, v[18:19]
    v_mfma_f32_16x16x32_bf16 v[244:247], a[44:47], v[116:119], v[244:247]
    buffer_load_dwordx4 v5, s[8:11], s56 offen lds
    v_mfma_f32_16x16x32_bf16 v[136:139], a[48:51], v[120:123], v[136:139]
    s_add_u32 s57, s57, s61
    ds_read_b128 a[84:87], v11 offset:45056
    v_and_or_b32 v18, v18, s44, v1
    v_mfma_f32_16x16x32_bf16 v[136:139], a[52:55], v[128:131], v[136:139]
    buffer_load_dwordx2 v[26:27], v3, s[12:15], s57 offen
    v_mfma_f32_16x16x32_bf16 v[140:143], a[48:51], v[124:127], v[140:143]
    s_waitcnt lgkmcnt(2)
    ds_read_b128 a[88:91], v10 offset:47104
    v_and_or_b32 v19, v19, s44, v1
    v_mfma_f32_16x16x32_bf16 v[140:143], a[52:55], v[132:135], v[140:143]
    s_mov_b32 s56, 132480
    v_and_or_b32 v20, v20, s44, v1
    v_and_or_b32 v21, v21, s44, v1
    v_mfma_f32_16x16x32_bf16 v[144:147], a[56:59], v[120:123], v[144:147]
    s_addk_i32 m0, 4096
    ds_read_b128 a[92:95], v11 offset:47104
    v_perm_b32 v92, v50, v51, v18
    v_mfma_f32_16x16x32_bf16 v[144:147], a[60:63], v[128:131], v[144:147]
    buffer_load_dwordx4 v5, s[8:11], s56 offen lds
    v_mfma_f32_16x16x32_bf16 v[148:151], a[56:59], v[124:127], v[148:151]
    ds_read_b128 a[0:3], v10 offset:49152
    v_perm_b32 v93, v50, v51, v20
    v_mfma_f32_16x16x32_bf16 v[148:151], a[60:63], v[132:135], v[148:151]
    v_perm_b32 v94, v50, v51, v19
    v_perm_b32 v95, v50, v51, v21
    v_mfma_f32_16x16x32_bf16 v[152:155], a[64:67], v[120:123], v[152:155]
    ds_read_b128 a[4:7], v11 offset:49152
    v_perm_b32 v18, v17, v23, s42
    v_mfma_f32_16x16x32_bf16 v[152:155], a[68:71], v[128:131], v[152:155]
    s_addk_i32 s56, 128
    v_perm_b32 v19, v17, v23, s43
    v_lshrrev_b64 v[20:21], 4, v[18:19]
    v_mfma_f32_16x16x32_bf16 v[156:159], a[64:67], v[124:127], v[156:159]
    s_addk_i32 m0, 4096
    ds_read_b128 a[8:11], v10 offset:51200
    v_and_or_b32 v18, v18, s44, v1
    v_mfma_f32_16x16x32_bf16 v[156:159], a[68:71], v[132:135], v[156:159]
    buffer_load_dwordx4 v5, s[8:11], s56 offen lds
    v_mfma_f32_16x16x32_bf16 v[160:163], a[72:75], v[120:123], v[160:163]
    ds_read_b128 a[12:15], v11 offset:51200
    v_and_or_b32 v19, v19, s44, v1
    v_mfma_f32_16x16x32_bf16 v[160:163], a[76:79], v[128:131], v[160:163]
    v_and_or_b32 v20, v20, s44, v1
    v_and_or_b32 v21, v21, s44, v1
    v_mfma_f32_16x16x32_bf16 v[164:167], a[72:75], v[124:127], v[164:167]
    s_waitcnt lgkmcnt(2)
    ds_read_b128 a[16:19], v10 offset:53248
    v_perm_b32 v100, v50, v51, v18
    v_mfma_f32_16x16x32_bf16 v[164:167], a[76:79], v[132:135], v[164:167]
    s_addk_i32 s56, 128
    v_perm_b32 v101, v50, v51, v20
    v_perm_b32 v102, v50, v51, v19
    v_mfma_f32_16x16x32_bf16 v[168:171], a[80:83], v[120:123], v[168:171]
    s_addk_i32 m0, 4096
    ds_read_b128 a[20:23], v11 offset:53248
    v_perm_b32 v103, v50, v51, v21
    v_mfma_f32_16x16x32_bf16 v[168:171], a[84:87], v[128:131], v[168:171]
    buffer_load_dwordx4 v5, s[8:11], s56 offen lds
    v_mfma_f32_16x16x32_bf16 v[172:175], a[80:83], v[124:127], v[172:175]
    s_waitcnt vmcnt(11) lgkmcnt(2)
    ds_read_b128 a[24:27], v10 offset:55296
    v_lshrrev_b64 v[16:17], 2, v[24:25]
    v_mfma_f32_16x16x32_bf16 v[172:175], a[84:87], v[132:135], v[172:175]
    ds_read_b128 v[52:55], v2 offset:1280
    v_perm_b32 v18, v16, v24, s40
    v_mfma_f32_16x16x32_bf16 v[176:179], a[88:91], v[120:123], v[176:179]
    ds_read_b128 a[28:31], v11 offset:55296
    v_perm_b32 v19, v16, v24, s41
    v_mfma_f32_16x16x32_bf16 v[176:179], a[92:95], v[128:131], v[176:179]
    s_addk_i32 s56, 128
    v_lshrrev_b64 v[20:21], 4, v[18:19]
    v_and_or_b32 v18, v18, s44, v1
    v_mfma_f32_16x16x32_bf16 v[180:183], a[88:91], v[124:127], v[180:183]
    s_addk_i32 m0, 4096
    ds_read_b128 a[32:35], v10 offset:57344
    v_and_or_b32 v19, v19, s44, v1
    v_mfma_f32_16x16x32_bf16 v[180:183], a[92:95], v[132:135], v[180:183]
    buffer_load_dwordx4 v5, s[8:11], s56 offen lds
    v_mfma_f32_16x16x32_bf16 v[184:187], a[0:3], v[120:123], v[184:187]
    ds_read_b128 a[36:39], v11 offset:57344
    v_and_or_b32 v20, v20, s44, v1
    v_mfma_f32_16x16x32_bf16 v[184:187], a[4:7], v[128:131], v[184:187]
    s_waitcnt lgkmcnt(2)
    v_and_or_b32 v21, v21, s44, v1
    v_perm_b32 v104, v52, v53, v18
    v_mfma_f32_16x16x32_bf16 v[188:191], a[0:3], v[124:127], v[188:191]
    ds_read_b128 a[40:43], v10 offset:59392
    v_perm_b32 v105, v52, v53, v20
    v_mfma_f32_16x16x32_bf16 v[188:191], a[4:7], v[132:135], v[188:191]
    s_addk_i32 s56, 128
    v_perm_b32 v106, v52, v53, v19
    v_perm_b32 v107, v52, v53, v21
    v_mfma_f32_16x16x32_bf16 v[192:195], a[8:11], v[120:123], v[192:195]
    s_addk_i32 m0, 4096
    ds_read_b128 a[44:47], v11 offset:59392
    v_perm_b32 v18, v16, v24, s42
    v_mfma_f32_16x16x32_bf16 v[192:195], a[12:15], v[128:131], v[192:195]
    buffer_load_dwordx4 v5, s[8:11], s56 offen lds
    v_mfma_f32_16x16x32_bf16 v[196:199], a[8:11], v[124:127], v[196:199]
    ds_read_b128 a[48:51], v10 offset:61440
    v_perm_b32 v19, v16, v24, s43
    v_mfma_f32_16x16x32_bf16 v[196:199], a[12:15], v[132:135], v[196:199]
    v_lshrrev_b64 v[20:21], 4, v[18:19]
    v_and_or_b32 v18, v18, s44, v1
    v_mfma_f32_16x16x32_bf16 v[200:203], a[16:19], v[120:123], v[200:203]
    ds_read_b128 a[52:55], v11 offset:61440
    v_and_or_b32 v19, v19, s44, v1
    v_mfma_f32_16x16x32_bf16 v[200:203], a[20:23], v[128:131], v[200:203]
    s_mov_b32 s56, 198016
    v_and_or_b32 v20, v20, s44, v1
    v_and_or_b32 v21, v21, s44, v1
    v_mfma_f32_16x16x32_bf16 v[204:207], a[16:19], v[124:127], v[204:207]
    s_addk_i32 m0, 4096
    ds_read_b128 a[56:59], v10 offset:63488
    v_perm_b32 v112, v52, v53, v18
    v_mfma_f32_16x16x32_bf16 v[204:207], a[20:23], v[132:135], v[204:207]
    buffer_load_dwordx4 v5, s[8:11], s56 offen lds
    v_mfma_f32_16x16x32_bf16 v[208:211], a[24:27], v[120:123], v[208:211]
    ds_read_b128 a[60:63], v11 offset:63488
    v_perm_b32 v113, v52, v53, v20
    v_mfma_f32_16x16x32_bf16 v[208:211], a[28:31], v[128:131], v[208:211]
    v_perm_b32 v114, v52, v53, v19
    v_perm_b32 v115, v52, v53, v21
    v_mfma_f32_16x16x32_bf16 v[212:215], a[24:27], v[124:127], v[212:215]
    s_waitcnt lgkmcnt(2)
    ds_read_b128 a[64:67], v12 offset:0
    v_perm_b32 v18, v17, v25, s40
    v_mfma_f32_16x16x32_bf16 v[212:215], a[28:31], v[132:135], v[212:215]
    s_addk_i32 s56, 128
    v_perm_b32 v19, v17, v25, s41
    v_lshrrev_b64 v[20:21], 4, v[18:19]
    v_mfma_f32_16x16x32_bf16 v[216:219], a[32:35], v[120:123], v[216:219]
    s_add_u32 s57, s57, s61
    ds_read_b128 a[68:71], v13 offset:0
    v_and_or_b32 v18, v18, s44, v1
    v_mfma_f32_16x16x32_bf16 v[216:219], a[36:39], v[128:131], v[216:219]
    buffer_load_dwordx2 v[28:29], v3, s[12:15], s57 offen
    v_mfma_f32_16x16x32_bf16 v[220:223], a[32:35], v[124:127], v[220:223]
    s_addk_i32 m0, 4096
    ds_read_b128 a[72:75], v12 offset:2048
    v_and_or_b32 v19, v19, s44, v1
    v_mfma_f32_16x16x32_bf16 v[220:223], a[36:39], v[132:135], v[220:223]
    buffer_load_dwordx4 v5, s[8:11], s56 offen lds
    v_mfma_f32_16x16x32_bf16 v[224:227], a[40:43], v[120:123], v[224:227]
    ds_read_b128 a[76:79], v13 offset:2048
    v_and_or_b32 v20, v20, s44, v1
    v_mfma_f32_16x16x32_bf16 v[224:227], a[44:47], v[128:131], v[224:227]
    s_addk_i32 s56, 128
    v_and_or_b32 v21, v21, s44, v1
    v_perm_b32 v108, v54, v55, v18
    v_mfma_f32_16x16x32_bf16 v[228:231], a[40:43], v[124:127], v[228:231]
    s_addk_i32 m0, 4096
    ds_read_b128 a[80:83], v12 offset:4096
    v_perm_b32 v109, v54, v55, v20
    v_mfma_f32_16x16x32_bf16 v[228:231], a[44:47], v[132:135], v[228:231]
    buffer_load_dwordx4 v5, s[8:11], s56 offen lds
    v_mfma_f32_16x16x32_bf16 v[232:235], a[48:51], v[120:123], v[232:235]
    ds_read_b128 a[84:87], v13 offset:4096
    v_perm_b32 v110, v54, v55, v19
    v_mfma_f32_16x16x32_bf16 v[232:235], a[52:55], v[128:131], v[232:235]
    v_perm_b32 v111, v54, v55, v21
    v_perm_b32 v18, v17, v25, s42
    v_mfma_f32_16x16x32_bf16 v[236:239], a[48:51], v[124:127], v[236:239]
    s_waitcnt lgkmcnt(2)
    ds_read_b128 a[88:91], v12 offset:6144
    v_perm_b32 v19, v17, v25, s43
    v_mfma_f32_16x16x32_bf16 v[236:239], a[52:55], v[132:135], v[236:239]
    s_addk_i32 s56, 128
    v_lshrrev_b64 v[20:21], 4, v[18:19]
    v_and_or_b32 v18, v18, s44, v1
    v_mfma_f32_16x16x32_bf16 v[240:243], a[56:59], v[120:123], v[240:243]
    s_addk_i32 m0, 4096
    ds_read_b128 a[92:95], v13 offset:6144
    v_and_or_b32 v19, v19, s44, v1
    v_mfma_f32_16x16x32_bf16 v[240:243], a[60:63], v[128:131], v[240:243]
    buffer_load_dwordx4 v5, s[8:11], s56 offen lds
    v_mfma_f32_16x16x32_bf16 v[244:247], a[56:59], v[124:127], v[244:247]
    ds_read_b128 a[0:3], v12 offset:8192
    v_and_or_b32 v20, v20, s44, v1
    v_mfma_f32_16x16x32_bf16 v[244:247], a[60:63], v[132:135], v[244:247]
    v_and_or_b32 v21, v21, s44, v1
    v_perm_b32 v116, v54, v55, v18
    v_mfma_f32_16x16x32_bf16 v[136:139], a[64:67], v[56:59], v[136:139]
    ds_read_b128 a[4:7], v13 offset:8192
    v_perm_b32 v117, v54, v55, v20
    v_mfma_f32_16x16x32_bf16 v[136:139], a[68:71], v[64:67], v[136:139]
    s_addk_i32 s56, 128
    ds_read_b128 v[48:51], v2 offset:1536
    v_perm_b32 v118, v54, v55, v19
    v_mfma_f32_16x16x32_bf16 v[140:143], a[64:67], v[60:63], v[140:143]
    s_addk_i32 m0, 4096
    ds_read_b128 a[8:11], v12 offset:10240
    v_perm_b32 v119, v54, v55, v21
    v_mfma_f32_16x16x32_bf16 v[140:143], a[68:71], v[68:71], v[140:143]
    buffer_load_dwordx4 v5, s[8:11], s56 offen lds
    v_mfma_f32_16x16x32_bf16 v[144:147], a[72:75], v[56:59], v[144:147]
    s_waitcnt vmcnt(11) lgkmcnt(3)
    ds_read_b128 a[12:15], v13 offset:10240
    v_lshrrev_b64 v[16:17], 2, v[26:27]
    v_mfma_f32_16x16x32_bf16 v[144:147], a[76:79], v[64:67], v[144:147]
    v_perm_b32 v18, v16, v26, s40
    v_perm_b32 v19, v16, v26, s41
    v_mfma_f32_16x16x32_bf16 v[148:151], a[72:75], v[60:63], v[148:151]
    ds_read_b128 a[16:19], v12 offset:12288
    v_lshrrev_b64 v[20:21], 4, v[18:19]
    v_mfma_f32_16x16x32_bf16 v[148:151], a[76:79], v[68:71], v[148:151]
    s_mov_b32 s56, 263552
    v_and_or_b32 v18, v18, s44, v1
    v_and_or_b32 v19, v19, s44, v1
    v_mfma_f32_16x16x32_bf16 v[152:155], a[80:83], v[56:59], v[152:155]
    s_addk_i32 m0, 4096
    ds_read_b128 a[20:23], v13 offset:12288
    v_and_or_b32 v20, v20, s44, v1
    v_mfma_f32_16x16x32_bf16 v[152:155], a[84:87], v[64:67], v[152:155]
    buffer_load_dwordx4 v5, s[8:11], s56 offen lds
    v_mfma_f32_16x16x32_bf16 v[156:159], a[80:83], v[60:63], v[156:159]
    ds_read_b128 a[24:27], v12 offset:14336
    v_and_or_b32 v21, v21, s44, v1
    v_mfma_f32_16x16x32_bf16 v[156:159], a[84:87], v[68:71], v[156:159]
    s_waitcnt lgkmcnt(2)
    v_perm_b32 v120, v48, v49, v18
    v_perm_b32 v121, v48, v49, v20
    v_mfma_f32_16x16x32_bf16 v[160:163], a[88:91], v[56:59], v[160:163]
    ds_read_b128 a[28:31], v13 offset:14336
    v_perm_b32 v122, v48, v49, v19
    v_mfma_f32_16x16x32_bf16 v[160:163], a[92:95], v[64:67], v[160:163]
    s_addk_i32 s56, 128
    v_perm_b32 v123, v48, v49, v21
    v_perm_b32 v18, v16, v26, s42
    v_mfma_f32_16x16x32_bf16 v[164:167], a[88:91], v[60:63], v[164:167]
    s_addk_i32 m0, 4096
    ds_read_b128 a[32:35], v12 offset:16384
    v_perm_b32 v19, v16, v26, s43
    v_mfma_f32_16x16x32_bf16 v[164:167], a[92:95], v[68:71], v[164:167]
    buffer_load_dwordx4 v5, s[8:11], s56 offen lds
    v_mfma_f32_16x16x32_bf16 v[168:171], a[0:3], v[56:59], v[168:171]
    ds_read_b128 a[36:39], v13 offset:16384
    v_lshrrev_b64 v[20:21], 4, v[18:19]
    v_mfma_f32_16x16x32_bf16 v[168:171], a[4:7], v[64:67], v[168:171]
    v_and_or_b32 v18, v18, s44, v1
    v_and_or_b32 v19, v19, s44, v1
    v_mfma_f32_16x16x32_bf16 v[172:175], a[0:3], v[60:63], v[172:175]
    ds_read_b128 a[40:43], v12 offset:18432
    v_and_or_b32 v20, v20, s44, v1
    v_mfma_f32_16x16x32_bf16 v[172:175], a[4:7], v[68:71], v[172:175]
    s_addk_i32 s56, 128
    v_and_or_b32 v21, v21, s44, v1
    v_perm_b32 v128, v48, v49, v18
    v_mfma_f32_16x16x32_bf16 v[176:179], a[8:11], v[56:59], v[176:179]
    s_addk_i32 m0, 4096
    ds_read_b128 a[44:47], v13 offset:18432
    v_perm_b32 v129, v48, v49, v20
    v_mfma_f32_16x16x32_bf16 v[176:179], a[12:15], v[64:67], v[176:179]
    buffer_load_dwordx4 v5, s[8:11], s56 offen lds
    v_mfma_f32_16x16x32_bf16 v[180:183], a[8:11], v[60:63], v[180:183]
    ds_read_b128 a[48:51], v12 offset:20480
    v_perm_b32 v130, v48, v49, v19
    v_mfma_f32_16x16x32_bf16 v[180:183], a[12:15], v[68:71], v[180:183]
    v_perm_b32 v131, v48, v49, v21
    v_perm_b32 v18, v17, v27, s40
    v_mfma_f32_16x16x32_bf16 v[184:187], a[16:19], v[56:59], v[184:187]
    s_waitcnt lgkmcnt(2)
    ds_read_b128 a[52:55], v13 offset:20480
    v_perm_b32 v19, v17, v27, s41
    v_mfma_f32_16x16x32_bf16 v[184:187], a[20:23], v[64:67], v[184:187]
    v_lshrrev_b64 v[20:21], 4, v[18:19]
    v_and_or_b32 v18, v18, s44, v1
    v_mfma_f32_16x16x32_bf16 v[188:191], a[16:19], v[60:63], v[188:191]
    ds_read_b128 a[56:59], v12 offset:22528
    v_and_or_b32 v19, v19, s44, v1
    v_mfma_f32_16x16x32_bf16 v[188:191], a[20:23], v[68:71], v[188:191]
    s_addk_i32 s56, 128
    v_and_or_b32 v20, v20, s44, v1
    v_and_or_b32 v21, v21, s44, v1
    v_mfma_f32_16x16x32_bf16 v[192:195], a[24:27], v[56:59], v[192:195]
    s_waitcnt vmcnt(8) lgkmcnt(2)
    ds_read_b128 a[60:63], v13 offset:22528
    v_perm_b32 v124, v50, v51, v18
    v_mfma_f32_16x16x32_bf16 v[192:195], a[28:31], v[64:67], v[192:195]
    s_barrier
    v_mfma_f32_16x16x32_bf16 v[196:199], a[24:27], v[60:63], v[196:199]
    s_addk_i32 m0, 4096
    ds_read_b128 a[64:67], v8 offset:0
    v_perm_b32 v125, v50, v51, v20
    v_mfma_f32_16x16x32_bf16 v[196:199], a[28:31], v[68:71], v[196:199]
    buffer_load_dwordx4 v5, s[8:11], s56 offen lds
    v_mfma_f32_16x16x32_bf16 v[200:203], a[32:35], v[56:59], v[200:203]
    ds_read_b128 a[68:71], v9 offset:0
    v_perm_b32 v126, v50, v51, v19
    v_mfma_f32_16x16x32_bf16 v[200:203], a[36:39], v[64:67], v[200:203]
    v_perm_b32 v127, v50, v51, v21
    v_perm_b32 v18, v17, v27, s42
    v_mfma_f32_16x16x32_bf16 v[204:207], a[32:35], v[60:63], v[204:207]
    ds_read_b128 a[72:75], v8 offset:2048
    v_perm_b32 v19, v17, v27, s43
    v_mfma_f32_16x16x32_bf16 v[204:207], a[36:39], v[68:71], v[204:207]
    s_addk_i32 s56, 128
    v_lshrrev_b64 v[20:21], 4, v[18:19]
    v_and_or_b32 v18, v18, s44, v1
    v_mfma_f32_16x16x32_bf16 v[208:211], a[40:43], v[56:59], v[208:211]
    s_addk_i32 m0, 4096
    ds_read_b128 a[76:79], v9 offset:2048
    v_and_or_b32 v19, v19, s44, v1
    v_mfma_f32_16x16x32_bf16 v[208:211], a[44:47], v[64:67], v[208:211]
    buffer_load_dwordx4 v5, s[8:11], s56 offen lds
    v_mfma_f32_16x16x32_bf16 v[212:215], a[40:43], v[60:63], v[212:215]
    ds_read_b128 a[80:83], v8 offset:4096
    v_and_or_b32 v20, v20, s44, v1
    v_mfma_f32_16x16x32_bf16 v[212:215], a[44:47], v[68:71], v[212:215]
    v_and_or_b32 v21, v21, s44, v1
    v_perm_b32 v132, v50, v51, v18
    v_mfma_f32_16x16x32_bf16 v[216:219], a[48:51], v[56:59], v[216:219]
    s_waitcnt lgkmcnt(2)
    ds_read_b128 a[84:87], v9 offset:4096
    v_perm_b32 v133, v50, v51, v20
    v_mfma_f32_16x16x32_bf16 v[216:219], a[52:55], v[64:67], v[216:219]
    s_mov_b32 s56, 329088
    ds_read_b128 v[52:55], v2 offset:1792
    v_perm_b32 v134, v50, v51, v19
    v_mfma_f32_16x16x32_bf16 v[220:223], a[48:51], v[60:63], v[220:223]
    s_addk_i32 m0, 4096
    ds_read_b128 a[88:91], v8 offset:6144
    v_perm_b32 v135, v50, v51, v21
    v_mfma_f32_16x16x32_bf16 v[220:223], a[52:55], v[68:71], v[220:223]
    buffer_load_dwordx4 v5, s[8:11], s56 offen lds
    v_mfma_f32_16x16x32_bf16 v[224:227], a[56:59], v[56:59], v[224:227]
    s_waitcnt vmcnt(10) lgkmcnt(3)
    ds_read_b128 a[92:95], v9 offset:6144
    v_lshrrev_b64 v[16:17], 2, v[28:29]
    v_mfma_f32_16x16x32_bf16 v[224:227], a[60:63], v[64:67], v[224:227]
    v_perm_b32 v18, v16, v28, s40
    v_perm_b32 v19, v16, v28, s41
    v_mfma_f32_16x16x32_bf16 v[228:231], a[56:59], v[60:63], v[228:231]
    ds_read_b128 a[0:3], v8 offset:8192
    v_lshrrev_b64 v[20:21], 4, v[18:19]
    v_mfma_f32_16x16x32_bf16 v[228:231], a[60:63], v[68:71], v[228:231]
    s_addk_i32 s56, 128
    v_and_or_b32 v18, v18, s44, v1
    v_and_or_b32 v19, v19, s44, v1
    v_mfma_f32_16x16x32_bf16 v[232:235], a[64:67], v[56:59], v[232:235]
    s_addk_i32 m0, 4096
    ds_read_b128 a[4:7], v9 offset:8192
    v_and_or_b32 v20, v20, s44, v1
    v_mfma_f32_16x16x32_bf16 v[232:235], a[68:71], v[64:67], v[232:235]
    buffer_load_dwordx4 v5, s[8:11], s56 offen lds
    v_mfma_f32_16x16x32_bf16 v[236:239], a[64:67], v[60:63], v[236:239]
    ds_read_b128 a[8:11], v8 offset:10240
    v_and_or_b32 v21, v21, s44, v1
    v_mfma_f32_16x16x32_bf16 v[236:239], a[68:71], v[68:71], v[236:239]
    v_mfma_f32_16x16x32_bf16 v[240:243], a[72:75], v[56:59], v[240:243]
    s_waitcnt lgkmcnt(2)
    ds_read_b128 a[12:15], v9 offset:10240
    v_perm_b32 v56, v52, v53, v18
    v_mfma_f32_16x16x32_bf16 v[240:243], a[76:79], v[64:67], v[240:243]
    s_addk_i32 s56, 128
    v_perm_b32 v57, v52, v53, v20
    v_perm_b32 v58, v52, v53, v19
    v_mfma_f32_16x16x32_bf16 v[244:247], a[72:75], v[60:63], v[244:247]
    s_addk_i32 m0, 4096
    ds_read_b128 a[16:19], v8 offset:12288
    v_perm_b32 v59, v52, v53, v21
    v_mfma_f32_16x16x32_bf16 v[244:247], a[76:79], v[68:71], v[244:247]
    buffer_load_dwordx4 v5, s[8:11], s56 offen lds
    v_mfma_f32_16x16x32_bf16 v[136:139], a[80:83], v[72:75], v[136:139]
    ds_read_b128 a[20:23], v9 offset:12288
    v_perm_b32 v18, v16, v28, s42
    v_mfma_f32_16x16x32_bf16 v[136:139], a[84:87], v[80:83], v[136:139]
    v_perm_b32 v19, v16, v28, s43
    v_lshrrev_b64 v[20:21], 4, v[18:19]
    v_mfma_f32_16x16x32_bf16 v[140:143], a[80:83], v[76:79], v[140:143]
    ds_read_b128 a[24:27], v8 offset:14336
    v_and_or_b32 v18, v18, s44, v1
    v_mfma_f32_16x16x32_bf16 v[140:143], a[84:87], v[84:87], v[140:143]
    s_addk_i32 s56, 128
    v_and_or_b32 v19, v19, s44, v1
    v_and_or_b32 v20, v20, s44, v1
    v_mfma_f32_16x16x32_bf16 v[144:147], a[88:91], v[72:75], v[144:147]
    s_addk_i32 m0, 4096
    ds_read_b128 a[28:31], v9 offset:14336
    v_and_or_b32 v21, v21, s44, v1
    v_mfma_f32_16x16x32_bf16 v[144:147], a[92:95], v[80:83], v[144:147]
    buffer_load_dwordx4 v5, s[8:11], s56 offen lds
    v_mfma_f32_16x16x32_bf16 v[148:151], a[88:91], v[76:79], v[148:151]
    ds_read_b128 a[32:35], v8 offset:16384
    v_perm_b32 v64, v52, v53, v18
    v_mfma_f32_16x16x32_bf16 v[148:151], a[92:95], v[84:87], v[148:151]
    v_perm_b32 v65, v52, v53, v20
    v_perm_b32 v66, v52, v53, v19
    v_mfma_f32_16x16x32_bf16 v[136:139], a[0:3], v[88:91], v[136:139]
    s_waitcnt lgkmcnt(2)
    ds_read_b128 a[36:39], v9 offset:16384
    v_perm_b32 v67, v52, v53, v21
    v_mfma_f32_16x16x32_bf16 v[136:139], a[4:7], v[96:99], v[136:139]
    s_addk_i32 s56, 128
    v_perm_b32 v18, v17, v29, s40
    v_perm_b32 v19, v17, v29, s41
    v_mfma_f32_16x16x32_bf16 v[140:143], a[0:3], v[92:95], v[140:143]
    s_addk_i32 m0, 4096
    ds_read_b128 a[40:43], v8 offset:18432
    v_lshrrev_b64 v[20:21], 4, v[18:19]
    v_mfma_f32_16x16x32_bf16 v[140:143], a[4:7], v[100:103], v[140:143]
    buffer_load_dwordx4 v5, s[8:11], s56 offen lds
    v_mfma_f32_16x16x32_bf16 v[144:147], a[8:11], v[88:91], v[144:147]
    ds_read_b128 a[44:47], v9 offset:18432
    v_and_or_b32 v18, v18, s44, v1
    v_mfma_f32_16x16x32_bf16 v[144:147], a[12:15], v[96:99], v[144:147]
    v_and_or_b32 v19, v19, s44, v1
    v_and_or_b32 v20, v20, s44, v1
    v_mfma_f32_16x16x32_bf16 v[148:151], a[8:11], v[92:95], v[148:151]
    ds_read_b128 a[48:51], v8 offset:20480
    v_and_or_b32 v21, v21, s44, v1
    v_mfma_f32_16x16x32_bf16 v[148:151], a[12:15], v[100:103], v[148:151]
    s_mov_b32 s56, 394624
    v_perm_b32 v60, v54, v55, v18
    v_perm_b32 v61, v54, v55, v20
    v_mfma_f32_16x16x32_bf16 v[136:139], a[16:19], v[104:107], v[136:139]
    s_addk_i32 m0, 4096
    ds_read_b128 a[52:55], v9 offset:20480
    v_perm_b32 v62, v54, v55, v19
    v_mfma_f32_16x16x32_bf16 v[136:139], a[20:23], v[112:115], v[136:139]
    buffer_load_dwordx4 v5, s[8:11], s56 offen lds
    v_mfma_f32_16x16x32_bf16 v[140:143], a[16:19], v[108:111], v[140:143]
    ds_read_b128 a[56:59], v8 offset:22528
    v_perm_b32 v63, v54, v55, v21
    v_mfma_f32_16x16x32_bf16 v[140:143], a[20:23], v[116:119], v[140:143]
    v_perm_b32 v18, v17, v29, s42
    v_perm_b32 v19, v17, v29, s43
    v_mfma_f32_16x16x32_bf16 v[144:147], a[24:27], v[104:107], v[144:147]
    s_waitcnt lgkmcnt(2)
    ds_read_b128 a[60:63], v9 offset:22528
    v_lshrrev_b64 v[20:21], 4, v[18:19]
    v_mfma_f32_16x16x32_bf16 v[144:147], a[28:31], v[112:115], v[144:147]
    s_addk_i32 s56, 128
    v_and_or_b32 v18, v18, s44, v1
    v_and_or_b32 v19, v19, s44, v1
    v_mfma_f32_16x16x32_bf16 v[148:151], a[24:27], v[108:111], v[148:151]
    s_addk_i32 m0, 4096
    ds_read_b128 a[64:67], v8 offset:24576
    v_and_or_b32 v20, v20, s44, v1
    v_mfma_f32_16x16x32_bf16 v[148:151], a[28:31], v[116:119], v[148:151]
    buffer_load_dwordx4 v5, s[8:11], s56 offen lds
    v_mfma_f32_16x16x32_bf16 v[136:139], a[32:35], v[120:123], v[136:139]
    ds_read_b128 a[68:71], v9 offset:24576
    v_and_or_b32 v21, v21, s44, v1
    v_mfma_f32_16x16x32_bf16 v[136:139], a[36:39], v[128:131], v[136:139]
    v_perm_b32 v68, v54, v55, v18
    v_perm_b32 v69, v54, v55, v20
    v_mfma_f32_16x16x32_bf16 v[140:143], a[32:35], v[124:127], v[140:143]
    ds_read_b128 a[72:75], v8 offset:28672
    v_perm_b32 v70, v54, v55, v19
    v_mfma_f32_16x16x32_bf16 v[140:143], a[36:39], v[132:135], v[140:143]
    s_addk_i32 s56, 128
    v_perm_b32 v71, v54, v55, v21
    v_mfma_f32_16x16x32_bf16 v[144:147], a[40:43], v[120:123], v[144:147]
    s_addk_i32 m0, 4096
    ds_read_b128 a[76:79], v9 offset:28672
    v_mfma_f32_16x16x32_bf16 v[144:147], a[44:47], v[128:131], v[144:147]
    buffer_load_dwordx4 v5, s[8:11], s56 offen lds
    v_mfma_f32_16x16x32_bf16 v[148:151], a[40:43], v[124:127], v[148:151]
    ds_read_b128 a[80:83], v8 offset:32768
    v_mfma_f32_16x16x32_bf16 v[148:151], a[44:47], v[132:135], v[148:151]
    v_mfma_f32_16x16x32_bf16 v[136:139], a[48:51], v[56:59], v[136:139]
    s_waitcnt lgkmcnt(2)
    ds_read_b128 a[84:87], v9 offset:32768
    v_mfma_f32_16x16x32_bf16 v[136:139], a[52:55], v[64:67], v[136:139]
    s_addk_i32 s56, 128
    v_mfma_f32_16x16x32_bf16 v[140:143], a[48:51], v[60:63], v[140:143]
    s_addk_i32 m0, 4096
    ds_read_b128 a[88:91], v8 offset:36864
    v_mfma_f32_16x16x32_bf16 v[140:143], a[52:55], v[68:71], v[140:143]
    buffer_load_dwordx4 v5, s[8:11], s56 offen lds
    v_mfma_f32_16x16x32_bf16 v[144:147], a[56:59], v[56:59], v[144:147]
    ds_read_b128 a[92:95], v9 offset:36864
    v_mfma_f32_16x16x32_bf16 v[144:147], a[60:63], v[64:67], v[144:147]
    v_mfma_f32_16x16x32_bf16 v[148:151], a[56:59], v[60:63], v[148:151]
    ds_read_b128 a[0:3], v8 offset:40960
    v_mfma_f32_16x16x32_bf16 v[148:151], a[60:63], v[68:71], v[148:151]
    s_addk_i32 s56, 128
    v_mfma_f32_16x16x32_bf16 v[152:155], a[64:67], v[72:75], v[152:155]
    s_addk_i32 m0, 4096
    ds_read_b128 a[4:7], v9 offset:40960
    v_mfma_f32_16x16x32_bf16 v[152:155], a[68:71], v[80:83], v[152:155]
    buffer_load_dwordx4 v5, s[8:11], s56 offen lds
    v_mfma_f32_16x16x32_bf16 v[152:155], a[72:75], v[88:91], v[152:155]
    s_waitcnt lgkmcnt(2)
    ds_read_b128 a[8:11], v8 offset:26624
    v_mfma_f32_16x16x32_bf16 v[152:155], a[76:79], v[96:99], v[152:155]
    v_mfma_f32_16x16x32_bf16 v[152:155], a[80:83], v[104:107], v[152:155]
    s_movk_i32 s58, 0
    ds_read_b128 a[12:15], v9 offset:26624
    v_cvt_pk_bf16_f32 v136, v136, v140
    v_mfma_f32_16x16x32_bf16 v[152:155], a[84:87], v[112:115], v[152:155]
    buffer_store_dword v136, v4, s[24:27], s58 offen sc1 nt
    v_mfma_f32_16x16x32_bf16 v[152:155], a[88:91], v[120:123], v[152:155]
L_hopB5:
    s_cbranch_execz L_hopret
    ds_read_b128 a[16:19], v8 offset:30720
    v_mfma_f32_16x16x32_bf16 v[152:155], a[92:95], v[128:131], v[152:155]
    s_waitcnt lgkmcnt(2)
    v_mfma_f32_16x16x32_bf16 v[152:155], a[0:3], v[56:59], v[152:155]
    s_addk_i32 s58, 7168
    ds_read_b128 a[20:23], v9 offset:30720
    v_cvt_pk_bf16_f32 v137, v137, v141
    v_mfma_f32_16x16x32_bf16 v[152:155], a[4:7], v[64:67], v[152:155]
    buffer_store_dword v137, v4, s[24:27], s58 offen sc1 nt
    v_mfma_f32_16x16x32_bf16 v[156:159], a[64:67], v[76:79], v[156:159]
    ds_read_b128 a[24:27], v8 offset:34816
    v_mfma_f32_16x16x32_bf16 v[156:159], a[68:71], v[84:87], v[156:159]
    v_mfma_f32_16x16x32_bf16 v[156:159], a[72:75], v[92:95], v[156:159]
    s_addk_i32 s58, 7168
    ds_read_b128 a[28:31], v9 offset:34816
    v_cvt_pk_bf16_f32 v138, v138, v142
    v_mfma_f32_16x16x32_bf16 v[156:159], a[76:79], v[100:103], v[156:159]
    buffer_store_dword v138, v4, s[24:27], s58 offen sc1 nt
    v_mfma_f32_16x16x32_bf16 v[156:159], a[80:83], v[108:111], v[156:159]
    ds_read_b128 a[32:35], v8 offset:38912
    v_mfma_f32_16x16x32_bf16 v[156:159], a[84:87], v[116:119], v[156:159]
    v_mfma_f32_16x16x32_bf16 v[156:159], a[88:91], v[124:127], v[156:159]
    s_addk_i32 s58, 7168
    ds_read_b128 a[36:39], v9 offset:38912
    v_cvt_pk_bf16_f32 v139, v139, v143
    v_mfma_f32_16x16x32_bf16 v[156:159], a[92:95], v[132:135], v[156:159]
    buffer_store_dword v139, v4, s[24:27], s58 offen sc1 nt
    v_mfma_f32_16x16x32_bf16 v[156:159], a[0:3], v[60:63], v[156:159]
    ds_read_b128 a[40:43], v8 offset:43008
    v_mfma_f32_16x16x32_bf16 v[156:159], a[4:7], v[68:71], v[156:159]
    s_waitcnt lgkmcnt(2)
    v_mfma_f32_16x16x32_bf16 v[160:163], a[8:11], v[72:75], v[160:163]
    s_add_u32 s58, s58, s63
    ds_read_b128 a[44:47], v9 offset:43008
    v_cvt_pk_bf16_f32 v144, v144, v148
    v_mfma_f32_16x16x32_bf16 v[160:163], a[12:15], v[80:83], v[160:163]
    buffer_store_dword v144, v4, s[24:27], s58 offen sc1 nt
    v_mfma_f32_16x16x32_bf16 v[160:163], a[16:19], v[88:91], v[160:163]
    ds_read_b128 a[48:51], v8 offset:45056
    v_mfma_f32_16x16x32_bf16 v[160:163], a[20:23], v[96:99], v[160:163]
    v_mfma_f32_16x16x32_bf16 v[160:163], a[24:27], v[104:107], v[160:163]
    s_addk_i32 s58, 7168
    ds_read_b128 a[52:55], v9 offset:45056
    v_cvt_pk_bf16_f32 v145, v145, v149
    v_mfma_f32_16x16x32_bf16 v[160:163], a[28:31], v[112:115], v[160:163]
    buffer_store_dword v145, v4, s[24:27], s58 offen sc1 nt
    v_mfma_f32_16x16x32_bf16 v[160:163], a[32:35], v[120:123], v[160:163]
    s_waitcnt lgkmcnt(2)
    ds_read_b128 a[56:59], v8 offset:49152
    v_mfma_f32_16x16x32_bf16 v[160:163], a[36:39], v[128:131], v[160:163]
    v_mfma_f32_16x16x32_bf16 v[160:163], a[40:43], v[56:59], v[160:163]
    s_addk_i32 s58, 7168
    ds_read_b128 a[60:63], v9 offset:49152
    v_cvt_pk_bf16_f32 v146, v146, v150
    v_mfma_f32_16x16x32_bf16 v[160:163], a[44:47], v[64:67], v[160:163]
    buffer_store_dword v146, v4, s[24:27], s58 offen sc1 nt
    v_mfma_f32_16x16x32_bf16 v[164:167], a[8:11], v[76:79], v[164:167]
    ds_read_b128 a[64:67], v8 offset:53248
    v_mfma_f32_16x16x32_bf16 v[164:167], a[12:15], v[84:87], v[164:167]
    v_mfma_f32_16x16x32_bf16 v[164:167], a[16:19], v[92:95], v[164:167]
    s_addk_i32 s58, 7168
    ds_read_b128 a[68:71], v9 offset:53248
    v_cvt_pk_bf16_f32 v147, v147, v151
    v_mfma_f32_16x16x32_bf16 v[164:167], a[20:23], v[100:103], v[164:167]
    buffer_store_dword v147, v4, s[24:27], s58 offen sc1 nt
    v_mfma_f32_16x16x32_bf16 v[164:167], a[24:27], v[108:111], v[164:167]
    ds_read_b128 a[72:75], v8 offset:57344
    v_mfma_f32_16x16x32_bf16 v[164:167], a[28:31], v[116:119], v[164:167]
    v_mfma_f32_16x16x32_bf16 v[164:167], a[32:35], v[124:127], v[164:167]
    ds_read_b128 a[76:79], v9 offset:57344
    v_mfma_f32_16x16x32_bf16 v[164:167], a[36:39], v[132:135], v[164:167]
    s_waitcnt lgkmcnt(2)
    v_mfma_f32_16x16x32_bf16 v[164:167], a[40:43], v[60:63], v[164:167]
    s_add_u32 s58, s58, s63
    ds_read_b128 a[80:83], v8 offset:61440
    v_cvt_pk_bf16_f32 v152, v152, v156
    v_mfma_f32_16x16x32_bf16 v[164:167], a[44:47], v[68:71], v[164:167]
    buffer_store_dword v152, v4, s[24:27], s58 offen sc1 nt
    v_mfma_f32_16x16x32_bf16 v[168:171], a[48:51], v[72:75], v[168:171]
    ds_read_b128 a[84:87], v9 offset:61440
    v_mfma_f32_16x16x32_bf16 v[168:171], a[52:55], v[80:83], v[168:171]
    v_mfma_f32_16x16x32_bf16 v[168:171], a[56:59], v[88:91], v[168:171]
    s_addk_i32 s58, 7168
    ds_read_b128 a[88:91], v8 offset:47104
    v_cvt_pk_bf16_f32 v153, v153, v157
    v_mfma_f32_16x16x32_bf16 v[168:171], a[60:63], v[96:99], v[168:171]
    buffer_store_dword v153, v4, s[24:27], s58 offen sc1 nt
    v_mfma_f32_16x16x32_bf16 v[168:171], a[64:67], v[104:107], v[168:171]
    ds_read_b128 a[92:95], v9 offset:47104
    v_mfma_f32_16x16x32_bf16 v[168:171], a[68:71], v[112:115], v[168:171]
    s_waitcnt lgkmcnt(2)
    v_mfma_f32_16x16x32_bf16 v[168:171], a[72:75], v[120:123], v[168:171]
    s_addk_i32 s58, 7168
    ds_read_b128 a[0:3], v8 offset:51200
    v_cvt_pk_bf16_f32 v154, v154, v158
    v_mfma_f32_16x16x32_bf16 v[168:171], a[76:79], v[128:131], v[168:171]
    buffer_store_dword v154, v4, s[24:27], s58 offen sc1 nt
    v_mfma_f32_16x16x32_bf16 v[168:171], a[80:83], v[56:59], v[168:171]
    ds_read_b128 a[4:7], v9 offset:51200
    v_mfma_f32_16x16x32_bf16 v[168:171], a[84:87], v[64:67], v[168:171]
    v_mfma_f32_16x16x32_bf16 v[172:175], a[48:51], v[76:79], v[172:175]
    s_addk_i32 s58, 7168
    ds_read_b128 a[8:11], v8 offset:55296
    v_cvt_pk_bf16_f32 v155, v155, v159
    v_mfma_f32_16x16x32_bf16 v[172:175], a[52:55], v[84:87], v[172:175]
    buffer_store_dword v155, v4, s[24:27], s58 offen sc1 nt
    v_mfma_f32_16x16x32_bf16 v[172:175], a[56:59], v[92:95], v[172:175]
    ds_read_b128 a[12:15], v9 offset:55296
    v_mfma_f32_16x16x32_bf16 v[172:175], a[60:63], v[100:103], v[172:175]
    v_mfma_f32_16x16x32_bf16 v[172:175], a[64:67], v[108:111], v[172:175]
    s_add_u32 s58, s58, s63
    ds_read_b128 a[16:19], v8 offset:59392
    v_cvt_pk_bf16_f32 v160, v160, v164
    v_mfma_f32_16x16x32_bf16 v[172:175], a[68:71], v[116:119], v[172:175]
    buffer_store_dword v160, v4, s[24:27], s58 offen sc1 nt
    v_mfma_f32_16x16x32_bf16 v[172:175], a[72:75], v[124:127], v[172:175]
    ds_read_b128 a[20:23], v9 offset:59392
    v_mfma_f32_16x16x32_bf16 v[172:175], a[76:79], v[132:135], v[172:175]
    s_waitcnt lgkmcnt(2)
    v_mfma_f32_16x16x32_bf16 v[172:175], a[80:83], v[60:63], v[172:175]
    s_addk_i32 s58, 7168
    ds_read_b128 a[24:27], v8 offset:63488
    v_cvt_pk_bf16_f32 v161, v161, v165
    v_mfma_f32_16x16x32_bf16 v[172:175], a[84:87], v[68:71], v[172:175]
    buffer_store_dword v161, v4, s[24:27], s58 offen sc1 nt
    v_mfma_f32_16x16x32_bf16 v[176:179], a[88:91], v[72:75], v[176:179]
    ds_read_b128 a[28:31], v9 offset:63488
    v_mfma_f32_16x16x32_bf16 v[176:179], a[92:95], v[80:83], v[176:179]
    v_mfma_f32_16x16x32_bf16 v[176:179], a[0:3], v[88:91], v[176:179]
    s_waitcnt vmcnt(16) lgkmcnt(2)
    ds_read_b128 a[32:35], v10 offset:0
    v_mfma_f32_16x16x32_bf16 v[176:179], a[4:7], v[96:99], v[176:179]
    s_barrier
    v_mfma_f32_16x16x32_bf16 v[176:179], a[8:11], v[104:107], v[176:179]
    s_addk_i32 s58, 7168
    ds_read_b128 a[36:39], v11 offset:0
    v_cvt_pk_bf16_f32 v162, v162, v166
    v_mfma_f32_16x16x32_bf16 v[176:179], a[12:15], v[112:115], v[176:179]
    buffer_store_dword v162, v4, s[24:27], s58 offen sc1 nt
    v_mfma_f32_16x16x32_bf16 v[176:179], a[16:19], v[120:123], v[176:179]
    s_waitcnt lgkmcnt(2)
    s_addk_i32 s58, 7168
    ds_read_b128 a[40:43], v10 offset:4096
    v_cvt_pk_bf16_f32 v163, v163, v167
    v_mfma_f32_16x16x32_bf16 v[176:179], a[20:23], v[128:131], v[176:179]
    buffer_store_dword v163, v4, s[24:27], s58 offen sc1 nt
    v_mfma_f32_16x16x32_bf16 v[176:179], a[24:27], v[56:59], v[176:179]
    ds_read_b128 a[44:47], v11 offset:4096
    v_mfma_f32_16x16x32_bf16 v[176:179], a[28:31], v[64:67], v[176:179]
    v_mfma_f32_16x16x32_bf16 v[180:183], a[88:91], v[76:79], v[180:183]
    ds_read_b128 a[48:51], v10 offset:8192
    v_mfma_f32_16x16x32_bf16 v[180:183], a[92:95], v[84:87], v[180:183]
    v_mfma_f32_16x16x32_bf16 v[180:183], a[0:3], v[92:95], v[180:183]
    s_add_u32 s58, s58, s63
    ds_read_b128 a[52:55], v11 offset:8192
    v_cvt_pk_bf16_f32 v168, v168, v172
    v_mfma_f32_16x16x32_bf16 v[180:183], a[4:7], v[100:103], v[180:183]
    buffer_store_dword v168, v4, s[24:27], s58 offen sc1 nt
    v_mfma_f32_16x16x32_bf16 v[180:183], a[8:11], v[108:111], v[180:183]
    ds_read_b128 a[56:59], v10 offset:12288
    v_mfma_f32_16x16x32_bf16 v[180:183], a[12:15], v[116:119], v[180:183]
    v_mfma_f32_16x16x32_bf16 v[180:183], a[16:19], v[124:127], v[180:183]
    s_addk_i32 s58, 7168
    ds_read_b128 a[60:63], v11 offset:12288
    v_cvt_pk_bf16_f32 v169, v169, v173
    v_mfma_f32_16x16x32_bf16 v[180:183], a[20:23], v[132:135], v[180:183]
    buffer_store_dword v169, v4, s[24:27], s58 offen sc1 nt
    v_mfma_f32_16x16x32_bf16 v[180:183], a[24:27], v[60:63], v[180:183]
    ds_read_b128 a[64:67], v10 offset:16384
    v_mfma_f32_16x16x32_bf16 v[180:183], a[28:31], v[68:71], v[180:183]
    s_waitcnt lgkmcnt(2)
    v_mfma_f32_16x16x32_bf16 v[184:187], a[32:35], v[72:75], v[184:187]
    s_addk_i32 s58, 7168
    ds_read_b128 a[68:71], v11 offset:16384
    v_cvt_pk_bf16_f32 v170, v170, v174
    v_mfma_f32_16x16x32_bf16 v[184:187], a[36:39], v[80:83], v[184:187]
    buffer_store_dword v170, v4, s[24:27], s58 offen sc1 nt
    v_mfma_f32_16x16x32_bf16 v[184:187], a[40:43], v[88:91], v[184:187]
    ds_read_b128 a[72:75], v10 offset:2048
    v_mfma_f32_16x16x32_bf16 v[184:187], a[44:47], v[96:99], v[184:187]
    v_mfma_f32_16x16x32_bf16 v[184:187], a[48:51], v[104:107], v[184:187]
    s_addk_i32 s58, 7168
    ds_read_b128 a[76:79], v11 offset:2048
    v_cvt_pk_bf16_f32 v171, v171, v175
    v_mfma_f32_16x16x32_bf16 v[184:187], a[52:55], v[112:115], v[184:187]
    buffer_store_dword v171, v4, s[24:27], s58 offen sc1 nt
    v_mfma_f32_16x16x32_bf16 v[184:187], a[56:59], v[120:123], v[184:187]
    s_waitcnt lgkmcnt(2)
    ds_read_b128 a[80:83], v10 offset:6144
    v_mfma_f32_16x16x32_bf16 v[184:187], a[60:63], v[128:131], v[184:187]
    v_mfma_f32_16x16x32_bf16 v[184:187], a[64:67], v[56:59], v[184:187]
    s_add_u32 s58, s58, s63
    ds_read_b128 a[84:87], v11 offset:6144
    v_cvt_pk_bf16_f32 v176, v176, v180
    v_mfma_f32_16x16x32_bf16 v[184:187], a[68:71], v[64:67], v[184:187]
    buffer_store_dword v176, v4, s[24:27], s58 offen sc1 nt
    v_mfma_f32_16x16x32_bf16 v[188:191], a[32:35], v[76:79], v[188:191]
    ds_read_b128 a[88:91], v10 offset:10240
    v_mfma_f32_16x16x32_bf16 v[188:191], a[36:39], v[84:87], v[188:191]
    v_mfma_f32_16x16x32_bf16 v[188:191], a[40:43], v[92:95], v[188:191]
    s_addk_i32 s58, 7168
    ds_read_b128 a[92:95], v11 offset:10240
    v_cvt_pk_bf16_f32 v177, v177, v181
    v_mfma_f32_16x16x32_bf16 v[188:191], a[44:47], v[100:103], v[188:191]
    buffer_store_dword v177, v4, s[24:27], s58 offen sc1 nt
    v_mfma_f32_16x16x32_bf16 v[188:191], a[48:51], v[108:111], v[188:191]
    ds_read_b128 a[0:3], v10 offset:14336
    v_mfma_f32_16x16x32_bf16 v[188:191], a[52:55], v[116:119], v[188:191]
    v_mfma_f32_16x16x32_bf16 v[188:191], a[56:59], v[124:127], v[188:191]
    s_addk_i32 s58, 7168
    ds_read_b128 a[4:7], v11 offset:14336
    v_cvt_pk_bf16_f32 v178, v178, v182
    v_mfma_f32_16x16x32_bf16 v[188:191], a[60:63], v[132:135], v[188:191]
    buffer_store_dword v178, v4, s[24:27], s58 offen sc1 nt
    v_mfma_f32_16x16x32_bf16 v[188:191], a[64:67], v[60:63], v[188:191]
    ds_read_b128 a[8:11], v10 offset:18432
    v_mfma_f32_16x16x32_bf16 v[188:191], a[68:71], v[68:71], v[188:191]
    s_waitcnt lgkmcnt(2)
    v_mfma_f32_16x16x32_bf16 v[192:195], a[72:75], v[72:75], v[192:195]
    s_addk_i32 s58, 7168
    ds_read_b128 a[12:15], v11 offset:18432
    v_cvt_pk_bf16_f32 v179, v179, v183
    v_mfma_f32_16x16x32_bf16 v[192:195], a[76:79], v[80:83], v[192:195]
    buffer_store_dword v179, v4, s[24:27], s58 offen sc1 nt
    v_mfma_f32_16x16x32_bf16 v[192:195], a[80:83], v[88:91], v[192:195]
    ds_read_b128 a[16:19], v10 offset:20480
    v_mfma_f32_16x16x32_bf16 v[192:195], a[84:87], v[96:99], v[192:195]
    v_mfma_f32_16x16x32_bf16 v[192:195], a[88:91], v[104:107], v[192:195]
    ds_read_b128 a[20:23], v11 offset:20480
    v_mfma_f32_16x16x32_bf16 v[192:195], a[92:95], v[112:115], v[192:195]
    v_mfma_f32_16x16x32_bf16 v[192:195], a[0:3], v[120:123], v[192:195]
    s_waitcnt lgkmcnt(2)
    ds_read_b128 a[24:27], v10 offset:24576
    v_mfma_f32_16x16x32_bf16 v[192:195], a[4:7], v[128:131], v[192:195]
    v_mfma_f32_16x16x32_bf16 v[192:195], a[8:11], v[56:59], v[192:195]
    s_add_u32 s58, s58, s63
    ds_read_b128 a[28:31], v11 offset:24576
    v_cvt_pk_bf16_f32 v184, v184, v188
    v_mfma_f32_16x16x32_bf16 v[192:195], a[12:15], v[64:67], v[192:195]
    buffer_store_dword v184, v4, s[24:27], s58 offen sc1 nt
    v_mfma_f32_16x16x32_bf16 v[196:199], a[72:75], v[76:79], v[196:199]
    ds_read_b128 a[32:35], v10 offset:28672
    v_mfma_f32_16x16x32_bf16 v[196:199], a[76:79], v[84:87], v[196:199]
    v_mfma_f32_16x16x32_bf16 v[196:199], a[80:83], v[92:95], v[196:199]
    s_addk_i32 s58, 7168
    ds_read_b128 a[36:39], v11 offset:28672
    v_cvt_pk_bf16_f32 v185, v185, v189
    v_mfma_f32_16x16x32_bf16 v[196:199], a[84:87], v[100:103], v[196:199]
    buffer_store_dword v185, v4, s[24:27], s58 offen sc1 nt
    v_mfma_f32_16x16x32_bf16 v[196:199], a[88:91], v[108:111], v[196:199]
    ds_read_b128 a[40:43], v10 offset:32768
    v_mfma_f32_16x16x32_bf16 v[196:199], a[92:95], v[116:119], v[196:199]
    v_mfma_f32_16x16x32_bf16 v[196:199], a[0:3], v[124:127], v[196:199]
    s_addk_i32 s58, 7168
    ds_read_b128 a[44:47], v11 offset:32768
    v_cvt_pk_bf16_f32 v186, v186, v190
    v_mfma_f32_16x16x32_bf16 v[196:199], a[4:7], v[132:135], v[196:199]
    buffer_store_dword v186, v4, s[24:27], s58 offen sc1 nt
    v_mfma_f32_16x16x32_bf16 v[196:199], a[8:11], v[60:63], v[196:199]
    ds_read_b128 a[48:51], v10 offset:36864
    v_mfma_f32_16x16x32_bf16 v[196:199], a[12:15], v[68:71], v[196:199]
    s_waitcnt lgkmcnt(2)
    v_mfma_f32_16x16x32_bf16 v[200:203], a[16:19], v[72:75], v[200:203]
    s_addk_i32 s58, 7168
    ds_read_b128 a[52:55], v11 offset:36864
    v_cvt_pk_bf16_f32 v187, v187, v191
    v_mfma_f32_16x16x32_bf16 v[200:203], a[20:23], v[80:83], v[200:203]
    buffer_store_dword v187, v4, s[24:27], s58 offen sc1 nt
    v_mfma_f32_16x16x32_bf16 v[200:203], a[24:27], v[88:91], v[200:203]
    ds_read_b128 a[56:59], v10 offset:22528
    v_mfma_f32_16x16x32_bf16 v[200:203], a[28:31], v[96:99], v[200:203]
    v_mfma_f32_16x16x32_bf16 v[200:203], a[32:35], v[104:107], v[200:203]
    ds_read_b128 a[60:63], v11 offset:22528
    v_mfma_f32_16x16x32_bf16 v[200:203], a[36:39], v[112:115], v[200:203]
    v_mfma_f32_16x16x32_bf16 v[200:203], a[40:43], v[120:123], v[200:203]
    s_waitcnt lgkmcnt(2)
    ds_read_b128 a[64:67], v10 offset:26624
    v_mfma_f32_16x16x32_bf16 v[200:203], a[44:47], v[128:131], v[200:203]
    v_mfma_f32_16x16x32_bf16 v[200:203], a[48:51], v[56:59], v[200:203]
    s_add_u32 s58, s58, s63
    ds_read_b128 a[68:71], v11 offset:26624
    v_cvt_pk_bf16_f32 v192, v192, v196
    v_mfma_f32_16x16x32_bf16 v[200:203], a[52:55], v[64:67], v[200:203]
    buffer_store_dword v192, v4, s[24:27], s58 offen sc1 nt
    v_mfma_f32_16x16x32_bf16 v[204:207], a[16:19], v[76:79], v[204:207]
    ds_read_b128 a[72:75], v10 offset:30720
    v_mfma_f32_16x16x32_bf16 v[204:207], a[20:23], v[84:87], v[204:207]
    v_mfma_f32_16x16x32_bf16 v[204:207], a[24:27], v[92:95], v[204:207]
    s_addk_i32 s58, 7168
    ds_read_b128 a[76:79], v11 offset:30720
    v_cvt_pk_bf16_f32 v193, v193, v197
    v_mfma_f32_16x16x32_bf16 v[204:207], a[28:31], v[100:103], v[204:207]
    buffer_store_dword v193, v4, s[24:27], s58 offen sc1 nt
    v_mfma_f32_16x16x32_bf16 v[204:207], a[32:35], v[108:111], v[204:207]
    ds_read_b128 a[80:83], v10 offset:34816
    v_mfma_f32_16x16x32_bf16 v[204:207], a[36:39], v[116:119], v[204:207]
    v_mfma_f32_16x16x32_bf16 v[204:207], a[40:43], v[124:127], v[204:207]
    s_addk_i32 s58, 7168
    ds_read_b128 a[84:87], v11 offset:34816
    v_cvt_pk_bf16_f32 v194, v194, v198
    v_mfma_f32_16x16x32_bf16 v[204:207], a[44:47], v[132:135], v[204:207]
    buffer_store_dword v194, v4, s[24:27], s58 offen sc1 nt
    v_mfma_f32_16x16x32_bf16 v[204:207], a[48:51], v[60:63], v[204:207]
    ds_read_b128 a[88:91], v10 offset:38912
    v_mfma_f32_16x16x32_bf16 v[204:207], a[52:55], v[68:71], v[204:207]
    s_waitcnt lgkmcnt(2)
    v_mfma_f32_16x16x32_bf16 v[208:211], a[56:59], v[72:75], v[208:211]
    s_addk_i32 s58, 7168
    ds_read_b128 a[92:95], v11 offset:38912
    v_cvt_pk_bf16_f32 v195, v195, v199
    v_mfma_f32_16x16x32_bf16 v[208:211], a[60:63], v[80:83], v[208:211]
    buffer_store_dword v195, v4, s[24:27], s58 offen sc1 nt
    v_mfma_f32_16x16x32_bf16 v[208:211], a[64:67], v[88:91], v[208:211]
    ds_read_b128 a[0:3], v10 offset:40960
    v_mfma_f32_16x16x32_bf16 v[208:211], a[68:71], v[96:99], v[208:211]
    v_mfma_f32_16x16x32_bf16 v[208:211], a[72:75], v[104:107], v[208:211]
    ds_read_b128 a[4:7], v11 offset:40960
    v_mfma_f32_16x16x32_bf16 v[208:211], a[76:79], v[112:115], v[208:211]
    v_mfma_f32_16x16x32_bf16 v[208:211], a[80:83], v[120:123], v[208:211]
    s_waitcnt lgkmcnt(2)
    ds_read_b128 a[8:11], v10 offset:45056
    v_mfma_f32_16x16x32_bf16 v[208:211], a[84:87], v[128:131], v[208:211]
    v_mfma_f32_16x16x32_bf16 v[208:211], a[88:91], v[56:59], v[208:211]
    s_add_u32 s58, s58, s63
    ds_read_b128 a[12:15], v11 offset:45056
    v_cvt_pk_bf16_f32 v200, v200, v204
    v_mfma_f32_16x16x32_bf16 v[208:211], a[92:95], v[64:67], v[208:211]
    buffer_store_dword v200, v4, s[24:27], s58 offen sc1 nt
    v_mfma_f32_16x16x32_bf16 v[212:215], a[56:59], v[76:79], v[212:215]
    ds_read_b128 a[16:19], v10 offset:49152
    v_mfma_f32_16x16x32_bf16 v[212:215], a[60:63], v[84:87], v[212:215]
    v_mfma_f32_16x16x32_bf16 v[212:215], a[64:67], v[92:95], v[212:215]
    s_addk_i32 s58, 7168
    ds_read_b128 a[20:23], v11 offset:49152
    v_cvt_pk_bf16_f32 v201, v201, v205
    v_mfma_f32_16x16x32_bf16 v[212:215], a[68:71], v[100:103], v[212:215]
    buffer_store_dword v201, v4, s[24:27], s58 offen sc1 nt
    v_mfma_f32_16x16x32_bf16 v[212:215], a[72:75], v[108:111], v[212:215]
    ds_read_b128 a[24:27], v10 offset:53248
    v_mfma_f32_16x16x32_bf16 v[212:215], a[76:79], v[116:119], v[212:215]
    v_mfma_f32_16x16x32_bf16 v[212:215], a[80:83], v[124:127], v[212:215]
    s_addk_i32 s58, 7168
    ds_read_b128 a[28:31], v11 offset:53248
    v_cvt_pk_bf16_f32 v202, v202, v206
    v_mfma_f32_16x16x32_bf16 v[212:215], a[84:87], v[132:135], v[212:215]
    buffer_store_dword v202, v4, s[24:27], s58 offen sc1 nt
    v_mfma_f32_16x16x32_bf16 v[212:215], a[88:91], v[60:63], v[212:215]
    ds_read_b128 a[32:35], v10 offset:57344
    v_mfma_f32_16x16x32_bf16 v[212:215], a[92:95], v[68:71], v[212:215]
    s_waitcnt lgkmcnt(2)
    v_mfma_f32_16x16x32_bf16 v[216:219], a[0:3], v[72:75], v[216:219]
    s_addk_i32 s58, 7168
    ds_read_b128 a[36:39], v11 offset:57344
    v_cvt_pk_bf16_f32 v203, v203, v207
    v_mfma_f32_16x16x32_bf16 v[216:219], a[4:7], v[80:83], v[216:219]
    buffer_store_dword v203, v4, s[24:27], s58 offen sc1 nt
    v_mfma_f32_16x16x32_bf16 v[216:219], a[8:11], v[88:91], v[216:219]
    ds_read_b128 a[40:43], v10 offset:43008
    v_mfma_f32_16x16x32_bf16 v[216:219], a[12:15], v[96:99], v[216:219]
    v_mfma_f32_16x16x32_bf16 v[216:219], a[16:19], v[104:107], v[216:219]
    ds_read_b128 a[44:47], v11 offset:43008
    v_mfma_f32_16x16x32_bf16 v[216:219], a[20:23], v[112:115], v[216:219]
    v_mfma_f32_16x16x32_bf16 v[216:219], a[24:27], v[120:123], v[216:219]
    s_waitcnt lgkmcnt(2)
    ds_read_b128 a[48:51], v10 offset:47104
    v_mfma_f32_16x16x32_bf16 v[216:219], a[28:31], v[128:131], v[216:219]
    v_mfma_f32_16x16x32_bf16 v[216:219], a[32:35], v[56:59], v[216:219]
    s_add_u32 s58, s58, s63
    ds_read_b128 a[52:55], v11 offset:47104
    v_cvt_pk_bf16_f32 v208, v208, v212
    v_mfma_f32_16x16x32_bf16 v[216:219], a[36:39], v[64:67], v[216:219]
    buffer_store_dword v208, v4, s[24:27], s58 offen sc1 nt
    v_mfma_f32_16x16x32_bf16 v[220:223], a[0:3], v[76:79], v[220:223]
    ds_read_b128 a[56:59], v10 offset:51200
    v_mfma_f32_16x16x32_bf16 v[220:223], a[4:7], v[84:87], v[220:223]
    v_mfma_f32_16x16x32_bf16 v[220:223], a[8:11], v[92:95], v[220:223]
    s_addk_i32 s58, 7168
    ds_read_b128 a[60:63], v11 offset:51200
    v_cvt_pk_bf16_f32 v209, v209, v213
    v_mfma_f32_16x16x32_bf16 v[220:223], a[12:15], v[100:103], v[220:223]
    buffer_store_dword v209, v4, s[24:27], s58 offen sc1 nt
    v_mfma_f32_16x16x32_bf16 v[220:223], a[16:19], v[108:111], v[220:223]
    ds_read_b128 a[64:67], v10 offset:55296
    v_mfma_f32_16x16x32_bf16 v[220:223], a[20:23], v[116:119], v[220:223]
    v_mfma_f32_16x16x32_bf16 v[220:223], a[24:27], v[124:127], v[220:223]
    s_addk_i32 s58, 7168
    ds_read_b128 a[68:71], v11 offset:55296
    v_cvt_pk_bf16_f32 v210, v210, v214
    v_mfma_f32_16x16x32_bf16 v[220:223], a[28:31], v[132:135], v[220:223]
    buffer_store_dword v210, v4, s[24:27], s58 offen sc1 nt
    v_mfma_f32_16x16x32_bf16 v[220:223], a[32:35], v[60:63], v[220:223]
    ds_read_b128 a[72:75], v10 offset:59392
    v_mfma_f32_16x16x32_bf16 v[220:223], a[36:39], v[68:71], v[220:223]
    s_waitcnt lgkmcnt(2)
    v_mfma_f32_16x16x32_bf16 v[224:227], a[40:43], v[72:75], v[224:227]
    s_addk_i32 s58, 7168
    ds_read_b128 a[76:79], v11 offset:59392
    v_cvt_pk_bf16_f32 v211, v211, v215
    v_mfma_f32_16x16x32_bf16 v[224:227], a[44:47], v[80:83], v[224:227]
    buffer_store_dword v211, v4, s[24:27], s58 offen sc1 nt
    v_mfma_f32_16x16x32_bf16 v[224:227], a[48:51], v[88:91], v[224:227]
    ds_read_b128 a[80:83], v10 offset:61440
    v_mfma_f32_16x16x32_bf16 v[224:227], a[52:55], v[96:99], v[224:227]
    v_mfma_f32_16x16x32_bf16 v[224:227], a[56:59], v[104:107], v[224:227]
    ds_read_b128 a[84:87], v11 offset:61440
    v_mfma_f32_16x16x32_bf16 v[224:227], a[60:63], v[112:115], v[224:227]
    v_mfma_f32_16x16x32_bf16 v[224:227], a[64:67], v[120:123], v[224:227]
    s_waitcnt lgkmcnt(2)
    ds_read_b128 a[88:91], v12 offset:0
    v_mfma_f32_16x16x32_bf16 v[224:227], a[68:71], v[128:131], v[224:227]
    v_mfma_f32_16x16x32_bf16 v[224:227], a[72:75], v[56:59], v[224:227]
    s_add_u32 s58, s58, s63
    ds_read_b128 a[92:95], v13 offset:0
    v_cvt_pk_bf16_f32 v216, v216, v220
    v_mfma_f32_16x16x32_bf16 v[224:227], a[76:79], v[64:67], v[224:227]
    buffer_store_dword v216, v4, s[24:27], s58 offen sc1 nt
    v_mfma_f32_16x16x32_bf16 v[228:231], a[40:43], v[76:79], v[228:231]
    ds_read_b128 a[0:3], v12 offset:4096
    v_mfma_f32_16x16x32_bf16 v[228:231], a[44:47], v[84:87], v[228:231]
    v_mfma_f32_16x16x32_bf16 v[228:231], a[48:51], v[92:95], v[228:231]
    s_waitcnt vmcnt(41) lgkmcnt(2)
    ds_read_b128 a[4:7], v13 offset:4096
    v_mfma_f32_16x16x32_bf16 v[228:231], a[52:55], v[100:103], v[228:231]
    s_barrier
    v_mfma_f32_16x16x32_bf16 v[228:231], a[56:59], v[108:111], v[228:231]
    s_addk_i32 s58, 7168
    ds_read_b128 a[8:11], v12 offset:8192
    v_cvt_pk_bf16_f32 v217, v217, v221
    v_mfma_f32_16x16x32_bf16 v[228:231], a[60:63], v[116:119], v[228:231]
    buffer_store_dword v217, v4, s[24:27], s58 offen sc1 nt
    v_mfma_f32_16x16x32_bf16 v[228:231], a[64:67], v[124:127], v[228:231]
    s_addk_i32 s58, 7168
    ds_read_b128 a[12:15], v13 offset:8192
    v_cvt_pk_bf16_f32 v218, v218, v222
    v_mfma_f32_16x16x32_bf16 v[228:231], a[68:71], v[132:135], v[228:231]
    buffer_store_dword v218, v4, s[24:27], s58 offen sc1 nt
    v_mfma_f32_16x16x32_bf16 v[228:231], a[72:75], v[60:63], v[228:231]
    ds_read_b128 a[16:19], v12 offset:12288
    v_mfma_f32_16x16x32_bf16 v[228:231], a[76:79], v[68:71], v[228:231]
    v_mfma_f32_16x16x32_bf16 v[232:235], a[80:83], v[72:75], v[232:235]
    s_addk_i32 s58, 7168
    ds_read_b128 a[20:23], v13 offset:12288
    v_cvt_pk_bf16_f32 v219, v219, v223
    v_mfma_f32_16x16x32_bf16 v[232:235], a[84:87], v[80:83], v[232:235]
    buffer_store_dword v219, v4, s[24:27], s58 offen sc1 nt
    v_mfma_f32_16x16x32_bf16 v[232:235], a[88:91], v[88:91], v[232:235]
    s_waitcnt lgkmcnt(2)
    ds_read_b128 a[24:27], v10 offset:63488
    v_mfma_f32_16x16x32_bf16 v[232:235], a[92:95], v[96:99], v[232:235]
    v_mfma_f32_16x16x32_bf16 v[232:235], a[0:3], v[104:107], v[232:235]
    ds_read_b128 a[28:31], v11 offset:63488
    v_mfma_f32_16x16x32_bf16 v[232:235], a[4:7], v[112:115], v[232:235]
    v_mfma_f32_16x16x32_bf16 v[232:235], a[8:11], v[120:123], v[232:235]
    ds_read_b128 a[32:35], v12 offset:2048
    v_mfma_f32_16x16x32_bf16 v[232:235], a[12:15], v[128:131], v[232:235]
    s_waitcnt lgkmcnt(2)
    v_mfma_f32_16x16x32_bf16 v[232:235], a[16:19], v[56:59], v[232:235]
    s_add_u32 s58, s58, s63
    ds_read_b128 a[36:39], v13 offset:2048
    v_cvt_pk_bf16_f32 v224, v224, v228
    v_mfma_f32_16x16x32_bf16 v[232:235], a[20:23], v[64:67], v[232:235]
    buffer_store_dword v224, v4, s[24:27], s58 offen sc1 nt
    v_mfma_f32_16x16x32_bf16 v[236:239], a[80:83], v[76:79], v[236:239]
    ds_read_b128 a[40:43], v12 offset:6144
    v_mfma_f32_16x16x32_bf16 v[236:239], a[84:87], v[84:87], v[236:239]
    v_mfma_f32_16x16x32_bf16 v[236:239], a[88:91], v[92:95], v[236:239]
    s_addk_i32 s58, 7168
    ds_read_b128 a[44:47], v13 offset:6144
    v_cvt_pk_bf16_f32 v225, v225, v229
    v_mfma_f32_16x16x32_bf16 v[236:239], a[92:95], v[100:103], v[236:239]
    buffer_store_dword v225, v4, s[24:27], s58 offen sc1 nt
    v_mfma_f32_16x16x32_bf16 v[236:239], a[0:3], v[108:111], v[236:239]
    ds_read_b128 a[48:51], v12 offset:10240
    v_mfma_f32_16x16x32_bf16 v[236:239], a[4:7], v[116:119], v[236:239]
    v_mfma_f32_16x16x32_bf16 v[236:239], a[8:11], v[124:127], v[236:239]
    s_addk_i32 s58, 7168
    ds_read_b128 a[52:55], v13 offset:10240
    v_cvt_pk_bf16_f32 v226, v226, v230
    v_mfma_f32_16x16x32_bf16 v[236:239], a[12:15], v[132:135], v[236:239]
    buffer_store_dword v226, v4, s[24:27], s58 offen sc1 nt
    v_mfma_f32_16x16x32_bf16 v[236:239], a[16:19], v[60:63], v[236:239]
    ds_read_b128 a[56:59], v12 offset:14336
    v_mfma_f32_16x16x32_bf16 v[236:239], a[20:23], v[68:71], v[236:239]
    s_waitcnt lgkmcnt(2)
    v_mfma_f32_16x16x32_bf16 v[240:243], a[24:27], v[72:75], v[240:243]
    s_addk_i32 s58, 7168
    ds_read_b128 a[60:63], v13 offset:14336
    v_cvt_pk_bf16_f32 v227, v227, v231
    v_mfma_f32_16x16x32_bf16 v[240:243], a[28:31], v[80:83], v[240:243]
    buffer_store_dword v227, v4, s[24:27], s58 offen sc1 nt
    v_mfma_f32_16x16x32_bf16 v[240:243], a[32:35], v[88:91], v[240:243]
    v_mfma_f32_16x16x32_bf16 v[240:243], a[36:39], v[96:99], v[240:243]
    v_mfma_f32_16x16x32_bf16 v[240:243], a[40:43], v[104:107], v[240:243]
    v_mfma_f32_16x16x32_bf16 v[240:243], a[44:47], v[112:115], v[240:243]
    v_mfma_f32_16x16x32_bf16 v[240:243], a[48:51], v[120:123], v[240:243]
    s_waitcnt lgkmcnt(0)
    v_mfma_f32_16x16x32_bf16 v[240:243], a[52:55], v[128:131], v[240:243]
    s_add_u32 s58, s58, s63
    v_cvt_pk_bf16_f32 v232, v232, v236
    v_mfma_f32_16x16x32_bf16 v[240:243], a[56:59], v[56:59], v[240:243]
    buffer_store_dword v232, v4, s[24:27], s58 offen sc1 nt
    v_mfma_f32_16x16x32_bf16 v[240:243], a[60:63], v[64:67], v[240:243]
    s_addk_i32 s58, 7168
    v_cvt_pk_bf16_f32 v233, v233, v237
    v_mfma_f32_16x16x32_bf16 v[244:247], a[24:27], v[76:79], v[244:247]
    buffer_store_dword v233, v4, s[24:27], s58 offen sc1 nt
    v_mfma_f32_16x16x32_bf16 v[244:247], a[28:31], v[84:87], v[244:247]
    s_addk_i32 s58, 7168
    v_cvt_pk_bf16_f32 v234, v234, v238
    v_mfma_f32_16x16x32_bf16 v[244:247], a[32:35], v[92:95], v[244:247]
    buffer_store_dword v234, v4, s[24:27], s58 offen sc1 nt
    v_mfma_f32_16x16x32_bf16 v[244:247], a[36:39], v[100:103], v[244:247]
    s_addk_i32 s58, 7168
    v_cvt_pk_bf16_f32 v235, v235, v239
    v_mfma_f32_16x16x32_bf16 v[244:247], a[40:43], v[108:111], v[244:247]
    buffer_store_dword v235, v4, s[24:27], s58 offen sc1 nt
    v_mfma_f32_16x16x32_bf16 v[244:247], a[44:47], v[116:119], v[244:247]
    v_mfma_f32_16x16x32_bf16 v[244:247], a[48:51], v[124:127], v[244:247]
    v_mfma_f32_16x16x32_bf16 v[244:247], a[52:55], v[132:135], v[244:247]
    v_mfma_f32_16x16x32_bf16 v[244:247], a[56:59], v[60:63], v[244:247]
    v_mfma_f32_16x16x32_bf16 v[244:247], a[60:63], v[68:71], v[244:247]
    s_mov_b32 s4, 1490944
    s_mov_b32 s5, 1498112
    s_mov_b32 s6, 1505280
    s_mov_b32 s7, 1512448
    s_nop 3
    v_cvt_pk_bf16_f32 v240, v240, v244
    v_cvt_pk_bf16_f32 v241, v241, v245
    v_cvt_pk_bf16_f32 v242, v242, v246
    v_cvt_pk_bf16_f32 v243, v243, v247
    buffer_store_dword v240, v4, s[24:27], s4 offen sc1 nt
    buffer_store_dword v241, v4, s[24:27], s5 offen sc1 nt
    buffer_store_dword v242, v4, s[24:27], s6 offen sc1 nt
    buffer_store_dword v243, v4, s[24:27], s7 offen sc1 nt
L_mainendB:
L_fin:
L_end:
s_endpgm
.fill 64, 4, 0xbf810000
.section .rodata,"a"
.p2align 6
.amdhsa_kernel standalone__weight_only_int_gptq__prompt_kernel
  .amdhsa_next_free_vgpr 356
  .amdhsa_next_free_sgpr 102
  .amdhsa_accum_offset 256
  .amdhsa_group_segment_fixed_size 0
  .amdhsa_kernarg_size 64
  .amdhsa_user_sgpr_count 2
  .amdhsa_user_sgpr_kernarg_segment_ptr 1
  .amdhsa_system_sgpr_workgroup_id_x 1
  .amdhsa_float_denorm_mode_32 3
.end_amdhsa_kernel
```
